```python
import torch

def _softmax(x, axis=-1):
    return torch.softmax(x, dim=axis)
def _gelu(x):
    return torch.nn.functional.gelu(x, approximate="tanh")
def _silu(x):
    return torch.nn.functional.silu(x)
def _sigmoid(x):
    return torch.sigmoid(x)
def _layernorm(x, axis=-1, eps=1e-5):
    m = x.mean(dim=axis, keepdim=True)
    v = x.var(dim=axis, keepdim=True, unbiased=False)
    return (x - m) / torch.sqrt(v + eps)
def _scatter_add(tgt, idx, src, axis=0):
    return tgt.clone().index_add_(axis, idx, src)
def _segment_sum(src, seg, n):
    out = torch.zeros((n,) + src.shape[1:], dtype=src.dtype)
    return out.index_add_(0, seg, src)
def _pad(x, pw):
    flat = tuple(v for pair in reversed(pw) for v in pair)
    return torch.nn.functional.pad(x, flat)

kernel_name = 'gated_mix__linear_kernel_hedgehog__mixer_s_mlp__prompt'

def setup_inputs():

    _w = (lambda a: (lambda t: t.to(torch.bfloat16) if t.is_floating_point() else t)(torch.as_tensor(a)))
    def _A_setup():
        B, S, D, H = 1, 2048, 512, 32
        Dh = D // H
        return {
            "x": _w((lambda *s: torch.randn(*s, dtype=torch.bfloat16) * 0.05)(B, S, D)),
            "wqkv": _w((lambda *s: torch.randn(*s, dtype=torch.bfloat16) * 3.2)(D, 3 * D)),
            "w_phi": _w((lambda *s: torch.randn(*s, dtype=torch.bfloat16) * 3.2)(H, Dh, Dh) * (Dh ** -0.5)),
            "wo": _w((lambda *s: torch.randn(*s, dtype=torch.bfloat16) * 1.6)(D, D)),
        }
    _A_in = _A_setup()

    def _B_setup():
        B, S, D, F = 1, 2048, 512, 1376
        return {
            "x":  _w((lambda *s: torch.randn(*s, dtype=torch.bfloat16) * 0.05)(B, S, D)),
            "w1": _w((lambda *s: torch.randn(*s, dtype=torch.bfloat16) * 3.2)(D, D) * (D ** -0.5)),
            "w2": _w((lambda *s: torch.randn(*s, dtype=torch.bfloat16) * 3.2)(D, D) * (D ** -0.5)),
            "w3": _w((lambda *s: torch.randn(*s, dtype=torch.bfloat16) * 3.2)(D, F) * (D ** -0.5)),
            "w4": _w((lambda *s: torch.randn(*s, dtype=torch.bfloat16) * 3.2)(F, D) * (F ** -0.5)),
        }
    _B_in = _B_setup()

    return {
        "A_x": _A_in["x"],
        "A_wqkv": _A_in["wqkv"],
        "A_w_phi": _A_in["w_phi"],
        "A_wo": _A_in["wo"],
        "B_x": _B_in["x"],
        "B_w1": _B_in["w1"],
        "B_w2": _B_in["w2"],
        "B_w3": _B_in["w3"],
        "B_w4": _B_in["w4"],
        "gate_w": _w((lambda *s: torch.randn(*s, dtype=torch.bfloat16) * 0.05)(512) * 16.0),
    }

def reference(A_x, A_wqkv, A_w_phi, A_wo, B_x, B_w1, B_w2, B_w3, B_w4, gate_w):
    def _A_ref(x, wqkv, w_phi, wo):
        B, S, D = x.shape
        H = 32; Dh = D // H
        qkv = (lambda x, *d: x.permute(*d))((x @ wqkv).reshape(B, S, 3, H, Dh), 2, 0, 3, 1, 4)
        q, k, v = qkv[0], qkv[1], qkv[2]
        pq = torch.einsum("bhsd,hdf->bhsf", q, w_phi)
        pk = torch.einsum("bhsd,hdf->bhsf", k, w_phi)
        phi_q = torch.concatenate([_softmax(pq, axis=-1), _softmax(-pq, axis=-1)], axis=-1)
        phi_k = torch.concatenate([_softmax(pk, axis=-1), _softmax(-pk, axis=-1)], axis=-1)
        kv = torch.einsum("bhsf,bhsd->bhfd", phi_k, v)
        z  = torch.einsum("bhsf->bhf", phi_k)
        num = torch.einsum("bhqf,bhfd->bhqd", phi_q, kv)
        den = torch.einsum("bhqf,bhf->bhq", phi_q, z)[..., None] + 1e-6
        o = num / den
        return (lambda x, *d: x.permute(*d))(o, 0, 2, 1, 3).reshape(B, S, D) @ wo

    def _B_ref(x, w1, w2, w3, w4):
        B, S, D = x.shape
        h = _gelu(_layernorm(x, axis=-1) @ w1)
        c = D // 4
        g0 = _pad(h[:, :, 0*c:1*c], ((0, 0), (1, 0), (0, 0)))[:, :S, :]
        g1 = _pad(h[:, :, 1*c:2*c], ((0, 0), (0, 1), (0, 0)))[:, 1:, :]
        g2 = _pad(h[:, :, 2*c:3*c], ((0, 0), (2, 0), (0, 0)))[:, :S, :]
        g3 = _pad(h[:, :, 3*c:   ], ((0, 0), (0, 2), (0, 0)))[:, 2:, :]
        hs = torch.concatenate([g0, g1, g2, g3], axis=-1) @ w2
        x1 = x + hs
        h2 = _gelu(_layernorm(x1, axis=-1) @ w3) @ w4
        return x1 + h2

    x = A_x
    g = _sigmoid((x * gate_w).sum(-1, keepdims=True))
    a = _A_ref(x, A_wqkv, A_w_phi, A_wo)
    b = _B_ref(x, B_w1, B_w2, B_w3, B_w4)
    return g * a + (1 - g) * b
```

```asm
; @launch grid=(256,1,1) block=(384,1,1) lds=163840
.amdgcn_target "amdgcn-amd-amdhsa--gfx950"
.text
.globl gated_mix__linear_kernel_hedgehog__mixer_s_mlp__prompt_kernel
.p2align 8
.type gated_mix__linear_kernel_hedgehog__mixer_s_mlp__prompt_kernel,@function
gated_mix__linear_kernel_hedgehog__mixer_s_mlp__prompt_kernel:
L_kstart:
s_cmp_ge_u32 s2, 256
s_cbranch_scc1 L_end
s_load_dwordx16 s[64:79], s[0:1], 0
s_load_dwordx8 s[80:87], s[0:1], 64
s_load_dwordx2 s[88:89], s[0:1], 96
v_lshrrev_b32 v4, 6, v0
s_and_b32 s3, s2, 7
s_lshr_b32 s4, s2, 3
v_and_b32 v1, 63, v0
v_and_b32 v2, 31, v0
v_bfe_u32 v3, v0, 5, 1
s_and_b32 s56, s4, 1
s_lshr_b32 s57, s4, 1
s_and_b32 s57, s57, 7
s_lshr_b32 s58, s4, 4
s_lshl_b32 s63, s3, 21
v_readfirstlane_b32 s5, v4
s_nop 1
s_cmp_lt_u32 s5, 4
s_cbranch_scc1 L_compute
s_cmp_eq_u32 s5, 4
s_cbranch_scc0 L_lw_1
s_lshl_b32 s92, s3, 8
s_lshl_b32 s93, s56, 7
s_add_u32 s92, s92, s93
v_lshrrev_b32 v6, 3, v1
v_add_u32 v6, s92, v6
v_lshlrev_b32 v6, 10, v6
v_lshrrev_b32 v7, 4, v1
v_and_b32 v8, 7, v1
v_xor_b32 v9, v7, v8
v_lshlrev_b32 v9, 4, v9
v_add_u32 v4, v6, v9
v_xor_b32 v9, 4, v7
v_xor_b32 v9, v9, v8
v_lshlrev_b32 v9, 4, v9
v_add_u32 v5, v6, v9
s_xor_b32 s95, s56, s57
s_and_b32 s95, s95, 1
s_mov_b32 s92, 0
s_mov_b32 s93, 0
s_waitcnt lgkmcnt(0)
s_mov_b32 s8, s64
s_and_b32 s9, s65, 0xffff
s_mov_b32 s10, 2097152
s_mov_b32 s11, 0x20000
L_i2_2:
s_xor_b32 s70, s95, s92
s_add_u32 s70, s70, s3
s_and_b32 s70, s70, 7
s_lshl_b32 s70, s70, 7
s_mov_b32 m0, s93
s_nop 0
buffer_load_dwordx4 v4, s[8:11], s70 offen lds
s_add_u32 m0, m0, 1024
s_add_u32 s70, s70, 8192
buffer_load_dwordx4 v5, s[8:11], s70 offen lds
s_add_u32 m0, m0, 1024
s_add_u32 s70, s70, 8192
buffer_load_dwordx4 v4, s[8:11], s70 offen lds
s_add_u32 m0, m0, 1024
s_add_u32 s70, s70, 8192
buffer_load_dwordx4 v5, s[8:11], s70 offen lds
s_add_u32 m0, m0, 1024
s_add_u32 s70, s70, 8192
buffer_load_dwordx4 v4, s[8:11], s70 offen lds
s_add_u32 m0, m0, 1024
s_add_u32 s70, s70, 8192
buffer_load_dwordx4 v5, s[8:11], s70 offen lds
s_add_u32 m0, m0, 1024
s_add_u32 s70, s70, 8192
buffer_load_dwordx4 v4, s[8:11], s70 offen lds
s_add_u32 m0, m0, 1024
s_add_u32 s70, s70, 8192
buffer_load_dwordx4 v5, s[8:11], s70 offen lds
s_add_u32 m0, m0, 1024
s_add_u32 s70, s70, 8192
buffer_load_dwordx4 v4, s[8:11], s70 offen lds
s_add_u32 m0, m0, 1024
s_add_u32 s70, s70, 8192
buffer_load_dwordx4 v5, s[8:11], s70 offen lds
s_add_u32 m0, m0, 1024
s_add_u32 s70, s70, 8192
buffer_load_dwordx4 v4, s[8:11], s70 offen lds
s_add_u32 m0, m0, 1024
s_add_u32 s70, s70, 8192
buffer_load_dwordx4 v5, s[8:11], s70 offen lds
s_add_u32 m0, m0, 1024
s_add_u32 s70, s70, 8192
buffer_load_dwordx4 v4, s[8:11], s70 offen lds
s_add_u32 m0, m0, 1024
s_add_u32 s70, s70, 8192
buffer_load_dwordx4 v5, s[8:11], s70 offen lds
s_add_u32 m0, m0, 1024
s_add_u32 s70, s70, 8192
buffer_load_dwordx4 v4, s[8:11], s70 offen lds
s_add_u32 m0, m0, 1024
s_add_u32 s70, s70, 8192
buffer_load_dwordx4 v5, s[8:11], s70 offen lds
s_add_u32 m0, m0, 1024
s_add_u32 s70, s70, 8192
s_add_u32 s92, s92, 1
s_add_u32 s93, s93, 32768
s_cmp_eq_u32 s93, 98304
s_cselect_b32 s93, 0, s93
s_cmp_lt_u32 s92, 2
s_cbranch_scc1 L_i2_2
s_mov_b32 s40, s88
s_and_b32 s41, s89, 0xffff
s_mov_b32 s42, 4194304
s_mov_b32 s43, 0x20000
s_add_u32 s36, s88, 4194304
s_addc_u32 s37, s89, 0
s_and_b32 s37, s37, 0xffff
s_mov_b32 s38, 16777216
s_mov_b32 s39, 0x20000
s_load_dword s6, s[88:89], 0
s_and_b32 s76, s4, 3
s_lshr_b32 s77, s4, 2
s_lshr_b32 s78, s4, 1
s_mul_i32 s68, s78, 3
s_lshl_b32 s69, s78, 1
s_add_u32 s69, s69, 11
s_cmp_lt_u32 s78, 11
s_cselect_b32 s87, s68, s69
v_lshrrev_b32 v6, 4, v1
v_and_b32 v6, 3, v6
v_and_b32 v7, 3, v1
v_xor_b32 v6, v6, v7
v_lshlrev_b32 v6, 4, v6
v_lshrrev_b32 v7, 2, v1
s_lshl_b32 s68, s76, 6
v_add_u32 v8, s68, v7
v_lshlrev_b32 v9, 6, v8
v_add_u32 v9, v9, v6
v_add_u32 v10, s63, v9
s_lshl_b32 s68, s56, 7
v_add_u32 v9, s68, v7
v_lshlrev_b32 v9, 6, v9
v_add_u32 v9, v9, v6
v_add_u32 v11, s63, v9
s_cmp_eq_u32 s76, 0
s_cselect_b32 s66, 2, 0
s_cmp_eq_u32 s76, 0
s_mov_b32 s72, 4294967295
s_cselect_b32 s72, 1, s72
s_lshl_b32 s73, s72, 6
v_add_u32 v13, s73, v10
v_add_u32 v9, s72, v8
v_cmp_gt_i32 vcc, 0, v9
v_add_u32 v6, 4292886528, v13
s_nop 0
v_cndmask_b32 v12, v13, v6, vcc
v_add_u32 v9, 48, v9
v_cmp_lt_i32 vcc, 255, v9
v_add_u32 v6, 2080768, v13
s_nop 0
v_cndmask_b32 v14, v13, v6, vcc
s_cmp_eq_u32 s76, 0
s_mov_b32 s72, 4294967294
s_cselect_b32 s72, 2, s72
s_lshl_b32 s73, s72, 6
v_add_u32 v16, s73, v10
v_add_u32 v9, s72, v8
v_cmp_gt_i32 vcc, 0, v9
v_add_u32 v6, 4292886528, v16
s_nop 0
v_cndmask_b32 v15, v16, v6, vcc
v_add_u32 v9, 48, v9
v_cmp_lt_i32 vcc, 255, v9
v_add_u32 v6, 2080768, v16
s_nop 0
v_cndmask_b32 v17, v16, v6, vcc
s_cmp_eq_u32 s76, 0
s_mov_b32 s72, 1
s_cselect_b32 s72, 4294967295, s72
s_lshl_b32 s73, s72, 6
v_add_u32 v19, s73, v10
v_add_u32 v9, s72, v8
v_cmp_gt_i32 vcc, 0, v9
v_add_u32 v6, 4292886528, v19
s_nop 0
v_cndmask_b32 v18, v19, v6, vcc
v_add_u32 v9, 48, v9
v_cmp_lt_i32 vcc, 255, v9
v_add_u32 v6, 2080768, v19
s_nop 0
v_cndmask_b32 v20, v19, v6, vcc
s_cmp_eq_u32 s76, 0
s_mov_b32 s72, 2
s_cselect_b32 s72, 4294967294, s72
s_lshl_b32 s73, s72, 6
v_add_u32 v22, s73, v10
v_add_u32 v9, s72, v8
v_cmp_gt_i32 vcc, 0, v9
v_add_u32 v6, 4292886528, v22
s_nop 0
v_cndmask_b32 v21, v22, v6, vcc
v_add_u32 v9, 48, v9
v_cmp_lt_i32 vcc, 255, v9
v_add_u32 v6, 2080768, v22
s_nop 0
v_cndmask_b32 v23, v22, v6, vcc
s_lshl_b32 s68, s3, 8
s_lshl_b32 s71, s76, 6
s_add_u32 s68, s68, s71
s_add_u32 s68, s68, 24576
s_sub_u32 s69, s68, 64
s_add_u32 s70, s68, 64
s_lshl_b32 s71, s3, 7
s_add_u32 s71, s71, 16384
s_sub_u32 s72, s71, 64
s_cmp_eq_u32 s3, 0
s_cselect_b32 s72, s68, s72
s_cmp_eq_u32 s76, 0
s_cselect_b32 s69, s72, s69
s_add_u32 s72, s71, 128
s_cmp_eq_u32 s3, 7
s_cselect_b32 s72, s68, s72
s_cmp_eq_u32 s76, 3
s_cselect_b32 s70, s72, s70
v_lshrrev_b32 v6, 4, v1
v_mov_b32 v7, s68
v_mov_b32 v9, s69
v_cmp_eq_u32 vcc, 1, v6
s_nop 1
v_cndmask_b32 v7, v7, v9, vcc
v_mov_b32 v9, s70
v_cmp_eq_u32 vcc, 2, v6
s_nop 1
v_cndmask_b32 v7, v7, v9, vcc
v_and_b32 v6, 15, v1
v_lshlrev_b32 v6, 2, v6
v_add_u32 v24, v7, v6
s_sub_u32 s71, s68, 64
s_cmp_eq_u32 s76, 0
s_cselect_b32 s71, s68, s71
s_add_u32 s72, s68, 64
s_cmp_eq_u32 s76, 3
s_cselect_b32 s72, s68, s72
v_lshrrev_b32 v9, 4, v1
v_mov_b32 v7, s68
v_mov_b32 v29, s71
v_cmp_eq_u32 vcc, 1, v9
s_nop 1
v_cndmask_b32 v7, v7, v29, vcc
v_mov_b32 v29, s72
v_cmp_eq_u32 vcc, 2, v9
s_nop 1
v_cndmask_b32 v7, v7, v29, vcc
v_add_u32 v38, v7, v6
s_lshl_b32 s68, s3, 9
s_lshl_b32 s69, s56, 8
s_add_u32 s68, s68, s69
s_add_u32 s68, s68, 28672
v_lshlrev_b32 v7, 2, v1
v_add_u32 v25, s68, v7
s_lshl_b32 s68, s3, 9
s_lshl_b32 s69, s76, 7
s_add_u32 s68, s68, s69
s_add_u32 s68, s68, 32768
v_lshlrev_b32 v7, 2, v2
v_add_u32 v26, s68, v7
s_lshl_b32 s68, s3, 8
s_lshl_b32 s69, s76, 6
s_add_u32 s68, s68, s69
s_add_u32 s68, s68, 36864
v_add_u32 v27, s68, v6
s_waitcnt lgkmcnt(0)
s_add_u32 s6, s6, 1
L_s1k_4:
s_waitcnt vmcnt(16)
s_barrier
s_xor_b32 s70, s95, s92
s_add_u32 s70, s70, s3
s_and_b32 s70, s70, 7
s_lshl_b32 s70, s70, 7
s_mov_b32 m0, s93
s_nop 0
buffer_load_dwordx4 v4, s[8:11], s70 offen lds
s_add_u32 m0, m0, 1024
s_add_u32 s70, s70, 8192
buffer_load_dwordx4 v5, s[8:11], s70 offen lds
s_add_u32 m0, m0, 1024
s_add_u32 s70, s70, 8192
buffer_load_dwordx4 v4, s[8:11], s70 offen lds
s_add_u32 m0, m0, 1024
s_add_u32 s70, s70, 8192
buffer_load_dwordx4 v5, s[8:11], s70 offen lds
s_add_u32 m0, m0, 1024
s_add_u32 s70, s70, 8192
buffer_load_dwordx4 v4, s[8:11], s70 offen lds
s_add_u32 m0, m0, 1024
s_add_u32 s70, s70, 8192
buffer_load_dwordx4 v5, s[8:11], s70 offen lds
s_add_u32 m0, m0, 1024
s_add_u32 s70, s70, 8192
buffer_load_dwordx4 v4, s[8:11], s70 offen lds
s_add_u32 m0, m0, 1024
s_add_u32 s70, s70, 8192
buffer_load_dwordx4 v5, s[8:11], s70 offen lds
s_add_u32 m0, m0, 1024
s_add_u32 s70, s70, 8192
buffer_load_dwordx4 v4, s[8:11], s70 offen lds
s_add_u32 m0, m0, 1024
s_add_u32 s70, s70, 8192
buffer_load_dwordx4 v5, s[8:11], s70 offen lds
s_add_u32 m0, m0, 1024
s_add_u32 s70, s70, 8192
buffer_load_dwordx4 v4, s[8:11], s70 offen lds
s_add_u32 m0, m0, 1024
s_add_u32 s70, s70, 8192
buffer_load_dwordx4 v5, s[8:11], s70 offen lds
s_add_u32 m0, m0, 1024
s_add_u32 s70, s70, 8192
buffer_load_dwordx4 v4, s[8:11], s70 offen lds
s_add_u32 m0, m0, 1024
s_add_u32 s70, s70, 8192
buffer_load_dwordx4 v5, s[8:11], s70 offen lds
s_add_u32 m0, m0, 1024
s_add_u32 s70, s70, 8192
buffer_load_dwordx4 v4, s[8:11], s70 offen lds
s_add_u32 m0, m0, 1024
s_add_u32 s70, s70, 8192
buffer_load_dwordx4 v5, s[8:11], s70 offen lds
s_add_u32 m0, m0, 1024
s_add_u32 s70, s70, 8192
s_add_u32 s92, s92, 1
s_add_u32 s93, s93, 32768
s_cmp_eq_u32 s93, 98304
s_cselect_b32 s93, 0, s93
s_cmp_lt_u32 s92, 8
s_cbranch_scc1 L_s1k_4
s_waitcnt vmcnt(16)
s_barrier
s_waitcnt vmcnt(0)
s_barrier
v_lshlrev_b32 v28, 7, v1
s_mul_i32 s68, s3, 256
s_add_u32 s68, s68, 24576
s_mov_b64 exec, 3
buffer_load_dword v29, v28, s[40:43], s68 offen sc1
s_mul_i32 s68, s3, 512
s_add_u32 s68, s68, 28672
s_mov_b64 exec, 15
buffer_load_dword v29, v28, s[40:43], s68 offen sc1
s_mul_i32 s68, s3, 512
s_add_u32 s68, s68, 32768
s_mov_b64 exec, 15
buffer_load_dword v29, v28, s[40:43], s68 offen sc1
s_mul_i32 s68, s3, 512
s_add_u32 s68, s68, 40960
s_mov_b64 exec, 15
buffer_load_dword v29, v28, s[40:43], s68 offen sc1
s_mul_i32 s68, s3, 512
s_add_u32 s68, s68, 49152
s_mov_b64 exec, 15
buffer_load_dword v29, v28, s[40:43], s68 offen sc1
s_mul_i32 s68, s3, 256
s_add_u32 s68, s68, 36864
s_mov_b64 exec, 3
buffer_load_dword v29, v28, s[40:43], s68 offen sc1
s_mov_b64 exec, -1
s_barrier
s_barrier
s_mov_b32 s79, 0
L_poll_6:
buffer_load_dword v30, v38, s[40:43], 0 offen sc1
s_add_u32 s79, s79, 1
s_cmp_gt_u32 s79, 200000
s_waitcnt vmcnt(0)
s_cbranch_scc1 L_pdone_7
v_cmp_ne_u32 vcc, s6, v30
s_nop 0
s_cbranch_vccnz L_poll_6
L_pdone_7:
s_xor_b32 s70, s66, 0
s_lshl_b32 s70, s70, 15
s_add_u32 s70, s70, 0
s_mov_b32 m0, 0
s_nop 0
buffer_load_dwordx4 v12, s[36:39], s70 offen lds
buffer_load_dwordx4 v13, s[36:39], s70 offen offset:1024 lds
buffer_load_dwordx4 v13, s[36:39], s70 offen offset:2048 lds
buffer_load_dwordx4 v14, s[36:39], s70 offen offset:3072 lds
s_xor_b32 s70, s66, 0
s_lshl_b32 s70, s70, 15
s_add_u32 s70, s70, 16384
s_mov_b32 m0, 4096
s_nop 0
buffer_load_dwordx4 v12, s[36:39], s70 offen lds
buffer_load_dwordx4 v13, s[36:39], s70 offen offset:1024 lds
buffer_load_dwordx4 v13, s[36:39], s70 offen offset:2048 lds
buffer_load_dwordx4 v14, s[36:39], s70 offen offset:3072 lds
s_xor_b32 s70, s66, 1
s_lshl_b32 s70, s70, 15
s_add_u32 s70, s70, 0
s_mov_b32 m0, 8192
s_nop 0
buffer_load_dwordx4 v12, s[36:39], s70 offen lds
buffer_load_dwordx4 v13, s[36:39], s70 offen offset:1024 lds
buffer_load_dwordx4 v13, s[36:39], s70 offen offset:2048 lds
buffer_load_dwordx4 v14, s[36:39], s70 offen offset:3072 lds
s_xor_b32 s70, s66, 1
s_lshl_b32 s70, s70, 15
s_add_u32 s70, s70, 16384
s_mov_b32 m0, 12288
s_nop 0
buffer_load_dwordx4 v12, s[36:39], s70 offen lds
buffer_load_dwordx4 v13, s[36:39], s70 offen offset:1024 lds
buffer_load_dwordx4 v13, s[36:39], s70 offen offset:2048 lds
buffer_load_dwordx4 v14, s[36:39], s70 offen offset:3072 lds
s_xor_b32 s70, s66, 4
s_lshl_b32 s70, s70, 15
s_add_u32 s70, s70, 0
s_mov_b32 m0, 16384
s_nop 0
buffer_load_dwordx4 v15, s[36:39], s70 offen lds
buffer_load_dwordx4 v16, s[36:39], s70 offen offset:1024 lds
buffer_load_dwordx4 v16, s[36:39], s70 offen offset:2048 lds
buffer_load_dwordx4 v17, s[36:39], s70 offen offset:3072 lds
s_xor_b32 s70, s66, 4
s_lshl_b32 s70, s70, 15
s_add_u32 s70, s70, 16384
s_mov_b32 m0, 20480
s_nop 0
buffer_load_dwordx4 v15, s[36:39], s70 offen lds
buffer_load_dwordx4 v16, s[36:39], s70 offen offset:1024 lds
buffer_load_dwordx4 v16, s[36:39], s70 offen offset:2048 lds
buffer_load_dwordx4 v17, s[36:39], s70 offen offset:3072 lds
s_xor_b32 s70, s66, 5
s_lshl_b32 s70, s70, 15
s_add_u32 s70, s70, 0
s_mov_b32 m0, 24576
s_nop 0
buffer_load_dwordx4 v15, s[36:39], s70 offen lds
buffer_load_dwordx4 v16, s[36:39], s70 offen offset:1024 lds
buffer_load_dwordx4 v16, s[36:39], s70 offen offset:2048 lds
buffer_load_dwordx4 v17, s[36:39], s70 offen offset:3072 lds
s_xor_b32 s70, s66, 5
s_lshl_b32 s70, s70, 15
s_add_u32 s70, s70, 16384
s_mov_b32 m0, 28672
s_nop 0
buffer_load_dwordx4 v15, s[36:39], s70 offen lds
buffer_load_dwordx4 v16, s[36:39], s70 offen offset:1024 lds
buffer_load_dwordx4 v16, s[36:39], s70 offen offset:2048 lds
buffer_load_dwordx4 v17, s[36:39], s70 offen offset:3072 lds
buffer_load_dword v31, v24, s[40:43], 0 offen sc1
s_waitcnt vmcnt(25)
s_barrier
s_waitcnt vmcnt(0)
v_cmp_ne_u32 vcc, s6, v31
s_nop 0
s_cbranch_vccz L_pdone_9
s_mov_b32 s79, 0
L_poll_8:
buffer_load_dword v31, v24, s[40:43], 0 offen sc1
s_add_u32 s79, s79, 1
s_cmp_gt_u32 s79, 200000
s_waitcnt vmcnt(0)
s_cbranch_scc1 L_pdone_9
v_cmp_ne_u32 vcc, s6, v31
s_nop 0
s_cbranch_vccnz L_poll_8
L_pdone_9:
s_xor_b32 s70, s66, 2
s_lshl_b32 s70, s70, 15
s_add_u32 s70, s70, 0
s_mov_b32 m0, 32768
s_nop 0
buffer_load_dwordx4 v18, s[36:39], s70 offen lds
buffer_load_dwordx4 v19, s[36:39], s70 offen offset:1024 lds
buffer_load_dwordx4 v19, s[36:39], s70 offen offset:2048 lds
buffer_load_dwordx4 v20, s[36:39], s70 offen offset:3072 lds
s_xor_b32 s70, s66, 2
s_lshl_b32 s70, s70, 15
s_add_u32 s70, s70, 16384
s_mov_b32 m0, 36864
s_nop 0
buffer_load_dwordx4 v18, s[36:39], s70 offen lds
buffer_load_dwordx4 v19, s[36:39], s70 offen offset:1024 lds
buffer_load_dwordx4 v19, s[36:39], s70 offen offset:2048 lds
buffer_load_dwordx4 v20, s[36:39], s70 offen offset:3072 lds
s_xor_b32 s70, s66, 3
s_lshl_b32 s70, s70, 15
s_add_u32 s70, s70, 0
s_mov_b32 m0, 40960
s_nop 0
buffer_load_dwordx4 v18, s[36:39], s70 offen lds
buffer_load_dwordx4 v19, s[36:39], s70 offen offset:1024 lds
buffer_load_dwordx4 v19, s[36:39], s70 offen offset:2048 lds
buffer_load_dwordx4 v20, s[36:39], s70 offen offset:3072 lds
s_xor_b32 s70, s66, 3
s_lshl_b32 s70, s70, 15
s_add_u32 s70, s70, 16384
s_mov_b32 m0, 45056
s_nop 0
buffer_load_dwordx4 v18, s[36:39], s70 offen lds
buffer_load_dwordx4 v19, s[36:39], s70 offen offset:1024 lds
buffer_load_dwordx4 v19, s[36:39], s70 offen offset:2048 lds
buffer_load_dwordx4 v20, s[36:39], s70 offen offset:3072 lds
s_barrier
s_xor_b32 s70, s66, 6
s_lshl_b32 s70, s70, 15
s_add_u32 s70, s70, 0
s_mov_b32 m0, 49152
s_nop 0
buffer_load_dwordx4 v21, s[36:39], s70 offen lds
buffer_load_dwordx4 v22, s[36:39], s70 offen offset:1024 lds
buffer_load_dwordx4 v22, s[36:39], s70 offen offset:2048 lds
buffer_load_dwordx4 v23, s[36:39], s70 offen offset:3072 lds
s_xor_b32 s70, s66, 6
s_lshl_b32 s70, s70, 15
s_add_u32 s70, s70, 16384
s_mov_b32 m0, 53248
s_nop 0
buffer_load_dwordx4 v21, s[36:39], s70 offen lds
buffer_load_dwordx4 v22, s[36:39], s70 offen offset:1024 lds
buffer_load_dwordx4 v22, s[36:39], s70 offen offset:2048 lds
buffer_load_dwordx4 v23, s[36:39], s70 offen offset:3072 lds
s_xor_b32 s70, s66, 7
s_lshl_b32 s70, s70, 15
s_add_u32 s70, s70, 0
s_mov_b32 m0, 57344
s_nop 0
buffer_load_dwordx4 v21, s[36:39], s70 offen lds
buffer_load_dwordx4 v22, s[36:39], s70 offen offset:1024 lds
buffer_load_dwordx4 v22, s[36:39], s70 offen offset:2048 lds
buffer_load_dwordx4 v23, s[36:39], s70 offen offset:3072 lds
s_xor_b32 s70, s66, 7
s_lshl_b32 s70, s70, 15
s_add_u32 s70, s70, 16384
s_mov_b32 m0, 61440
s_nop 0
buffer_load_dwordx4 v21, s[36:39], s70 offen lds
buffer_load_dwordx4 v22, s[36:39], s70 offen offset:1024 lds
buffer_load_dwordx4 v22, s[36:39], s70 offen offset:2048 lds
buffer_load_dwordx4 v23, s[36:39], s70 offen offset:3072 lds
s_barrier
s_barrier
s_waitcnt vmcnt(24)
s_barrier
s_waitcnt vmcnt(16)
s_barrier
s_waitcnt vmcnt(8)
s_barrier
s_waitcnt vmcnt(0)
s_barrier
s_barrier
s_mov_b32 s79, 0
L_poll_10:
buffer_load_dword v30, v25, s[40:43], 0 offen sc1
s_add_u32 s79, s79, 1
s_cmp_gt_u32 s79, 200000
s_waitcnt vmcnt(0)
s_cbranch_scc1 L_pdone_11
v_cmp_ne_u32 vcc, s6, v30
s_nop 0
s_cbranch_vccnz L_poll_10
L_pdone_11:
s_lshl_b32 s95, s56, 2
s_add_u32 s95, s95, s3
s_add_u32 s95, s95, s78
s_and_b32 s95, s95, 7
s_add_u32 s71, s95, 0
s_and_b32 s71, s71, 7
s_lshl_b32 s71, s71, 15
s_add_u32 s71, s71, 262144
s_mov_b32 m0, 114688
s_add_u32 s70, s71, 0
buffer_load_dwordx4 v11, s[36:39], s70 offen lds
buffer_load_dwordx4 v11, s[36:39], s70 offen offset:1024 lds
buffer_load_dwordx4 v11, s[36:39], s70 offen offset:2048 lds
buffer_load_dwordx4 v11, s[36:39], s70 offen offset:3072 lds
s_mov_b32 m0, 118784
s_add_u32 s70, s71, 4096
buffer_load_dwordx4 v11, s[36:39], s70 offen lds
buffer_load_dwordx4 v11, s[36:39], s70 offen offset:1024 lds
buffer_load_dwordx4 v11, s[36:39], s70 offen offset:2048 lds
buffer_load_dwordx4 v11, s[36:39], s70 offen offset:3072 lds
s_mov_b32 m0, 122880
s_add_u32 s70, s71, 16384
buffer_load_dwordx4 v11, s[36:39], s70 offen lds
buffer_load_dwordx4 v11, s[36:39], s70 offen offset:1024 lds
buffer_load_dwordx4 v11, s[36:39], s70 offen offset:2048 lds
buffer_load_dwordx4 v11, s[36:39], s70 offen offset:3072 lds
s_mov_b32 m0, 126976
s_add_u32 s70, s71, 20480
buffer_load_dwordx4 v11, s[36:39], s70 offen lds
buffer_load_dwordx4 v11, s[36:39], s70 offen offset:1024 lds
buffer_load_dwordx4 v11, s[36:39], s70 offen offset:2048 lds
buffer_load_dwordx4 v11, s[36:39], s70 offen offset:3072 lds
s_add_u32 s71, s95, 1
s_and_b32 s71, s71, 7
s_lshl_b32 s71, s71, 15
s_add_u32 s71, s71, 262144
s_mov_b32 m0, 131072
s_add_u32 s70, s71, 0
buffer_load_dwordx4 v11, s[36:39], s70 offen lds
buffer_load_dwordx4 v11, s[36:39], s70 offen offset:1024 lds
buffer_load_dwordx4 v11, s[36:39], s70 offen offset:2048 lds
buffer_load_dwordx4 v11, s[36:39], s70 offen offset:3072 lds
s_mov_b32 m0, 135168
s_add_u32 s70, s71, 4096
buffer_load_dwordx4 v11, s[36:39], s70 offen lds
buffer_load_dwordx4 v11, s[36:39], s70 offen offset:1024 lds
buffer_load_dwordx4 v11, s[36:39], s70 offen offset:2048 lds
buffer_load_dwordx4 v11, s[36:39], s70 offen offset:3072 lds
s_mov_b32 m0, 139264
s_add_u32 s70, s71, 16384
buffer_load_dwordx4 v11, s[36:39], s70 offen lds
buffer_load_dwordx4 v11, s[36:39], s70 offen offset:1024 lds
buffer_load_dwordx4 v11, s[36:39], s70 offen offset:2048 lds
buffer_load_dwordx4 v11, s[36:39], s70 offen offset:3072 lds
s_mov_b32 m0, 143360
s_add_u32 s70, s71, 20480
buffer_load_dwordx4 v11, s[36:39], s70 offen lds
buffer_load_dwordx4 v11, s[36:39], s70 offen offset:1024 lds
buffer_load_dwordx4 v11, s[36:39], s70 offen offset:2048 lds
buffer_load_dwordx4 v11, s[36:39], s70 offen offset:3072 lds
s_barrier
s_waitcnt vmcnt(16)
s_barrier
s_add_u32 s71, s95, 2
s_and_b32 s71, s71, 7
s_lshl_b32 s71, s71, 15
s_add_u32 s71, s71, 262144
s_mov_b32 m0, 147456
s_add_u32 s70, s71, 0
buffer_load_dwordx4 v11, s[36:39], s70 offen lds
buffer_load_dwordx4 v11, s[36:39], s70 offen offset:1024 lds
buffer_load_dwordx4 v11, s[36:39], s70 offen offset:2048 lds
buffer_load_dwordx4 v11, s[36:39], s70 offen offset:3072 lds
s_mov_b32 m0, 151552
s_add_u32 s70, s71, 4096
buffer_load_dwordx4 v11, s[36:39], s70 offen lds
buffer_load_dwordx4 v11, s[36:39], s70 offen offset:1024 lds
buffer_load_dwordx4 v11, s[36:39], s70 offen offset:2048 lds
buffer_load_dwordx4 v11, s[36:39], s70 offen offset:3072 lds
s_mov_b32 m0, 155648
s_add_u32 s70, s71, 16384
buffer_load_dwordx4 v11, s[36:39], s70 offen lds
buffer_load_dwordx4 v11, s[36:39], s70 offen offset:1024 lds
buffer_load_dwordx4 v11, s[36:39], s70 offen offset:2048 lds
buffer_load_dwordx4 v11, s[36:39], s70 offen offset:3072 lds
s_mov_b32 m0, 159744
s_add_u32 s70, s71, 20480
buffer_load_dwordx4 v11, s[36:39], s70 offen lds
buffer_load_dwordx4 v11, s[36:39], s70 offen offset:1024 lds
buffer_load_dwordx4 v11, s[36:39], s70 offen offset:2048 lds
buffer_load_dwordx4 v11, s[36:39], s70 offen offset:3072 lds
s_waitcnt vmcnt(16)
s_barrier
s_add_u32 s71, s95, 3
s_and_b32 s71, s71, 7
s_lshl_b32 s71, s71, 15
s_add_u32 s71, s71, 262144
s_mov_b32 m0, 114688
s_add_u32 s70, s71, 0
buffer_load_dwordx4 v11, s[36:39], s70 offen lds
buffer_load_dwordx4 v11, s[36:39], s70 offen offset:1024 lds
buffer_load_dwordx4 v11, s[36:39], s70 offen offset:2048 lds
buffer_load_dwordx4 v11, s[36:39], s70 offen offset:3072 lds
s_mov_b32 m0, 118784
s_add_u32 s70, s71, 4096
buffer_load_dwordx4 v11, s[36:39], s70 offen lds
buffer_load_dwordx4 v11, s[36:39], s70 offen offset:1024 lds
buffer_load_dwordx4 v11, s[36:39], s70 offen offset:2048 lds
buffer_load_dwordx4 v11, s[36:39], s70 offen offset:3072 lds
s_mov_b32 m0, 122880
s_add_u32 s70, s71, 16384
buffer_load_dwordx4 v11, s[36:39], s70 offen lds
buffer_load_dwordx4 v11, s[36:39], s70 offen offset:1024 lds
buffer_load_dwordx4 v11, s[36:39], s70 offen offset:2048 lds
buffer_load_dwordx4 v11, s[36:39], s70 offen offset:3072 lds
s_mov_b32 m0, 126976
s_add_u32 s70, s71, 20480
buffer_load_dwordx4 v11, s[36:39], s70 offen lds
buffer_load_dwordx4 v11, s[36:39], s70 offen offset:1024 lds
buffer_load_dwordx4 v11, s[36:39], s70 offen offset:2048 lds
buffer_load_dwordx4 v11, s[36:39], s70 offen offset:3072 lds
s_waitcnt vmcnt(16)
s_barrier
s_add_u32 s71, s95, 4
s_and_b32 s71, s71, 7
s_lshl_b32 s71, s71, 15
s_add_u32 s71, s71, 262144
s_mov_b32 m0, 131072
s_add_u32 s70, s71, 0
buffer_load_dwordx4 v11, s[36:39], s70 offen lds
buffer_load_dwordx4 v11, s[36:39], s70 offen offset:1024 lds
buffer_load_dwordx4 v11, s[36:39], s70 offen offset:2048 lds
buffer_load_dwordx4 v11, s[36:39], s70 offen offset:3072 lds
s_mov_b32 m0, 135168
s_add_u32 s70, s71, 4096
buffer_load_dwordx4 v11, s[36:39], s70 offen lds
buffer_load_dwordx4 v11, s[36:39], s70 offen offset:1024 lds
buffer_load_dwordx4 v11, s[36:39], s70 offen offset:2048 lds
buffer_load_dwordx4 v11, s[36:39], s70 offen offset:3072 lds
s_mov_b32 m0, 139264
s_add_u32 s70, s71, 16384
buffer_load_dwordx4 v11, s[36:39], s70 offen lds
buffer_load_dwordx4 v11, s[36:39], s70 offen offset:1024 lds
buffer_load_dwordx4 v11, s[36:39], s70 offen offset:2048 lds
buffer_load_dwordx4 v11, s[36:39], s70 offen offset:3072 lds
s_mov_b32 m0, 143360
s_add_u32 s70, s71, 20480
buffer_load_dwordx4 v11, s[36:39], s70 offen lds
buffer_load_dwordx4 v11, s[36:39], s70 offen offset:1024 lds
buffer_load_dwordx4 v11, s[36:39], s70 offen offset:2048 lds
buffer_load_dwordx4 v11, s[36:39], s70 offen offset:3072 lds
s_waitcnt vmcnt(16)
s_barrier
s_add_u32 s71, s95, 5
s_and_b32 s71, s71, 7
s_lshl_b32 s71, s71, 15
s_add_u32 s71, s71, 262144
s_mov_b32 m0, 147456
s_add_u32 s70, s71, 0
buffer_load_dwordx4 v11, s[36:39], s70 offen lds
buffer_load_dwordx4 v11, s[36:39], s70 offen offset:1024 lds
buffer_load_dwordx4 v11, s[36:39], s70 offen offset:2048 lds
buffer_load_dwordx4 v11, s[36:39], s70 offen offset:3072 lds
s_mov_b32 m0, 151552
s_add_u32 s70, s71, 4096
buffer_load_dwordx4 v11, s[36:39], s70 offen lds
buffer_load_dwordx4 v11, s[36:39], s70 offen offset:1024 lds
buffer_load_dwordx4 v11, s[36:39], s70 offen offset:2048 lds
buffer_load_dwordx4 v11, s[36:39], s70 offen offset:3072 lds
s_mov_b32 m0, 155648
s_add_u32 s70, s71, 16384
buffer_load_dwordx4 v11, s[36:39], s70 offen lds
buffer_load_dwordx4 v11, s[36:39], s70 offen offset:1024 lds
buffer_load_dwordx4 v11, s[36:39], s70 offen offset:2048 lds
buffer_load_dwordx4 v11, s[36:39], s70 offen offset:3072 lds
s_mov_b32 m0, 159744
s_add_u32 s70, s71, 20480
buffer_load_dwordx4 v11, s[36:39], s70 offen lds
buffer_load_dwordx4 v11, s[36:39], s70 offen offset:1024 lds
buffer_load_dwordx4 v11, s[36:39], s70 offen offset:2048 lds
buffer_load_dwordx4 v11, s[36:39], s70 offen offset:3072 lds
s_waitcnt vmcnt(16)
s_barrier
s_add_u32 s71, s95, 6
s_and_b32 s71, s71, 7
s_lshl_b32 s71, s71, 15
s_add_u32 s71, s71, 262144
s_mov_b32 m0, 114688
s_add_u32 s70, s71, 0
buffer_load_dwordx4 v11, s[36:39], s70 offen lds
buffer_load_dwordx4 v11, s[36:39], s70 offen offset:1024 lds
buffer_load_dwordx4 v11, s[36:39], s70 offen offset:2048 lds
buffer_load_dwordx4 v11, s[36:39], s70 offen offset:3072 lds
s_mov_b32 m0, 118784
s_add_u32 s70, s71, 4096
buffer_load_dwordx4 v11, s[36:39], s70 offen lds
buffer_load_dwordx4 v11, s[36:39], s70 offen offset:1024 lds
buffer_load_dwordx4 v11, s[36:39], s70 offen offset:2048 lds
buffer_load_dwordx4 v11, s[36:39], s70 offen offset:3072 lds
s_mov_b32 m0, 122880
s_add_u32 s70, s71, 16384
buffer_load_dwordx4 v11, s[36:39], s70 offen lds
buffer_load_dwordx4 v11, s[36:39], s70 offen offset:1024 lds
buffer_load_dwordx4 v11, s[36:39], s70 offen offset:2048 lds
buffer_load_dwordx4 v11, s[36:39], s70 offen offset:3072 lds
s_mov_b32 m0, 126976
s_add_u32 s70, s71, 20480
buffer_load_dwordx4 v11, s[36:39], s70 offen lds
buffer_load_dwordx4 v11, s[36:39], s70 offen offset:1024 lds
buffer_load_dwordx4 v11, s[36:39], s70 offen offset:2048 lds
buffer_load_dwordx4 v11, s[36:39], s70 offen offset:3072 lds
s_waitcnt vmcnt(16)
s_barrier
s_add_u32 s71, s95, 7
s_and_b32 s71, s71, 7
s_lshl_b32 s71, s71, 15
s_add_u32 s71, s71, 262144
s_mov_b32 m0, 131072
s_add_u32 s70, s71, 0
buffer_load_dwordx4 v11, s[36:39], s70 offen lds
buffer_load_dwordx4 v11, s[36:39], s70 offen offset:1024 lds
buffer_load_dwordx4 v11, s[36:39], s70 offen offset:2048 lds
buffer_load_dwordx4 v11, s[36:39], s70 offen offset:3072 lds
s_mov_b32 m0, 135168
s_add_u32 s70, s71, 4096
buffer_load_dwordx4 v11, s[36:39], s70 offen lds
buffer_load_dwordx4 v11, s[36:39], s70 offen offset:1024 lds
buffer_load_dwordx4 v11, s[36:39], s70 offen offset:2048 lds
buffer_load_dwordx4 v11, s[36:39], s70 offen offset:3072 lds
s_mov_b32 m0, 139264
s_add_u32 s70, s71, 16384
buffer_load_dwordx4 v11, s[36:39], s70 offen lds
buffer_load_dwordx4 v11, s[36:39], s70 offen offset:1024 lds
buffer_load_dwordx4 v11, s[36:39], s70 offen offset:2048 lds
buffer_load_dwordx4 v11, s[36:39], s70 offen offset:3072 lds
s_mov_b32 m0, 143360
s_add_u32 s70, s71, 20480
buffer_load_dwordx4 v11, s[36:39], s70 offen lds
buffer_load_dwordx4 v11, s[36:39], s70 offen offset:1024 lds
buffer_load_dwordx4 v11, s[36:39], s70 offen offset:2048 lds
buffer_load_dwordx4 v11, s[36:39], s70 offen offset:3072 lds
s_waitcnt vmcnt(16)
s_barrier
s_waitcnt vmcnt(0)
s_barrier
s_barrier
s_mov_b32 s79, 0
L_poll_12:
buffer_load_dword v30, v26, s[40:43], 0 offen sc1
s_add_u32 s79, s79, 1
s_cmp_gt_u32 s79, 200000
s_waitcnt vmcnt(0)
s_cbranch_scc1 L_pdone_13
v_cmp_ne_u32 vcc, s6, v30
s_nop 0
s_cbranch_vccnz L_poll_12
L_pdone_13:
s_lshl_b32 s94, s76, 1
s_add_u32 s94, s94, s3
s_add_u32 s94, s94, s77
s_mov_b32 s95, s94
s_sub_u32 s70, s95, 5
s_cmp_ge_u32 s95, 5
s_cselect_b32 s95, s70, s95
s_sub_u32 s70, s95, 5
s_cmp_ge_u32 s95, 5
s_cselect_b32 s95, s70, s95
s_sub_u32 s70, s95, 5
s_cmp_ge_u32 s95, 5
s_cselect_b32 s95, s70, s95
s_sub_u32 s70, s95, 5
s_cmp_ge_u32 s95, 5
s_cselect_b32 s95, s70, s95
v_add_u32 v32, 8192, v26
v_and_b32 v34, 15, v1
v_lshlrev_b32 v35, 2, v34
v_add_u32 v33, 16384, v26
v_sub_u32 v35, v33, v35
v_cmp_lt_u32 vcc, 10, v34
s_nop 1
v_cndmask_b32 v33, v33, v35, vcc
s_add_u32 s72, s94, 0
s_and_b32 s72, s72, 7
s_lshl_b32 s72, s72, 1
s_mul_i32 s68, s72, 3
s_add_u32 s68, s68, 0
s_lshl_b32 s71, s72, 1
s_add_u32 s71, s71, 11
s_cmp_lt_u32 s72, 11
s_cselect_b32 s68, s68, s71
s_add_u32 s72, s72, 1
s_mul_i32 s69, s72, 3
s_add_u32 s69, s69, 0
s_lshl_b32 s71, s72, 1
s_add_u32 s71, s71, 11
s_cmp_lt_u32 s72, 11
s_cselect_b32 s69, s69, s71
s_lshl_b32 s70, s68, 14
s_add_u32 s70, s70, 786432
s_mov_b32 m0, 98304
s_nop 0
buffer_load_dwordx4 v10, s[36:39], s70 offen lds
buffer_load_dwordx4 v10, s[36:39], s70 offen offset:1024 lds
buffer_load_dwordx4 v10, s[36:39], s70 offen offset:2048 lds
buffer_load_dwordx4 v10, s[36:39], s70 offen offset:3072 lds
s_lshl_b32 s70, s69, 14
s_add_u32 s70, s70, 786432
s_mov_b32 m0, 102400
s_nop 0
buffer_load_dwordx4 v10, s[36:39], s70 offen lds
buffer_load_dwordx4 v10, s[36:39], s70 offen offset:1024 lds
buffer_load_dwordx4 v10, s[36:39], s70 offen offset:2048 lds
buffer_load_dwordx4 v10, s[36:39], s70 offen offset:3072 lds
s_add_u32 s72, s94, 1
s_and_b32 s72, s72, 7
s_lshl_b32 s72, s72, 1
s_mul_i32 s68, s72, 3
s_add_u32 s68, s68, 0
s_lshl_b32 s71, s72, 1
s_add_u32 s71, s71, 11
s_cmp_lt_u32 s72, 11
s_cselect_b32 s68, s68, s71
s_add_u32 s72, s72, 1
s_mul_i32 s69, s72, 3
s_add_u32 s69, s69, 0
s_lshl_b32 s71, s72, 1
s_add_u32 s71, s71, 11
s_cmp_lt_u32 s72, 11
s_cselect_b32 s69, s69, s71
s_lshl_b32 s70, s68, 14
s_add_u32 s70, s70, 786432
s_mov_b32 m0, 106496
s_nop 0
buffer_load_dwordx4 v10, s[36:39], s70 offen lds
buffer_load_dwordx4 v10, s[36:39], s70 offen offset:1024 lds
buffer_load_dwordx4 v10, s[36:39], s70 offen offset:2048 lds
buffer_load_dwordx4 v10, s[36:39], s70 offen offset:3072 lds
s_lshl_b32 s70, s69, 14
s_add_u32 s70, s70, 786432
s_mov_b32 m0, 110592
s_nop 0
buffer_load_dwordx4 v10, s[36:39], s70 offen lds
buffer_load_dwordx4 v10, s[36:39], s70 offen offset:1024 lds
buffer_load_dwordx4 v10, s[36:39], s70 offen offset:2048 lds
buffer_load_dwordx4 v10, s[36:39], s70 offen offset:3072 lds
s_add_u32 s72, s94, 2
s_and_b32 s72, s72, 7
s_lshl_b32 s72, s72, 1
s_mul_i32 s68, s72, 3
s_add_u32 s68, s68, 0
s_lshl_b32 s71, s72, 1
s_add_u32 s71, s71, 11
s_cmp_lt_u32 s72, 11
s_cselect_b32 s68, s68, s71
s_add_u32 s72, s72, 1
s_mul_i32 s69, s72, 3
s_add_u32 s69, s69, 0
s_lshl_b32 s71, s72, 1
s_add_u32 s71, s71, 11
s_cmp_lt_u32 s72, 11
s_cselect_b32 s69, s69, s71
s_lshl_b32 s70, s68, 14
s_add_u32 s70, s70, 786432
s_mov_b32 m0, 114688
s_nop 0
buffer_load_dwordx4 v10, s[36:39], s70 offen lds
buffer_load_dwordx4 v10, s[36:39], s70 offen offset:1024 lds
buffer_load_dwordx4 v10, s[36:39], s70 offen offset:2048 lds
buffer_load_dwordx4 v10, s[36:39], s70 offen offset:3072 lds
s_lshl_b32 s70, s69, 14
s_add_u32 s70, s70, 786432
s_mov_b32 m0, 118784
s_nop 0
buffer_load_dwordx4 v10, s[36:39], s70 offen lds
buffer_load_dwordx4 v10, s[36:39], s70 offen offset:1024 lds
buffer_load_dwordx4 v10, s[36:39], s70 offen offset:2048 lds
buffer_load_dwordx4 v10, s[36:39], s70 offen offset:3072 lds
s_add_u32 s72, s94, 3
s_and_b32 s72, s72, 7
s_lshl_b32 s72, s72, 1
s_mul_i32 s68, s72, 3
s_add_u32 s68, s68, 0
s_lshl_b32 s71, s72, 1
s_add_u32 s71, s71, 11
s_cmp_lt_u32 s72, 11
s_cselect_b32 s68, s68, s71
s_add_u32 s72, s72, 1
s_mul_i32 s69, s72, 3
s_add_u32 s69, s69, 0
s_lshl_b32 s71, s72, 1
s_add_u32 s71, s71, 11
s_cmp_lt_u32 s72, 11
s_cselect_b32 s69, s69, s71
s_lshl_b32 s70, s68, 14
s_add_u32 s70, s70, 786432
s_mov_b32 m0, 122880
s_nop 0
buffer_load_dwordx4 v10, s[36:39], s70 offen lds
buffer_load_dwordx4 v10, s[36:39], s70 offen offset:1024 lds
buffer_load_dwordx4 v10, s[36:39], s70 offen offset:2048 lds
buffer_load_dwordx4 v10, s[36:39], s70 offen offset:3072 lds
s_lshl_b32 s70, s69, 14
s_add_u32 s70, s70, 786432
s_mov_b32 m0, 126976
s_nop 0
buffer_load_dwordx4 v10, s[36:39], s70 offen lds
buffer_load_dwordx4 v10, s[36:39], s70 offen offset:1024 lds
buffer_load_dwordx4 v10, s[36:39], s70 offen offset:2048 lds
buffer_load_dwordx4 v10, s[36:39], s70 offen offset:3072 lds
buffer_load_dword v36, v32, s[40:43], 0 offen sc1
s_waitcnt vmcnt(25)
s_barrier
s_add_u32 s72, s94, 4
s_and_b32 s72, s72, 7
s_lshl_b32 s72, s72, 1
s_mul_i32 s68, s72, 3
s_add_u32 s68, s68, 0
s_lshl_b32 s71, s72, 1
s_add_u32 s71, s71, 11
s_cmp_lt_u32 s72, 11
s_cselect_b32 s68, s68, s71
s_add_u32 s72, s72, 1
s_mul_i32 s69, s72, 3
s_add_u32 s69, s69, 0
s_lshl_b32 s71, s72, 1
s_add_u32 s71, s71, 11
s_cmp_lt_u32 s72, 11
s_cselect_b32 s69, s69, s71
s_lshl_b32 s70, s68, 14
s_add_u32 s70, s70, 786432
s_mov_b32 m0, 131072
s_nop 0
buffer_load_dwordx4 v10, s[36:39], s70 offen lds
buffer_load_dwordx4 v10, s[36:39], s70 offen offset:1024 lds
buffer_load_dwordx4 v10, s[36:39], s70 offen offset:2048 lds
buffer_load_dwordx4 v10, s[36:39], s70 offen offset:3072 lds
s_lshl_b32 s70, s69, 14
s_add_u32 s70, s70, 786432
s_mov_b32 m0, 135168
s_nop 0
buffer_load_dwordx4 v10, s[36:39], s70 offen lds
buffer_load_dwordx4 v10, s[36:39], s70 offen offset:1024 lds
buffer_load_dwordx4 v10, s[36:39], s70 offen offset:2048 lds
buffer_load_dwordx4 v10, s[36:39], s70 offen offset:3072 lds
s_add_u32 s72, s94, 5
s_and_b32 s72, s72, 7
s_lshl_b32 s72, s72, 1
s_mul_i32 s68, s72, 3
s_add_u32 s68, s68, 0
s_lshl_b32 s71, s72, 1
s_add_u32 s71, s71, 11
s_cmp_lt_u32 s72, 11
s_cselect_b32 s68, s68, s71
s_add_u32 s72, s72, 1
s_mul_i32 s69, s72, 3
s_add_u32 s69, s69, 0
s_lshl_b32 s71, s72, 1
s_add_u32 s71, s71, 11
s_cmp_lt_u32 s72, 11
s_cselect_b32 s69, s69, s71
s_lshl_b32 s70, s68, 14
s_add_u32 s70, s70, 786432
s_mov_b32 m0, 139264
s_nop 0
buffer_load_dwordx4 v10, s[36:39], s70 offen lds
buffer_load_dwordx4 v10, s[36:39], s70 offen offset:1024 lds
buffer_load_dwordx4 v10, s[36:39], s70 offen offset:2048 lds
buffer_load_dwordx4 v10, s[36:39], s70 offen offset:3072 lds
s_lshl_b32 s70, s69, 14
s_add_u32 s70, s70, 786432
s_mov_b32 m0, 143360
s_nop 0
buffer_load_dwordx4 v10, s[36:39], s70 offen lds
buffer_load_dwordx4 v10, s[36:39], s70 offen offset:1024 lds
buffer_load_dwordx4 v10, s[36:39], s70 offen offset:2048 lds
buffer_load_dwordx4 v10, s[36:39], s70 offen offset:3072 lds
s_waitcnt vmcnt(33)
s_barrier
s_add_u32 s72, s94, 6
s_and_b32 s72, s72, 7
s_lshl_b32 s72, s72, 1
s_mul_i32 s68, s72, 3
s_add_u32 s68, s68, 0
s_lshl_b32 s71, s72, 1
s_add_u32 s71, s71, 11
s_cmp_lt_u32 s72, 11
s_cselect_b32 s68, s68, s71
s_add_u32 s72, s72, 1
s_mul_i32 s69, s72, 3
s_add_u32 s69, s69, 0
s_lshl_b32 s71, s72, 1
s_add_u32 s71, s71, 11
s_cmp_lt_u32 s72, 11
s_cselect_b32 s69, s69, s71
s_lshl_b32 s70, s68, 14
s_add_u32 s70, s70, 786432
s_mov_b32 m0, 147456
s_nop 0
buffer_load_dwordx4 v10, s[36:39], s70 offen lds
buffer_load_dwordx4 v10, s[36:39], s70 offen offset:1024 lds
buffer_load_dwordx4 v10, s[36:39], s70 offen offset:2048 lds
buffer_load_dwordx4 v10, s[36:39], s70 offen offset:3072 lds
s_lshl_b32 s70, s69, 14
s_add_u32 s70, s70, 786432
s_mov_b32 m0, 151552
s_nop 0
buffer_load_dwordx4 v10, s[36:39], s70 offen lds
buffer_load_dwordx4 v10, s[36:39], s70 offen offset:1024 lds
buffer_load_dwordx4 v10, s[36:39], s70 offen offset:2048 lds
buffer_load_dwordx4 v10, s[36:39], s70 offen offset:3072 lds
s_waitcnt vmcnt(33)
s_barrier
s_add_u32 s72, s94, 7
s_and_b32 s72, s72, 7
s_lshl_b32 s72, s72, 1
s_mul_i32 s68, s72, 3
s_add_u32 s68, s68, 0
s_lshl_b32 s71, s72, 1
s_add_u32 s71, s71, 11
s_cmp_lt_u32 s72, 11
s_cselect_b32 s68, s68, s71
s_add_u32 s72, s72, 1
s_mul_i32 s69, s72, 3
s_add_u32 s69, s69, 0
s_lshl_b32 s71, s72, 1
s_add_u32 s71, s71, 11
s_cmp_lt_u32 s72, 11
s_cselect_b32 s69, s69, s71
s_lshl_b32 s70, s68, 14
s_add_u32 s70, s70, 786432
s_mov_b32 m0, 155648
s_nop 0
buffer_load_dwordx4 v10, s[36:39], s70 offen lds
buffer_load_dwordx4 v10, s[36:39], s70 offen offset:1024 lds
buffer_load_dwordx4 v10, s[36:39], s70 offen offset:2048 lds
buffer_load_dwordx4 v10, s[36:39], s70 offen offset:3072 lds
s_lshl_b32 s70, s69, 14
s_add_u32 s70, s70, 786432
s_mov_b32 m0, 159744
s_nop 0
buffer_load_dwordx4 v10, s[36:39], s70 offen lds
buffer_load_dwordx4 v10, s[36:39], s70 offen offset:1024 lds
buffer_load_dwordx4 v10, s[36:39], s70 offen offset:2048 lds
buffer_load_dwordx4 v10, s[36:39], s70 offen offset:3072 lds
s_waitcnt vmcnt(33)
s_barrier
buffer_load_dword v37, v33, s[40:43], 0 offen sc1
s_waitcnt vmcnt(33)
v_cmp_ne_u32 vcc, s6, v36
s_nop 0
s_cbranch_vccz L_pdone_15
s_mov_b32 s79, 0
L_poll_14:
buffer_load_dword v36, v32, s[40:43], 0 offen sc1
s_add_u32 s79, s79, 1
s_cmp_gt_u32 s79, 200000
s_waitcnt vmcnt(0)
s_cbranch_scc1 L_pdone_15
v_cmp_ne_u32 vcc, s6, v36
s_nop 0
s_cbranch_vccnz L_poll_14
L_pdone_15:
s_add_u32 s72, s94, 0
s_and_b32 s72, s72, 7
s_lshl_b32 s72, s72, 1
s_mul_i32 s68, s72, 3
s_add_u32 s68, s68, 1
s_lshl_b32 s71, s72, 1
s_add_u32 s71, s71, 12
s_cmp_lt_u32 s72, 11
s_cselect_b32 s68, s68, s71
s_add_u32 s72, s72, 1
s_mul_i32 s69, s72, 3
s_add_u32 s69, s69, 1
s_lshl_b32 s71, s72, 1
s_add_u32 s71, s71, 12
s_cmp_lt_u32 s72, 11
s_cselect_b32 s69, s69, s71
s_lshl_b32 s70, s68, 14
s_add_u32 s70, s70, 786432
s_mov_b32 m0, 98304
s_nop 0
buffer_load_dwordx4 v10, s[36:39], s70 offen lds
buffer_load_dwordx4 v10, s[36:39], s70 offen offset:1024 lds
buffer_load_dwordx4 v10, s[36:39], s70 offen offset:2048 lds
buffer_load_dwordx4 v10, s[36:39], s70 offen offset:3072 lds
s_lshl_b32 s70, s69, 14
s_add_u32 s70, s70, 786432
s_mov_b32 m0, 102400
s_nop 0
buffer_load_dwordx4 v10, s[36:39], s70 offen lds
buffer_load_dwordx4 v10, s[36:39], s70 offen offset:1024 lds
buffer_load_dwordx4 v10, s[36:39], s70 offen offset:2048 lds
buffer_load_dwordx4 v10, s[36:39], s70 offen offset:3072 lds
s_waitcnt vmcnt(33)
s_barrier
s_add_u32 s72, s94, 1
s_and_b32 s72, s72, 7
s_lshl_b32 s72, s72, 1
s_mul_i32 s68, s72, 3
s_add_u32 s68, s68, 1
s_lshl_b32 s71, s72, 1
s_add_u32 s71, s71, 12
s_cmp_lt_u32 s72, 11
s_cselect_b32 s68, s68, s71
s_add_u32 s72, s72, 1
s_mul_i32 s69, s72, 3
s_add_u32 s69, s69, 1
s_lshl_b32 s71, s72, 1
s_add_u32 s71, s71, 12
s_cmp_lt_u32 s72, 11
s_cselect_b32 s69, s69, s71
s_lshl_b32 s70, s68, 14
s_add_u32 s70, s70, 786432
s_mov_b32 m0, 106496
s_nop 0
buffer_load_dwordx4 v10, s[36:39], s70 offen lds
buffer_load_dwordx4 v10, s[36:39], s70 offen offset:1024 lds
buffer_load_dwordx4 v10, s[36:39], s70 offen offset:2048 lds
buffer_load_dwordx4 v10, s[36:39], s70 offen offset:3072 lds
s_lshl_b32 s70, s69, 14
s_add_u32 s70, s70, 786432
s_mov_b32 m0, 110592
s_nop 0
buffer_load_dwordx4 v10, s[36:39], s70 offen lds
buffer_load_dwordx4 v10, s[36:39], s70 offen offset:1024 lds
buffer_load_dwordx4 v10, s[36:39], s70 offen offset:2048 lds
buffer_load_dwordx4 v10, s[36:39], s70 offen offset:3072 lds
s_waitcnt vmcnt(33)
s_barrier
s_add_u32 s72, s94, 2
s_and_b32 s72, s72, 7
s_lshl_b32 s72, s72, 1
s_mul_i32 s68, s72, 3
s_add_u32 s68, s68, 1
s_lshl_b32 s71, s72, 1
s_add_u32 s71, s71, 12
s_cmp_lt_u32 s72, 11
s_cselect_b32 s68, s68, s71
s_add_u32 s72, s72, 1
s_mul_i32 s69, s72, 3
s_add_u32 s69, s69, 1
s_lshl_b32 s71, s72, 1
s_add_u32 s71, s71, 12
s_cmp_lt_u32 s72, 11
s_cselect_b32 s69, s69, s71
s_lshl_b32 s70, s68, 14
s_add_u32 s70, s70, 786432
s_mov_b32 m0, 114688
s_nop 0
buffer_load_dwordx4 v10, s[36:39], s70 offen lds
buffer_load_dwordx4 v10, s[36:39], s70 offen offset:1024 lds
buffer_load_dwordx4 v10, s[36:39], s70 offen offset:2048 lds
buffer_load_dwordx4 v10, s[36:39], s70 offen offset:3072 lds
s_lshl_b32 s70, s69, 14
s_add_u32 s70, s70, 786432
s_mov_b32 m0, 118784
s_nop 0
buffer_load_dwordx4 v10, s[36:39], s70 offen lds
buffer_load_dwordx4 v10, s[36:39], s70 offen offset:1024 lds
buffer_load_dwordx4 v10, s[36:39], s70 offen offset:2048 lds
buffer_load_dwordx4 v10, s[36:39], s70 offen offset:3072 lds
s_waitcnt vmcnt(33)
s_barrier
s_add_u32 s72, s94, 3
s_and_b32 s72, s72, 7
s_lshl_b32 s72, s72, 1
s_mul_i32 s68, s72, 3
s_add_u32 s68, s68, 1
s_lshl_b32 s71, s72, 1
s_add_u32 s71, s71, 12
s_cmp_lt_u32 s72, 11
s_cselect_b32 s68, s68, s71
s_add_u32 s72, s72, 1
s_mul_i32 s69, s72, 3
s_add_u32 s69, s69, 1
s_lshl_b32 s71, s72, 1
s_add_u32 s71, s71, 12
s_cmp_lt_u32 s72, 11
s_cselect_b32 s69, s69, s71
s_lshl_b32 s70, s68, 14
s_add_u32 s70, s70, 786432
s_mov_b32 m0, 122880
s_nop 0
buffer_load_dwordx4 v10, s[36:39], s70 offen lds
buffer_load_dwordx4 v10, s[36:39], s70 offen offset:1024 lds
buffer_load_dwordx4 v10, s[36:39], s70 offen offset:2048 lds
buffer_load_dwordx4 v10, s[36:39], s70 offen offset:3072 lds
s_lshl_b32 s70, s69, 14
s_add_u32 s70, s70, 786432
s_mov_b32 m0, 126976
s_nop 0
buffer_load_dwordx4 v10, s[36:39], s70 offen lds
buffer_load_dwordx4 v10, s[36:39], s70 offen offset:1024 lds
buffer_load_dwordx4 v10, s[36:39], s70 offen offset:2048 lds
buffer_load_dwordx4 v10, s[36:39], s70 offen offset:3072 lds
s_waitcnt vmcnt(33)
s_barrier
s_add_u32 s72, s94, 4
s_and_b32 s72, s72, 7
s_lshl_b32 s72, s72, 1
s_mul_i32 s68, s72, 3
s_add_u32 s68, s68, 1
s_lshl_b32 s71, s72, 1
s_add_u32 s71, s71, 12
s_cmp_lt_u32 s72, 11
s_cselect_b32 s68, s68, s71
s_add_u32 s72, s72, 1
s_mul_i32 s69, s72, 3
s_add_u32 s69, s69, 1
s_lshl_b32 s71, s72, 1
s_add_u32 s71, s71, 12
s_cmp_lt_u32 s72, 11
s_cselect_b32 s69, s69, s71
s_lshl_b32 s70, s68, 14
s_add_u32 s70, s70, 786432
s_mov_b32 m0, 131072
s_nop 0
buffer_load_dwordx4 v10, s[36:39], s70 offen lds
buffer_load_dwordx4 v10, s[36:39], s70 offen offset:1024 lds
buffer_load_dwordx4 v10, s[36:39], s70 offen offset:2048 lds
buffer_load_dwordx4 v10, s[36:39], s70 offen offset:3072 lds
s_lshl_b32 s70, s69, 14
s_add_u32 s70, s70, 786432
s_mov_b32 m0, 135168
s_nop 0
buffer_load_dwordx4 v10, s[36:39], s70 offen lds
buffer_load_dwordx4 v10, s[36:39], s70 offen offset:1024 lds
buffer_load_dwordx4 v10, s[36:39], s70 offen offset:2048 lds
buffer_load_dwordx4 v10, s[36:39], s70 offen offset:3072 lds
s_waitcnt vmcnt(32)
s_barrier
s_add_u32 s72, s94, 5
s_and_b32 s72, s72, 7
s_lshl_b32 s72, s72, 1
s_mul_i32 s68, s72, 3
s_add_u32 s68, s68, 1
s_lshl_b32 s71, s72, 1
s_add_u32 s71, s71, 12
s_cmp_lt_u32 s72, 11
s_cselect_b32 s68, s68, s71
s_add_u32 s72, s72, 1
s_mul_i32 s69, s72, 3
s_add_u32 s69, s69, 1
s_lshl_b32 s71, s72, 1
s_add_u32 s71, s71, 12
s_cmp_lt_u32 s72, 11
s_cselect_b32 s69, s69, s71
s_lshl_b32 s70, s68, 14
s_add_u32 s70, s70, 786432
s_mov_b32 m0, 139264
s_nop 0
buffer_load_dwordx4 v10, s[36:39], s70 offen lds
buffer_load_dwordx4 v10, s[36:39], s70 offen offset:1024 lds
buffer_load_dwordx4 v10, s[36:39], s70 offen offset:2048 lds
buffer_load_dwordx4 v10, s[36:39], s70 offen offset:3072 lds
s_lshl_b32 s70, s69, 14
s_add_u32 s70, s70, 786432
s_mov_b32 m0, 143360
s_nop 0
buffer_load_dwordx4 v10, s[36:39], s70 offen lds
buffer_load_dwordx4 v10, s[36:39], s70 offen offset:1024 lds
buffer_load_dwordx4 v10, s[36:39], s70 offen offset:2048 lds
buffer_load_dwordx4 v10, s[36:39], s70 offen offset:3072 lds
s_waitcnt vmcnt(32)
s_barrier
s_add_u32 s72, s94, 6
s_and_b32 s72, s72, 7
s_lshl_b32 s72, s72, 1
s_mul_i32 s68, s72, 3
s_add_u32 s68, s68, 1
s_lshl_b32 s71, s72, 1
s_add_u32 s71, s71, 12
s_cmp_lt_u32 s72, 11
s_cselect_b32 s68, s68, s71
s_add_u32 s72, s72, 1
s_mul_i32 s69, s72, 3
s_add_u32 s69, s69, 1
s_lshl_b32 s71, s72, 1
s_add_u32 s71, s71, 12
s_cmp_lt_u32 s72, 11
s_cselect_b32 s69, s69, s71
s_lshl_b32 s70, s68, 14
s_add_u32 s70, s70, 786432
s_mov_b32 m0, 147456
s_nop 0
buffer_load_dwordx4 v10, s[36:39], s70 offen lds
buffer_load_dwordx4 v10, s[36:39], s70 offen offset:1024 lds
buffer_load_dwordx4 v10, s[36:39], s70 offen offset:2048 lds
buffer_load_dwordx4 v10, s[36:39], s70 offen offset:3072 lds
s_lshl_b32 s70, s69, 14
s_add_u32 s70, s70, 786432
s_mov_b32 m0, 151552
s_nop 0
buffer_load_dwordx4 v10, s[36:39], s70 offen lds
buffer_load_dwordx4 v10, s[36:39], s70 offen offset:1024 lds
buffer_load_dwordx4 v10, s[36:39], s70 offen offset:2048 lds
buffer_load_dwordx4 v10, s[36:39], s70 offen offset:3072 lds
s_waitcnt vmcnt(32)
s_barrier
s_add_u32 s72, s94, 7
s_and_b32 s72, s72, 7
s_lshl_b32 s72, s72, 1
s_mul_i32 s68, s72, 3
s_add_u32 s68, s68, 1
s_lshl_b32 s71, s72, 1
s_add_u32 s71, s71, 12
s_cmp_lt_u32 s72, 11
s_cselect_b32 s68, s68, s71
s_add_u32 s72, s72, 1
s_mul_i32 s69, s72, 3
s_add_u32 s69, s69, 1
s_lshl_b32 s71, s72, 1
s_add_u32 s71, s71, 12
s_cmp_lt_u32 s72, 11
s_cselect_b32 s69, s69, s71
s_lshl_b32 s70, s68, 14
s_add_u32 s70, s70, 786432
s_mov_b32 m0, 155648
s_nop 0
buffer_load_dwordx4 v10, s[36:39], s70 offen lds
buffer_load_dwordx4 v10, s[36:39], s70 offen offset:1024 lds
buffer_load_dwordx4 v10, s[36:39], s70 offen offset:2048 lds
buffer_load_dwordx4 v10, s[36:39], s70 offen offset:3072 lds
s_lshl_b32 s70, s69, 14
s_add_u32 s70, s70, 786432
s_mov_b32 m0, 159744
s_nop 0
buffer_load_dwordx4 v10, s[36:39], s70 offen lds
buffer_load_dwordx4 v10, s[36:39], s70 offen offset:1024 lds
buffer_load_dwordx4 v10, s[36:39], s70 offen offset:2048 lds
buffer_load_dwordx4 v10, s[36:39], s70 offen offset:3072 lds
s_waitcnt vmcnt(32)
s_barrier
buffer_load_dword v31, v27, s[40:43], 0 offen sc1
v_cmp_ne_u32 vcc, s6, v37
s_nop 0
s_cbranch_vccz L_pdone_17
s_mov_b32 s79, 0
L_poll_16:
buffer_load_dword v37, v33, s[40:43], 0 offen sc1
s_add_u32 s79, s79, 1
s_cmp_gt_u32 s79, 200000
s_waitcnt vmcnt(0)
s_cbranch_scc1 L_pdone_17
v_cmp_ne_u32 vcc, s6, v37
s_nop 0
s_cbranch_vccnz L_poll_16
L_pdone_17:
s_add_u32 s72, s95, 0
s_sub_u32 s71, s72, 5
s_cmp_ge_u32 s72, 5
s_cselect_b32 s72, s71, s72
s_mul_i32 s68, s72, 6
s_add_u32 s68, s68, 2
s_add_u32 s69, s68, 3
s_lshl_b32 s70, s68, 14
s_add_u32 s70, s70, 786432
s_mov_b32 m0, 98304
s_nop 0
buffer_load_dwordx4 v10, s[36:39], s70 offen lds
buffer_load_dwordx4 v10, s[36:39], s70 offen offset:1024 lds
buffer_load_dwordx4 v10, s[36:39], s70 offen offset:2048 lds
buffer_load_dwordx4 v10, s[36:39], s70 offen offset:3072 lds
s_lshl_b32 s70, s69, 14
s_add_u32 s70, s70, 786432
s_mov_b32 m0, 102400
s_nop 0
buffer_load_dwordx4 v10, s[36:39], s70 offen lds
buffer_load_dwordx4 v10, s[36:39], s70 offen offset:1024 lds
buffer_load_dwordx4 v10, s[36:39], s70 offen offset:2048 lds
buffer_load_dwordx4 v10, s[36:39], s70 offen offset:3072 lds
s_waitcnt vmcnt(33)
s_barrier
s_add_u32 s72, s95, 1
s_sub_u32 s71, s72, 5
s_cmp_ge_u32 s72, 5
s_cselect_b32 s72, s71, s72
s_mul_i32 s68, s72, 6
s_add_u32 s68, s68, 2
s_add_u32 s69, s68, 3
s_lshl_b32 s70, s68, 14
s_add_u32 s70, s70, 786432
s_mov_b32 m0, 106496
s_nop 0
buffer_load_dwordx4 v10, s[36:39], s70 offen lds
buffer_load_dwordx4 v10, s[36:39], s70 offen offset:1024 lds
buffer_load_dwordx4 v10, s[36:39], s70 offen offset:2048 lds
buffer_load_dwordx4 v10, s[36:39], s70 offen offset:3072 lds
s_lshl_b32 s70, s69, 14
s_add_u32 s70, s70, 786432
s_mov_b32 m0, 110592
s_nop 0
buffer_load_dwordx4 v10, s[36:39], s70 offen lds
buffer_load_dwordx4 v10, s[36:39], s70 offen offset:1024 lds
buffer_load_dwordx4 v10, s[36:39], s70 offen offset:2048 lds
buffer_load_dwordx4 v10, s[36:39], s70 offen offset:3072 lds
s_waitcnt vmcnt(33)
s_barrier
s_add_u32 s72, s95, 2
s_sub_u32 s71, s72, 5
s_cmp_ge_u32 s72, 5
s_cselect_b32 s72, s71, s72
s_mul_i32 s68, s72, 6
s_add_u32 s68, s68, 2
s_add_u32 s69, s68, 3
s_lshl_b32 s70, s68, 14
s_add_u32 s70, s70, 786432
s_mov_b32 m0, 114688
s_nop 0
buffer_load_dwordx4 v10, s[36:39], s70 offen lds
buffer_load_dwordx4 v10, s[36:39], s70 offen offset:1024 lds
buffer_load_dwordx4 v10, s[36:39], s70 offen offset:2048 lds
buffer_load_dwordx4 v10, s[36:39], s70 offen offset:3072 lds
s_lshl_b32 s70, s69, 14
s_add_u32 s70, s70, 786432
s_mov_b32 m0, 118784
s_nop 0
buffer_load_dwordx4 v10, s[36:39], s70 offen lds
buffer_load_dwordx4 v10, s[36:39], s70 offen offset:1024 lds
buffer_load_dwordx4 v10, s[36:39], s70 offen offset:2048 lds
buffer_load_dwordx4 v10, s[36:39], s70 offen offset:3072 lds
s_waitcnt vmcnt(33)
s_barrier
s_add_u32 s72, s95, 3
s_sub_u32 s71, s72, 5
s_cmp_ge_u32 s72, 5
s_cselect_b32 s72, s71, s72
s_mul_i32 s68, s72, 6
s_add_u32 s68, s68, 2
s_add_u32 s69, s68, 3
s_lshl_b32 s70, s68, 14
s_add_u32 s70, s70, 786432
s_mov_b32 m0, 122880
s_nop 0
buffer_load_dwordx4 v10, s[36:39], s70 offen lds
buffer_load_dwordx4 v10, s[36:39], s70 offen offset:1024 lds
buffer_load_dwordx4 v10, s[36:39], s70 offen offset:2048 lds
buffer_load_dwordx4 v10, s[36:39], s70 offen offset:3072 lds
s_lshl_b32 s70, s69, 14
s_add_u32 s70, s70, 786432
s_mov_b32 m0, 126976
s_nop 0
buffer_load_dwordx4 v10, s[36:39], s70 offen lds
buffer_load_dwordx4 v10, s[36:39], s70 offen offset:1024 lds
buffer_load_dwordx4 v10, s[36:39], s70 offen offset:2048 lds
buffer_load_dwordx4 v10, s[36:39], s70 offen offset:3072 lds
s_waitcnt vmcnt(33)
s_barrier
s_add_u32 s72, s95, 4
s_sub_u32 s71, s72, 5
s_cmp_ge_u32 s72, 5
s_cselect_b32 s72, s71, s72
s_mul_i32 s68, s72, 6
s_add_u32 s68, s68, 2
s_add_u32 s69, s68, 3
s_lshl_b32 s70, s68, 14
s_add_u32 s70, s70, 786432
s_mov_b32 m0, 131072
s_nop 0
buffer_load_dwordx4 v10, s[36:39], s70 offen lds
buffer_load_dwordx4 v10, s[36:39], s70 offen offset:1024 lds
buffer_load_dwordx4 v10, s[36:39], s70 offen offset:2048 lds
buffer_load_dwordx4 v10, s[36:39], s70 offen offset:3072 lds
s_lshl_b32 s70, s69, 14
s_add_u32 s70, s70, 786432
s_mov_b32 m0, 135168
s_nop 0
buffer_load_dwordx4 v10, s[36:39], s70 offen lds
buffer_load_dwordx4 v10, s[36:39], s70 offen offset:1024 lds
buffer_load_dwordx4 v10, s[36:39], s70 offen offset:2048 lds
buffer_load_dwordx4 v10, s[36:39], s70 offen offset:3072 lds
s_waitcnt vmcnt(32)
s_barrier
s_mov_b32 s68, 32
s_lshl_b32 s70, s68, 14
s_add_u32 s70, s70, 786432
s_mov_b32 m0, 139264
s_nop 0
buffer_load_dwordx4 v10, s[36:39], s70 offen lds
buffer_load_dwordx4 v10, s[36:39], s70 offen offset:1024 lds
buffer_load_dwordx4 v10, s[36:39], s70 offen offset:2048 lds
buffer_load_dwordx4 v10, s[36:39], s70 offen offset:3072 lds
s_waitcnt vmcnt(28)
s_barrier
v_cmp_ne_u32 vcc, s6, v31
s_nop 0
s_cbranch_vccz L_pdone_19
s_mov_b32 s79, 0
L_poll_18:
buffer_load_dword v31, v27, s[40:43], 0 offen sc1
s_add_u32 s79, s79, 1
s_cmp_gt_u32 s79, 200000
s_waitcnt vmcnt(0)
s_cbranch_scc1 L_pdone_19
v_cmp_ne_u32 vcc, s6, v31
s_nop 0
s_cbranch_vccnz L_poll_18
L_pdone_19:
s_add_u32 s70, s94, 0
s_and_b32 s70, s70, 7
s_lshl_b32 s70, s70, 15
s_add_u32 s70, s70, 524288
s_mov_b32 m0, 147456
s_nop 0
buffer_load_dwordx4 v10, s[36:39], s70 offen lds
buffer_load_dwordx4 v10, s[36:39], s70 offen offset:1024 lds
buffer_load_dwordx4 v10, s[36:39], s70 offen offset:2048 lds
buffer_load_dwordx4 v10, s[36:39], s70 offen offset:3072 lds
s_mov_b32 m0, 151552
s_add_u32 s70, s70, 16384
buffer_load_dwordx4 v10, s[36:39], s70 offen lds
buffer_load_dwordx4 v10, s[36:39], s70 offen offset:1024 lds
buffer_load_dwordx4 v10, s[36:39], s70 offen offset:2048 lds
buffer_load_dwordx4 v10, s[36:39], s70 offen offset:3072 lds
s_waitcnt vmcnt(28)
s_barrier
s_add_u32 s70, s94, 1
s_and_b32 s70, s70, 7
s_lshl_b32 s70, s70, 15
s_add_u32 s70, s70, 524288
s_mov_b32 m0, 155648
s_nop 0
buffer_load_dwordx4 v10, s[36:39], s70 offen lds
buffer_load_dwordx4 v10, s[36:39], s70 offen offset:1024 lds
buffer_load_dwordx4 v10, s[36:39], s70 offen offset:2048 lds
buffer_load_dwordx4 v10, s[36:39], s70 offen offset:3072 lds
s_mov_b32 m0, 159744
s_add_u32 s70, s70, 16384
buffer_load_dwordx4 v10, s[36:39], s70 offen lds
buffer_load_dwordx4 v10, s[36:39], s70 offen offset:1024 lds
buffer_load_dwordx4 v10, s[36:39], s70 offen offset:2048 lds
buffer_load_dwordx4 v10, s[36:39], s70 offen offset:3072 lds
s_waitcnt vmcnt(28)
s_barrier
s_add_u32 s70, s94, 2
s_and_b32 s70, s70, 7
s_lshl_b32 s70, s70, 15
s_add_u32 s70, s70, 524288
s_mov_b32 m0, 98304
s_nop 0
buffer_load_dwordx4 v10, s[36:39], s70 offen lds
buffer_load_dwordx4 v10, s[36:39], s70 offen offset:1024 lds
buffer_load_dwordx4 v10, s[36:39], s70 offen offset:2048 lds
buffer_load_dwordx4 v10, s[36:39], s70 offen offset:3072 lds
s_mov_b32 m0, 102400
s_add_u32 s70, s70, 16384
buffer_load_dwordx4 v10, s[36:39], s70 offen lds
buffer_load_dwordx4 v10, s[36:39], s70 offen offset:1024 lds
buffer_load_dwordx4 v10, s[36:39], s70 offen offset:2048 lds
buffer_load_dwordx4 v10, s[36:39], s70 offen offset:3072 lds
s_waitcnt vmcnt(28)
s_barrier
s_add_u32 s70, s94, 3
s_and_b32 s70, s70, 7
s_lshl_b32 s70, s70, 15
s_add_u32 s70, s70, 524288
s_mov_b32 m0, 106496
s_nop 0
buffer_load_dwordx4 v10, s[36:39], s70 offen lds
buffer_load_dwordx4 v10, s[36:39], s70 offen offset:1024 lds
buffer_load_dwordx4 v10, s[36:39], s70 offen offset:2048 lds
buffer_load_dwordx4 v10, s[36:39], s70 offen offset:3072 lds
s_mov_b32 m0, 110592
s_add_u32 s70, s70, 16384
buffer_load_dwordx4 v10, s[36:39], s70 offen lds
buffer_load_dwordx4 v10, s[36:39], s70 offen offset:1024 lds
buffer_load_dwordx4 v10, s[36:39], s70 offen offset:2048 lds
buffer_load_dwordx4 v10, s[36:39], s70 offen offset:3072 lds
s_waitcnt vmcnt(32)
s_barrier
s_add_u32 s70, s94, 4
s_and_b32 s70, s70, 7
s_lshl_b32 s70, s70, 15
s_add_u32 s70, s70, 524288
s_mov_b32 m0, 114688
s_nop 0
buffer_load_dwordx4 v10, s[36:39], s70 offen lds
buffer_load_dwordx4 v10, s[36:39], s70 offen offset:1024 lds
buffer_load_dwordx4 v10, s[36:39], s70 offen offset:2048 lds
buffer_load_dwordx4 v10, s[36:39], s70 offen offset:3072 lds
s_mov_b32 m0, 118784
s_add_u32 s70, s70, 16384
buffer_load_dwordx4 v10, s[36:39], s70 offen lds
buffer_load_dwordx4 v10, s[36:39], s70 offen offset:1024 lds
buffer_load_dwordx4 v10, s[36:39], s70 offen offset:2048 lds
buffer_load_dwordx4 v10, s[36:39], s70 offen offset:3072 lds
s_waitcnt vmcnt(32)
s_barrier
s_add_u32 s70, s94, 5
s_and_b32 s70, s70, 7
s_lshl_b32 s70, s70, 15
s_add_u32 s70, s70, 524288
s_mov_b32 m0, 122880
s_nop 0
buffer_load_dwordx4 v10, s[36:39], s70 offen lds
buffer_load_dwordx4 v10, s[36:39], s70 offen offset:1024 lds
buffer_load_dwordx4 v10, s[36:39], s70 offen offset:2048 lds
buffer_load_dwordx4 v10, s[36:39], s70 offen offset:3072 lds
s_mov_b32 m0, 126976
s_add_u32 s70, s70, 16384
buffer_load_dwordx4 v10, s[36:39], s70 offen lds
buffer_load_dwordx4 v10, s[36:39], s70 offen offset:1024 lds
buffer_load_dwordx4 v10, s[36:39], s70 offen offset:2048 lds
buffer_load_dwordx4 v10, s[36:39], s70 offen offset:3072 lds
s_waitcnt vmcnt(32)
s_barrier
s_add_u32 s70, s94, 6
s_and_b32 s70, s70, 7
s_lshl_b32 s70, s70, 15
s_add_u32 s70, s70, 524288
s_mov_b32 m0, 131072
s_nop 0
buffer_load_dwordx4 v10, s[36:39], s70 offen lds
buffer_load_dwordx4 v10, s[36:39], s70 offen offset:1024 lds
buffer_load_dwordx4 v10, s[36:39], s70 offen offset:2048 lds
buffer_load_dwordx4 v10, s[36:39], s70 offen offset:3072 lds
s_mov_b32 m0, 135168
s_add_u32 s70, s70, 16384
buffer_load_dwordx4 v10, s[36:39], s70 offen lds
buffer_load_dwordx4 v10, s[36:39], s70 offen offset:1024 lds
buffer_load_dwordx4 v10, s[36:39], s70 offen offset:2048 lds
buffer_load_dwordx4 v10, s[36:39], s70 offen offset:3072 lds
s_waitcnt vmcnt(32)
s_barrier
s_add_u32 s70, s94, 7
s_and_b32 s70, s70, 7
s_lshl_b32 s70, s70, 15
s_add_u32 s70, s70, 524288
s_mov_b32 m0, 139264
s_nop 0
buffer_load_dwordx4 v10, s[36:39], s70 offen lds
buffer_load_dwordx4 v10, s[36:39], s70 offen offset:1024 lds
buffer_load_dwordx4 v10, s[36:39], s70 offen offset:2048 lds
buffer_load_dwordx4 v10, s[36:39], s70 offen offset:3072 lds
s_mov_b32 m0, 143360
s_add_u32 s70, s70, 16384
buffer_load_dwordx4 v10, s[36:39], s70 offen lds
buffer_load_dwordx4 v10, s[36:39], s70 offen offset:1024 lds
buffer_load_dwordx4 v10, s[36:39], s70 offen offset:2048 lds
buffer_load_dwordx4 v10, s[36:39], s70 offen offset:3072 lds
s_waitcnt vmcnt(32)
s_barrier
s_waitcnt vmcnt(24)
s_barrier
s_waitcnt vmcnt(16)
s_barrier
s_waitcnt vmcnt(8)
s_barrier
s_waitcnt vmcnt(0)
s_barrier
s_endpgm
L_lw_1:
L_lwstart:
v_lshrrev_b32 v8, 3, v1
v_lshrrev_b32 v9, 4, v1
v_and_b32 v9, 1, v9
v_lshlrev_b32 v9, 2, v9
v_and_b32 v10, 7, v1
v_xor_b32 v9, v9, v10
v_lshlrev_b32 v9, 4, v9
s_lshl_b32 s94, s57, 7
s_add_u32 s95, s57, 2
s_and_b32 s95, s95, 7
s_lshl_b32 s95, s95, 7
s_cmp_eq_u32 s58, 0
s_cselect_b32 s90, 1024, 0
s_cselect_b32 s91, 2048, 0
s_cselect_b32 s95, s94, s95
s_mov_b32 s92, 1024
s_cselect_b32 s92, 3072, s92
s_add_u32 s90, s90, s94
s_add_u32 s91, s91, s95
s_lshl_b32 s93, s92, 3
v_mul_u32_u24 v4, 3072, v8
v_add_u32 v4, v4, v9
v_add_u32 v4, s90, v4
v_mul_u32_u24 v5, s92, v8
v_add_u32 v5, v5, v9
v_add_u32 v5, s91, v5
s_xor_b32 s92, s56, s57
s_and_b32 s92, s92, 1
s_waitcnt lgkmcnt(0)
s_mov_b32 s82, 0
s_mov_b32 s83, 16384
s_mov_b32 s12, s66
s_and_b32 s13, s67, 0xffff
s_mov_b32 s14, 1572864
s_mov_b32 s15, 0x20000
s_cmp_eq_u32 s58, 0
s_cselect_b32 s16, s66, s74
s_cselect_b32 s17, s67, s75
s_mov_b32 s18, 0x80000
s_cselect_b32 s18, 0x180000, s18
s_and_b32 s17, s17, 0xffff
s_mov_b32 s19, 0x20000
L_i2_20:
s_xor_b32 s95, s92, s82
s_add_u32 s95, s95, s3
s_and_b32 s95, s95, 7
s_mul_i32 s94, s95, 196608
s_mul_i32 s95, s95, s93
s_lshl_b32 s95, s95, 3
s_mov_b32 m0, s83
s_nop 0
buffer_load_dwordx4 v4, s[12:15], s94 offen lds
s_add_u32 m0, m0, 8192
s_add_u32 s94, s94, 24576
buffer_load_dwordx4 v5, s[16:19], s95 offen lds
s_sub_u32 m0, m0, 7168
s_add_u32 s95, s95, s93
buffer_load_dwordx4 v4, s[12:15], s94 offen lds
s_add_u32 m0, m0, 8192
s_add_u32 s94, s94, 24576
buffer_load_dwordx4 v5, s[16:19], s95 offen lds
s_sub_u32 m0, m0, 7168
s_add_u32 s95, s95, s93
buffer_load_dwordx4 v4, s[12:15], s94 offen lds
s_add_u32 m0, m0, 8192
s_add_u32 s94, s94, 24576
buffer_load_dwordx4 v5, s[16:19], s95 offen lds
s_sub_u32 m0, m0, 7168
s_add_u32 s95, s95, s93
buffer_load_dwordx4 v4, s[12:15], s94 offen lds
s_add_u32 m0, m0, 8192
s_add_u32 s94, s94, 24576
buffer_load_dwordx4 v5, s[16:19], s95 offen lds
s_sub_u32 m0, m0, 7168
s_add_u32 s95, s95, s93
buffer_load_dwordx4 v4, s[12:15], s94 offen lds
s_add_u32 m0, m0, 8192
s_add_u32 s94, s94, 24576
buffer_load_dwordx4 v5, s[16:19], s95 offen lds
s_sub_u32 m0, m0, 7168
s_add_u32 s95, s95, s93
buffer_load_dwordx4 v4, s[12:15], s94 offen lds
s_add_u32 m0, m0, 8192
s_add_u32 s94, s94, 24576
buffer_load_dwordx4 v5, s[16:19], s95 offen lds
s_sub_u32 m0, m0, 7168
s_add_u32 s95, s95, s93
buffer_load_dwordx4 v4, s[12:15], s94 offen lds
s_add_u32 m0, m0, 8192
s_add_u32 s94, s94, 24576
buffer_load_dwordx4 v5, s[16:19], s95 offen lds
s_sub_u32 m0, m0, 7168
s_add_u32 s95, s95, s93
buffer_load_dwordx4 v4, s[12:15], s94 offen lds
s_add_u32 m0, m0, 8192
s_add_u32 s94, s94, 24576
buffer_load_dwordx4 v5, s[16:19], s95 offen lds
s_sub_u32 m0, m0, 7168
s_add_u32 s95, s95, s93
s_add_u32 s82, s82, 1
s_add_u32 s83, s83, 32768
s_cmp_eq_u32 s83, 114688
s_cselect_b32 s83, 16384, s83
s_cmp_lt_u32 s82, 2
s_cbranch_scc1 L_i2_20
s_mov_b32 s32, s70
s_and_b32 s33, s71, 0xffff
s_mov_b32 s34, 524288
s_mov_b32 s35, 0x20000
s_mov_b32 s20, s76
s_and_b32 s21, s77, 0xffff
s_mov_b32 s22, 524288
s_mov_b32 s23, 0x20000
s_mov_b32 s24, s78
s_and_b32 s25, s79, 0xffff
s_mov_b32 s26, 1409024
s_mov_b32 s27, 0x20000
s_mov_b32 s28, s80
s_and_b32 s29, s81, 0xffff
s_mov_b32 s30, 1409024
s_mov_b32 s31, 0x20000
s_mov_b32 s40, s88
s_and_b32 s41, s89, 0xffff
s_mov_b32 s42, 4194304
s_mov_b32 s43, 0x20000
s_load_dword s6, s[88:89], 0
s_and_b32 s76, s4, 3
s_lshr_b32 s77, s4, 2
s_lshr_b32 s78, s4, 1
s_mul_i32 s68, s78, 3
s_lshl_b32 s69, s78, 1
s_add_u32 s69, s69, 11
s_cmp_lt_u32 s78, 11
s_cselect_b32 s87, s68, s69
s_lshl_b32 s68, s77, 7
v_lshlrev_b32 v6, 10, v8
v_add_u32 v6, v6, v9
v_add_u32 v6, s68, v6
s_add_u32 s36, s88, 4194304
s_addc_u32 s37, s89, 0
s_and_b32 s37, s37, 0xffff
s_mov_b32 s38, 16777216
s_mov_b32 s39, 0x20000
v_lshrrev_b32 v101, 4, v1
v_and_b32 v101, 3, v101
v_and_b32 v102, 3, v1
v_xor_b32 v101, v101, v102
v_lshlrev_b32 v101, 4, v101
v_lshrrev_b32 v102, 2, v1
s_lshl_b32 s68, s56, 7
v_add_u32 v102, s68, v102
v_lshlrev_b32 v102, 6, v102
v_add_u32 v102, v102, v101
v_add_u32 v100, s63, v102
s_lshl_b32 s68, s87, 6
s_mov_b32 s70, 43691
v_add_u32 v8, 0, v1
v_mul_lo_u32 v9, v8, s70
v_lshrrev_b32 v9, 19, v9
v_mul_u32_u24 v10, 12, v9
v_sub_u32 v10, v8, v10
v_lshlrev_b32 v10, 4, v10
v_mul_u32_u24 v9, 2752, v9
v_add_u32 v9, v9, v10
v_add_u32 v12, s68, v9
v_add_u32 v8, 64, v1
v_mul_lo_u32 v9, v8, s70
v_lshrrev_b32 v9, 19, v9
v_mul_u32_u24 v10, 12, v9
v_sub_u32 v10, v8, v10
v_lshlrev_b32 v10, 4, v10
v_mul_u32_u24 v9, 2752, v9
v_add_u32 v9, v9, v10
v_add_u32 v13, s68, v9
v_add_u32 v8, 128, v1
v_mul_lo_u32 v9, v8, s70
v_lshrrev_b32 v9, 19, v9
v_mul_u32_u24 v10, 12, v9
v_sub_u32 v10, v8, v10
v_lshlrev_b32 v10, 4, v10
v_mul_u32_u24 v9, 2752, v9
v_add_u32 v9, v9, v10
v_add_u32 v14, s68, v9
v_add_u32 v8, 192, v1
v_mul_lo_u32 v9, v8, s70
v_lshrrev_b32 v9, 19, v9
v_mul_u32_u24 v10, 12, v9
v_sub_u32 v10, v8, v10
v_lshlrev_b32 v10, 4, v10
v_mul_u32_u24 v9, 2752, v9
v_add_u32 v9, v9, v10
v_add_u32 v15, s68, v9
v_add_u32 v8, 256, v1
v_mul_lo_u32 v9, v8, s70
v_lshrrev_b32 v9, 19, v9
v_mul_u32_u24 v10, 12, v9
v_sub_u32 v10, v8, v10
v_lshlrev_b32 v10, 4, v10
v_mul_u32_u24 v9, 2752, v9
v_add_u32 v9, v9, v10
v_add_u32 v16, s68, v9
v_add_u32 v8, 320, v1
v_mul_lo_u32 v9, v8, s70
v_lshrrev_b32 v9, 19, v9
v_mul_u32_u24 v10, 12, v9
v_sub_u32 v10, v8, v10
v_lshlrev_b32 v10, 4, v10
v_mul_u32_u24 v9, 2752, v9
v_add_u32 v9, v9, v10
v_add_u32 v17, s68, v9
v_add_u32 v8, 384, v1
v_mul_lo_u32 v9, v8, s70
v_lshrrev_b32 v9, 19, v9
v_mul_u32_u24 v10, 12, v9
v_sub_u32 v10, v8, v10
v_lshlrev_b32 v10, 4, v10
v_mul_u32_u24 v9, 2752, v9
v_add_u32 v9, v9, v10
v_add_u32 v18, s68, v9
v_add_u32 v8, 448, v1
v_mul_lo_u32 v9, v8, s70
v_lshrrev_b32 v9, 19, v9
v_mul_u32_u24 v10, 12, v9
v_sub_u32 v10, v8, v10
v_lshlrev_b32 v10, 4, v10
v_mul_u32_u24 v9, 2752, v9
v_add_u32 v9, v9, v10
v_add_u32 v19, s68, v9
v_add_u32 v8, 512, v1
v_mul_lo_u32 v9, v8, s70
v_lshrrev_b32 v9, 19, v9
v_mul_u32_u24 v10, 12, v9
v_sub_u32 v10, v8, v10
v_lshlrev_b32 v10, 4, v10
v_mul_u32_u24 v9, 2752, v9
v_add_u32 v9, v9, v10
v_add_u32 v20, s68, v9
v_add_u32 v8, 576, v1
v_mul_lo_u32 v9, v8, s70
v_lshrrev_b32 v9, 19, v9
v_mul_u32_u24 v10, 12, v9
v_sub_u32 v10, v8, v10
v_lshlrev_b32 v10, 4, v10
v_mul_u32_u24 v9, 2752, v9
v_add_u32 v9, v9, v10
v_add_u32 v21, s68, v9
v_add_u32 v8, 640, v1
v_mul_lo_u32 v9, v8, s70
v_lshrrev_b32 v9, 19, v9
v_mul_u32_u24 v10, 12, v9
v_sub_u32 v10, v8, v10
v_lshlrev_b32 v10, 4, v10
v_mul_u32_u24 v9, 2752, v9
v_add_u32 v9, v9, v10
v_add_u32 v22, s68, v9
v_add_u32 v8, 704, v1
v_mul_lo_u32 v9, v8, s70
v_lshrrev_b32 v9, 19, v9
v_mul_u32_u24 v10, 12, v9
v_sub_u32 v10, v8, v10
v_lshlrev_b32 v10, 4, v10
v_mul_u32_u24 v9, 2752, v9
v_add_u32 v9, v9, v10
v_add_u32 v23, s68, v9
s_waitcnt lgkmcnt(0)
s_add_u32 s6, s6, 1
s_lshl_b32 s64, s56, 2
s_add_u32 s64, s64, s3
s_add_u32 s64, s64, s78
s_and_b32 s64, s64, 7
L_s1k_22:
s_waitcnt vmcnt(16)
s_barrier
s_xor_b32 s95, s92, s82
s_add_u32 s95, s95, s3
s_and_b32 s95, s95, 7
s_mul_i32 s94, s95, 196608
s_mul_i32 s95, s95, s93
s_lshl_b32 s95, s95, 3
s_mov_b32 m0, s83
s_nop 0
buffer_load_dwordx4 v4, s[12:15], s94 offen lds
s_add_u32 m0, m0, 8192
s_add_u32 s94, s94, 24576
buffer_load_dwordx4 v5, s[16:19], s95 offen lds
s_sub_u32 m0, m0, 7168
s_add_u32 s95, s95, s93
buffer_load_dwordx4 v4, s[12:15], s94 offen lds
s_add_u32 m0, m0, 8192
s_add_u32 s94, s94, 24576
buffer_load_dwordx4 v5, s[16:19], s95 offen lds
s_sub_u32 m0, m0, 7168
s_add_u32 s95, s95, s93
buffer_load_dwordx4 v4, s[12:15], s94 offen lds
s_add_u32 m0, m0, 8192
s_add_u32 s94, s94, 24576
buffer_load_dwordx4 v5, s[16:19], s95 offen lds
s_sub_u32 m0, m0, 7168
s_add_u32 s95, s95, s93
buffer_load_dwordx4 v4, s[12:15], s94 offen lds
s_add_u32 m0, m0, 8192
s_add_u32 s94, s94, 24576
buffer_load_dwordx4 v5, s[16:19], s95 offen lds
s_sub_u32 m0, m0, 7168
s_add_u32 s95, s95, s93
buffer_load_dwordx4 v4, s[12:15], s94 offen lds
s_add_u32 m0, m0, 8192
s_add_u32 s94, s94, 24576
buffer_load_dwordx4 v5, s[16:19], s95 offen lds
s_sub_u32 m0, m0, 7168
s_add_u32 s95, s95, s93
buffer_load_dwordx4 v4, s[12:15], s94 offen lds
s_add_u32 m0, m0, 8192
s_add_u32 s94, s94, 24576
buffer_load_dwordx4 v5, s[16:19], s95 offen lds
s_sub_u32 m0, m0, 7168
s_add_u32 s95, s95, s93
buffer_load_dwordx4 v4, s[12:15], s94 offen lds
s_add_u32 m0, m0, 8192
s_add_u32 s94, s94, 24576
buffer_load_dwordx4 v5, s[16:19], s95 offen lds
s_sub_u32 m0, m0, 7168
s_add_u32 s95, s95, s93
buffer_load_dwordx4 v4, s[12:15], s94 offen lds
s_add_u32 m0, m0, 8192
s_add_u32 s94, s94, 24576
buffer_load_dwordx4 v5, s[16:19], s95 offen lds
s_sub_u32 m0, m0, 7168
s_add_u32 s95, s95, s93
s_add_u32 s82, s82, 1
s_add_u32 s83, s83, 32768
s_cmp_eq_u32 s83, 114688
s_cselect_b32 s83, 16384, s83
s_cmp_lt_u32 s82, 8
s_cbranch_scc1 L_s1k_22
s_waitcnt vmcnt(16)
s_barrier
s_waitcnt vmcnt(0)
s_barrier
s_lshl_b32 s71, s76, 1
s_add_u32 s71, s71, s3
s_add_u32 s71, s71, 0
s_and_b32 s71, s71, 7
s_and_b32 s70, s71, 1
s_and_b32 s72, s71, 2
s_lshl_b32 s72, s72, 1
s_or_b32 s70, s70, s72
s_lshr_b32 s72, s71, 1
s_and_b32 s72, s72, 2
s_or_b32 s70, s70, s72
s_cmp_eq_u32 s76, 0
s_cselect_b32 s72, 2, 0
s_xor_b32 s70, s70, s72
s_lshl_b32 s70, s70, 16
s_lshl_b32 s71, s71, 13
s_add_u32 m0, s71, 98304
s_nop 0
buffer_load_dwordx4 v6, s[20:23], s70 offen lds
s_add_u32 m0, m0, 1024
s_add_u32 s70, s70, 8192
buffer_load_dwordx4 v6, s[20:23], s70 offen lds
s_add_u32 m0, m0, 1024
s_add_u32 s70, s70, 8192
buffer_load_dwordx4 v6, s[20:23], s70 offen lds
s_add_u32 m0, m0, 1024
s_add_u32 s70, s70, 8192
buffer_load_dwordx4 v6, s[20:23], s70 offen lds
s_add_u32 m0, m0, 1024
s_add_u32 s70, s70, 8192
buffer_load_dwordx4 v6, s[20:23], s70 offen lds
s_add_u32 m0, m0, 1024
s_add_u32 s70, s70, 8192
buffer_load_dwordx4 v6, s[20:23], s70 offen lds
s_add_u32 m0, m0, 1024
s_add_u32 s70, s70, 8192
buffer_load_dwordx4 v6, s[20:23], s70 offen lds
s_add_u32 m0, m0, 1024
s_add_u32 s70, s70, 8192
buffer_load_dwordx4 v6, s[20:23], s70 offen lds
s_lshl_b32 s71, s76, 1
s_add_u32 s71, s71, s3
s_add_u32 s71, s71, 1
s_and_b32 s71, s71, 7
s_and_b32 s70, s71, 1
s_and_b32 s72, s71, 2
s_lshl_b32 s72, s72, 1
s_or_b32 s70, s70, s72
s_lshr_b32 s72, s71, 1
s_and_b32 s72, s72, 2
s_or_b32 s70, s70, s72
s_cmp_eq_u32 s76, 0
s_cselect_b32 s72, 2, 0
s_xor_b32 s70, s70, s72
s_lshl_b32 s70, s70, 16
s_lshl_b32 s71, s71, 13
s_add_u32 m0, s71, 98304
s_nop 0
buffer_load_dwordx4 v6, s[20:23], s70 offen lds
s_add_u32 m0, m0, 1024
s_add_u32 s70, s70, 8192
buffer_load_dwordx4 v6, s[20:23], s70 offen lds
s_add_u32 m0, m0, 1024
s_add_u32 s70, s70, 8192
buffer_load_dwordx4 v6, s[20:23], s70 offen lds
s_add_u32 m0, m0, 1024
s_add_u32 s70, s70, 8192
buffer_load_dwordx4 v6, s[20:23], s70 offen lds
s_add_u32 m0, m0, 1024
s_add_u32 s70, s70, 8192
buffer_load_dwordx4 v6, s[20:23], s70 offen lds
s_add_u32 m0, m0, 1024
s_add_u32 s70, s70, 8192
buffer_load_dwordx4 v6, s[20:23], s70 offen lds
s_add_u32 m0, m0, 1024
s_add_u32 s70, s70, 8192
buffer_load_dwordx4 v6, s[20:23], s70 offen lds
s_add_u32 m0, m0, 1024
s_add_u32 s70, s70, 8192
buffer_load_dwordx4 v6, s[20:23], s70 offen lds
s_lshl_b32 s71, s76, 1
s_add_u32 s71, s71, s3
s_add_u32 s71, s71, 2
s_and_b32 s71, s71, 7
s_and_b32 s70, s71, 1
s_and_b32 s72, s71, 2
s_lshl_b32 s72, s72, 1
s_or_b32 s70, s70, s72
s_lshr_b32 s72, s71, 1
s_and_b32 s72, s72, 2
s_or_b32 s70, s70, s72
s_cmp_eq_u32 s76, 0
s_cselect_b32 s72, 2, 0
s_xor_b32 s70, s70, s72
s_lshl_b32 s70, s70, 16
s_lshl_b32 s71, s71, 13
s_add_u32 m0, s71, 98304
s_nop 0
buffer_load_dwordx4 v6, s[20:23], s70 offen lds
s_add_u32 m0, m0, 1024
s_add_u32 s70, s70, 8192
buffer_load_dwordx4 v6, s[20:23], s70 offen lds
s_add_u32 m0, m0, 1024
s_add_u32 s70, s70, 8192
buffer_load_dwordx4 v6, s[20:23], s70 offen lds
s_add_u32 m0, m0, 1024
s_add_u32 s70, s70, 8192
buffer_load_dwordx4 v6, s[20:23], s70 offen lds
s_add_u32 m0, m0, 1024
s_add_u32 s70, s70, 8192
buffer_load_dwordx4 v6, s[20:23], s70 offen lds
s_add_u32 m0, m0, 1024
s_add_u32 s70, s70, 8192
buffer_load_dwordx4 v6, s[20:23], s70 offen lds
s_add_u32 m0, m0, 1024
s_add_u32 s70, s70, 8192
buffer_load_dwordx4 v6, s[20:23], s70 offen lds
s_add_u32 m0, m0, 1024
s_add_u32 s70, s70, 8192
buffer_load_dwordx4 v6, s[20:23], s70 offen lds
s_lshl_b32 s71, s76, 1
s_add_u32 s71, s71, s3
s_add_u32 s71, s71, 3
s_and_b32 s71, s71, 7
s_and_b32 s70, s71, 1
s_and_b32 s72, s71, 2
s_lshl_b32 s72, s72, 1
s_or_b32 s70, s70, s72
s_lshr_b32 s72, s71, 1
s_and_b32 s72, s72, 2
s_or_b32 s70, s70, s72
s_cmp_eq_u32 s76, 0
s_cselect_b32 s72, 2, 0
s_xor_b32 s70, s70, s72
s_lshl_b32 s70, s70, 16
s_lshl_b32 s71, s71, 13
s_add_u32 m0, s71, 98304
s_nop 0
buffer_load_dwordx4 v6, s[20:23], s70 offen lds
s_add_u32 m0, m0, 1024
s_add_u32 s70, s70, 8192
buffer_load_dwordx4 v6, s[20:23], s70 offen lds
s_add_u32 m0, m0, 1024
s_add_u32 s70, s70, 8192
buffer_load_dwordx4 v6, s[20:23], s70 offen lds
s_add_u32 m0, m0, 1024
s_add_u32 s70, s70, 8192
buffer_load_dwordx4 v6, s[20:23], s70 offen lds
s_add_u32 m0, m0, 1024
s_add_u32 s70, s70, 8192
buffer_load_dwordx4 v6, s[20:23], s70 offen lds
s_add_u32 m0, m0, 1024
s_add_u32 s70, s70, 8192
buffer_load_dwordx4 v6, s[20:23], s70 offen lds
s_add_u32 m0, m0, 1024
s_add_u32 s70, s70, 8192
buffer_load_dwordx4 v6, s[20:23], s70 offen lds
s_add_u32 m0, m0, 1024
s_add_u32 s70, s70, 8192
buffer_load_dwordx4 v6, s[20:23], s70 offen lds
s_lshl_b32 s71, s76, 1
s_add_u32 s71, s71, s3
s_add_u32 s71, s71, 4
s_and_b32 s71, s71, 7
s_and_b32 s70, s71, 1
s_and_b32 s72, s71, 2
s_lshl_b32 s72, s72, 1
s_or_b32 s70, s70, s72
s_lshr_b32 s72, s71, 1
s_and_b32 s72, s72, 2
s_or_b32 s70, s70, s72
s_cmp_eq_u32 s76, 0
s_cselect_b32 s72, 2, 0
s_xor_b32 s70, s70, s72
s_lshl_b32 s70, s70, 16
s_lshl_b32 s71, s71, 13
s_add_u32 m0, s71, 98304
s_nop 0
buffer_load_dwordx4 v6, s[20:23], s70 offen lds
s_add_u32 m0, m0, 1024
s_add_u32 s70, s70, 8192
buffer_load_dwordx4 v6, s[20:23], s70 offen lds
s_add_u32 m0, m0, 1024
s_add_u32 s70, s70, 8192
buffer_load_dwordx4 v6, s[20:23], s70 offen lds
s_add_u32 m0, m0, 1024
s_add_u32 s70, s70, 8192
buffer_load_dwordx4 v6, s[20:23], s70 offen lds
s_add_u32 m0, m0, 1024
s_add_u32 s70, s70, 8192
buffer_load_dwordx4 v6, s[20:23], s70 offen lds
s_add_u32 m0, m0, 1024
s_add_u32 s70, s70, 8192
buffer_load_dwordx4 v6, s[20:23], s70 offen lds
s_add_u32 m0, m0, 1024
s_add_u32 s70, s70, 8192
buffer_load_dwordx4 v6, s[20:23], s70 offen lds
s_add_u32 m0, m0, 1024
s_add_u32 s70, s70, 8192
buffer_load_dwordx4 v6, s[20:23], s70 offen lds
s_lshl_b32 s71, s76, 1
s_add_u32 s71, s71, s3
s_add_u32 s71, s71, 5
s_and_b32 s71, s71, 7
s_and_b32 s70, s71, 1
s_and_b32 s72, s71, 2
s_lshl_b32 s72, s72, 1
s_or_b32 s70, s70, s72
s_lshr_b32 s72, s71, 1
s_and_b32 s72, s72, 2
s_or_b32 s70, s70, s72
s_cmp_eq_u32 s76, 0
s_cselect_b32 s72, 2, 0
s_xor_b32 s70, s70, s72
s_lshl_b32 s70, s70, 16
s_lshl_b32 s71, s71, 13
s_add_u32 m0, s71, 98304
s_nop 0
buffer_load_dwordx4 v6, s[20:23], s70 offen lds
s_add_u32 m0, m0, 1024
s_add_u32 s70, s70, 8192
buffer_load_dwordx4 v6, s[20:23], s70 offen lds
s_add_u32 m0, m0, 1024
s_add_u32 s70, s70, 8192
buffer_load_dwordx4 v6, s[20:23], s70 offen lds
s_add_u32 m0, m0, 1024
s_add_u32 s70, s70, 8192
buffer_load_dwordx4 v6, s[20:23], s70 offen lds
s_add_u32 m0, m0, 1024
s_add_u32 s70, s70, 8192
buffer_load_dwordx4 v6, s[20:23], s70 offen lds
s_add_u32 m0, m0, 1024
s_add_u32 s70, s70, 8192
buffer_load_dwordx4 v6, s[20:23], s70 offen lds
s_add_u32 m0, m0, 1024
s_add_u32 s70, s70, 8192
buffer_load_dwordx4 v6, s[20:23], s70 offen lds
s_add_u32 m0, m0, 1024
s_add_u32 s70, s70, 8192
buffer_load_dwordx4 v6, s[20:23], s70 offen lds
s_lshl_b32 s71, s76, 1
s_add_u32 s71, s71, s3
s_add_u32 s71, s71, 6
s_and_b32 s71, s71, 7
s_and_b32 s70, s71, 1
s_and_b32 s72, s71, 2
s_lshl_b32 s72, s72, 1
s_or_b32 s70, s70, s72
s_lshr_b32 s72, s71, 1
s_and_b32 s72, s72, 2
s_or_b32 s70, s70, s72
s_cmp_eq_u32 s76, 0
s_cselect_b32 s72, 2, 0
s_xor_b32 s70, s70, s72
s_lshl_b32 s70, s70, 16
s_lshl_b32 s71, s71, 13
s_add_u32 m0, s71, 98304
s_nop 0
buffer_load_dwordx4 v6, s[20:23], s70 offen lds
s_add_u32 m0, m0, 1024
s_add_u32 s70, s70, 8192
buffer_load_dwordx4 v6, s[20:23], s70 offen lds
s_add_u32 m0, m0, 1024
s_add_u32 s70, s70, 8192
buffer_load_dwordx4 v6, s[20:23], s70 offen lds
s_add_u32 m0, m0, 1024
s_add_u32 s70, s70, 8192
buffer_load_dwordx4 v6, s[20:23], s70 offen lds
s_add_u32 m0, m0, 1024
s_add_u32 s70, s70, 8192
buffer_load_dwordx4 v6, s[20:23], s70 offen lds
s_add_u32 m0, m0, 1024
s_add_u32 s70, s70, 8192
buffer_load_dwordx4 v6, s[20:23], s70 offen lds
s_add_u32 m0, m0, 1024
s_add_u32 s70, s70, 8192
buffer_load_dwordx4 v6, s[20:23], s70 offen lds
s_add_u32 m0, m0, 1024
s_add_u32 s70, s70, 8192
buffer_load_dwordx4 v6, s[20:23], s70 offen lds
s_lshl_b32 s71, s76, 1
s_add_u32 s71, s71, s3
s_add_u32 s71, s71, 7
s_and_b32 s71, s71, 7
s_and_b32 s70, s71, 1
s_and_b32 s72, s71, 2
s_lshl_b32 s72, s72, 1
s_or_b32 s70, s70, s72
s_lshr_b32 s72, s71, 1
s_and_b32 s72, s72, 2
s_or_b32 s70, s70, s72
s_cmp_eq_u32 s76, 0
s_cselect_b32 s72, 2, 0
s_xor_b32 s70, s70, s72
s_lshl_b32 s70, s70, 16
s_lshl_b32 s71, s71, 13
s_add_u32 m0, s71, 98304
s_nop 0
buffer_load_dwordx4 v6, s[20:23], s70 offen lds
s_add_u32 m0, m0, 1024
s_add_u32 s70, s70, 8192
buffer_load_dwordx4 v6, s[20:23], s70 offen lds
s_add_u32 m0, m0, 1024
s_add_u32 s70, s70, 8192
buffer_load_dwordx4 v6, s[20:23], s70 offen lds
s_add_u32 m0, m0, 1024
s_add_u32 s70, s70, 8192
buffer_load_dwordx4 v6, s[20:23], s70 offen lds
s_add_u32 m0, m0, 1024
s_add_u32 s70, s70, 8192
buffer_load_dwordx4 v6, s[20:23], s70 offen lds
s_add_u32 m0, m0, 1024
s_add_u32 s70, s70, 8192
buffer_load_dwordx4 v6, s[20:23], s70 offen lds
s_add_u32 m0, m0, 1024
s_add_u32 s70, s70, 8192
buffer_load_dwordx4 v6, s[20:23], s70 offen lds
s_add_u32 m0, m0, 1024
s_add_u32 s70, s70, 8192
buffer_load_dwordx4 v6, s[20:23], s70 offen lds
s_barrier
s_barrier
s_waitcnt vmcnt(0)
s_barrier
s_barrier
s_barrier
s_barrier
s_barrier
s_barrier
s_add_u32 s70, s64, 0
s_and_b32 s70, s70, 7
s_mul_i32 s70, s70, 176128
s_mov_b32 m0, 65536
s_nop 0
buffer_load_dwordx4 v12, s[24:27], s70 offen lds
s_mov_b32 m0, 66560
s_nop 0
buffer_load_dwordx4 v13, s[24:27], s70 offen lds
s_mov_b32 m0, 67584
s_nop 0
buffer_load_dwordx4 v14, s[24:27], s70 offen lds
s_mov_b32 m0, 68608
s_nop 0
buffer_load_dwordx4 v15, s[24:27], s70 offen lds
s_mov_b32 m0, 69632
s_nop 0
buffer_load_dwordx4 v16, s[24:27], s70 offen lds
s_mov_b32 m0, 70656
s_nop 0
buffer_load_dwordx4 v17, s[24:27], s70 offen lds
s_mov_b32 m0, 71680
s_nop 0
buffer_load_dwordx4 v18, s[24:27], s70 offen lds
s_mov_b32 m0, 72704
s_nop 0
buffer_load_dwordx4 v19, s[24:27], s70 offen lds
s_mov_b32 m0, 73728
s_nop 0
buffer_load_dwordx4 v20, s[24:27], s70 offen lds
s_mov_b32 m0, 74752
s_nop 0
buffer_load_dwordx4 v21, s[24:27], s70 offen lds
s_mov_b32 m0, 75776
s_nop 0
buffer_load_dwordx4 v22, s[24:27], s70 offen lds
s_mov_b32 m0, 76800
s_nop 0
buffer_load_dwordx4 v23, s[24:27], s70 offen lds
s_add_u32 s70, s64, 1
s_and_b32 s70, s70, 7
s_mul_i32 s70, s70, 176128
s_mov_b32 m0, 77824
s_nop 0
buffer_load_dwordx4 v12, s[24:27], s70 offen lds
s_mov_b32 m0, 78848
s_nop 0
buffer_load_dwordx4 v13, s[24:27], s70 offen lds
s_mov_b32 m0, 79872
s_nop 0
buffer_load_dwordx4 v14, s[24:27], s70 offen lds
s_mov_b32 m0, 80896
s_nop 0
buffer_load_dwordx4 v15, s[24:27], s70 offen lds
s_mov_b32 m0, 81920
s_nop 0
buffer_load_dwordx4 v16, s[24:27], s70 offen lds
s_mov_b32 m0, 82944
s_nop 0
buffer_load_dwordx4 v17, s[24:27], s70 offen lds
s_mov_b32 m0, 83968
s_nop 0
buffer_load_dwordx4 v18, s[24:27], s70 offen lds
s_mov_b32 m0, 84992
s_nop 0
buffer_load_dwordx4 v19, s[24:27], s70 offen lds
s_mov_b32 m0, 86016
s_nop 0
buffer_load_dwordx4 v20, s[24:27], s70 offen lds
s_mov_b32 m0, 87040
s_nop 0
buffer_load_dwordx4 v21, s[24:27], s70 offen lds
s_mov_b32 m0, 88064
s_nop 0
buffer_load_dwordx4 v22, s[24:27], s70 offen lds
s_mov_b32 m0, 89088
s_nop 0
buffer_load_dwordx4 v23, s[24:27], s70 offen lds
s_barrier
s_lshr_b32 s68, s2, 3
s_lshl_b32 s70, s68, 6
s_add_u32 s70, s70, 18432
v_and_b32 v24, 15, v1
v_lshlrev_b32 v24, 2, v24
v_add_u32 v24, s70, v24
buffer_load_dword v25, v24, s[40:43], 0 offen sc1
s_barrier
s_barrier
s_waitcnt vmcnt(0)
v_cmp_ne_u32 vcc, s6, v25
s_nop 0
s_cbranch_vccz L_pdone_25
s_mov_b32 s79, 0
L_poll_24:
s_sleep 1
buffer_load_dword v25, v24, s[40:43], 0 offen sc1
s_add_u32 s79, s79, 1
s_cmp_gt_u32 s79, 200000
s_waitcnt vmcnt(0)
s_cbranch_scc1 L_pdone_25
v_cmp_ne_u32 vcc, s6, v25
s_nop 0
s_cbranch_vccnz L_poll_24
L_pdone_25:
s_lshr_b32 s68, s2, 3
s_and_b32 s69, s2, 7
s_lshl_b32 s70, s68, 11
s_lshl_b32 s71, s69, 8
s_add_u32 s70, s70, s71
s_add_u32 s70, s70, 1048576
v_lshlrev_b32 v24, 2, v1
buffer_load_dword v26, v24, s[40:43], s70 offen sc1
s_add_u32 s70, s70, 65536
buffer_load_dword v27, v24, s[40:43], s70 offen sc1
s_add_u32 s70, s70, 65536
buffer_load_dword v28, v24, s[40:43], s70 offen sc1
s_add_u32 s70, s70, 65536
buffer_load_dword v29, v24, s[40:43], s70 offen sc1
s_add_u32 s70, s70, 65536
buffer_load_dword v30, v24, s[40:43], s70 offen sc1
s_add_u32 s70, s70, 65536
buffer_load_dword v31, v24, s[40:43], s70 offen sc1
s_add_u32 s70, s70, 65536
buffer_load_dword v32, v24, s[40:43], s70 offen sc1
s_add_u32 s70, s70, 65536
buffer_load_dword v33, v24, s[40:43], s70 offen sc1
s_add_u32 s70, s70, 65536
buffer_load_dword v34, v24, s[40:43], s70 offen sc1
s_add_u32 s70, s70, 65536
buffer_load_dword v35, v24, s[40:43], s70 offen sc1
s_add_u32 s70, s70, 65536
buffer_load_dword v36, v24, s[40:43], s70 offen sc1
s_add_u32 s70, s70, 65536
buffer_load_dword v37, v24, s[40:43], s70 offen sc1
s_add_u32 s70, s70, 65536
buffer_load_dword v38, v24, s[40:43], s70 offen sc1
s_add_u32 s70, s70, 65536
buffer_load_dword v39, v24, s[40:43], s70 offen sc1
s_add_u32 s70, s70, 65536
buffer_load_dword v40, v24, s[40:43], s70 offen sc1
s_add_u32 s70, s70, 65536
buffer_load_dword v41, v24, s[40:43], s70 offen sc1
s_lshl_b32 s70, s68, 7
s_add_u32 s70, s70, 2097152
v_lshlrev_b32 v25, 2, v2
buffer_load_dword v42, v25, s[40:43], s70 offen sc1
s_add_u32 s70, s70, 4096
buffer_load_dword v43, v25, s[40:43], s70 offen sc1
s_add_u32 s70, s70, 4096
buffer_load_dword v44, v25, s[40:43], s70 offen sc1
s_add_u32 s70, s70, 4096
buffer_load_dword v45, v25, s[40:43], s70 offen sc1
s_add_u32 s70, s70, 4096
buffer_load_dword v46, v25, s[40:43], s70 offen sc1
s_add_u32 s70, s70, 4096
buffer_load_dword v47, v25, s[40:43], s70 offen sc1
s_add_u32 s70, s70, 4096
buffer_load_dword v48, v25, s[40:43], s70 offen sc1
s_add_u32 s70, s70, 4096
buffer_load_dword v49, v25, s[40:43], s70 offen sc1
s_add_u32 s70, s70, 4096
buffer_load_dword v50, v25, s[40:43], s70 offen sc1
s_add_u32 s70, s70, 4096
buffer_load_dword v51, v25, s[40:43], s70 offen sc1
s_add_u32 s70, s70, 4096
buffer_load_dword v52, v25, s[40:43], s70 offen sc1
s_add_u32 s70, s70, 4096
buffer_load_dword v53, v25, s[40:43], s70 offen sc1
s_add_u32 s70, s70, 4096
buffer_load_dword v54, v25, s[40:43], s70 offen sc1
s_add_u32 s70, s70, 4096
buffer_load_dword v55, v25, s[40:43], s70 offen sc1
s_add_u32 s70, s70, 4096
buffer_load_dword v56, v25, s[40:43], s70 offen sc1
s_add_u32 s70, s70, 4096
buffer_load_dword v57, v25, s[40:43], s70 offen sc1
s_add_u32 s70, s64, 2
s_and_b32 s70, s70, 7
s_mul_i32 s70, s70, 176128
s_mov_b32 m0, 0
s_nop 0
buffer_load_dwordx4 v12, s[24:27], s70 offen lds
s_mov_b32 m0, 1024
s_nop 0
buffer_load_dwordx4 v13, s[24:27], s70 offen lds
s_mov_b32 m0, 2048
s_nop 0
buffer_load_dwordx4 v14, s[24:27], s70 offen lds
s_mov_b32 m0, 3072
s_nop 0
buffer_load_dwordx4 v15, s[24:27], s70 offen lds
s_mov_b32 m0, 4096
s_nop 0
buffer_load_dwordx4 v16, s[24:27], s70 offen lds
s_mov_b32 m0, 5120
s_nop 0
buffer_load_dwordx4 v17, s[24:27], s70 offen lds
s_mov_b32 m0, 6144
s_nop 0
buffer_load_dwordx4 v18, s[24:27], s70 offen lds
s_mov_b32 m0, 7168
s_nop 0
buffer_load_dwordx4 v19, s[24:27], s70 offen lds
s_mov_b32 m0, 8192
s_nop 0
buffer_load_dwordx4 v20, s[24:27], s70 offen lds
s_mov_b32 m0, 9216
s_nop 0
buffer_load_dwordx4 v21, s[24:27], s70 offen lds
s_mov_b32 m0, 10240
s_nop 0
buffer_load_dwordx4 v22, s[24:27], s70 offen lds
s_mov_b32 m0, 11264
s_nop 0
buffer_load_dwordx4 v23, s[24:27], s70 offen lds
s_add_u32 s70, s64, 3
s_and_b32 s70, s70, 7
s_mul_i32 s70, s70, 176128
s_mov_b32 m0, 12288
s_nop 0
buffer_load_dwordx4 v12, s[24:27], s70 offen lds
s_mov_b32 m0, 13312
s_nop 0
buffer_load_dwordx4 v13, s[24:27], s70 offen lds
s_mov_b32 m0, 14336
s_nop 0
buffer_load_dwordx4 v14, s[24:27], s70 offen lds
s_mov_b32 m0, 15360
s_nop 0
buffer_load_dwordx4 v15, s[24:27], s70 offen lds
s_mov_b32 m0, 16384
s_nop 0
buffer_load_dwordx4 v16, s[24:27], s70 offen lds
s_mov_b32 m0, 17408
s_nop 0
buffer_load_dwordx4 v17, s[24:27], s70 offen lds
s_mov_b32 m0, 18432
s_nop 0
buffer_load_dwordx4 v18, s[24:27], s70 offen lds
s_mov_b32 m0, 19456
s_nop 0
buffer_load_dwordx4 v19, s[24:27], s70 offen lds
s_mov_b32 m0, 20480
s_nop 0
buffer_load_dwordx4 v20, s[24:27], s70 offen lds
s_mov_b32 m0, 21504
s_nop 0
buffer_load_dwordx4 v21, s[24:27], s70 offen lds
s_mov_b32 m0, 22528
s_nop 0
buffer_load_dwordx4 v22, s[24:27], s70 offen lds
s_mov_b32 m0, 23552
s_nop 0
buffer_load_dwordx4 v23, s[24:27], s70 offen lds
s_add_u32 s70, s64, 4
s_and_b32 s70, s70, 7
s_mul_i32 s70, s70, 176128
s_mov_b32 m0, 24576
s_nop 0
buffer_load_dwordx4 v12, s[24:27], s70 offen lds
s_mov_b32 m0, 25600
s_nop 0
buffer_load_dwordx4 v13, s[24:27], s70 offen lds
s_mov_b32 m0, 26624
s_nop 0
buffer_load_dwordx4 v14, s[24:27], s70 offen lds
s_mov_b32 m0, 27648
s_nop 0
buffer_load_dwordx4 v15, s[24:27], s70 offen lds
s_mov_b32 m0, 28672
s_nop 0
buffer_load_dwordx4 v16, s[24:27], s70 offen lds
s_mov_b32 m0, 29696
s_nop 0
buffer_load_dwordx4 v17, s[24:27], s70 offen lds
s_mov_b32 m0, 30720
s_nop 0
buffer_load_dwordx4 v18, s[24:27], s70 offen lds
s_mov_b32 m0, 31744
s_nop 0
buffer_load_dwordx4 v19, s[24:27], s70 offen lds
s_mov_b32 m0, 32768
s_nop 0
buffer_load_dwordx4 v20, s[24:27], s70 offen lds
s_mov_b32 m0, 33792
s_nop 0
buffer_load_dwordx4 v21, s[24:27], s70 offen lds
s_mov_b32 m0, 34816
s_nop 0
buffer_load_dwordx4 v22, s[24:27], s70 offen lds
s_mov_b32 m0, 35840
s_nop 0
buffer_load_dwordx4 v23, s[24:27], s70 offen lds
s_add_u32 s70, s64, 5
s_and_b32 s70, s70, 7
s_mul_i32 s70, s70, 176128
s_mov_b32 m0, 36864
s_nop 0
buffer_load_dwordx4 v12, s[24:27], s70 offen lds
s_mov_b32 m0, 37888
s_nop 0
buffer_load_dwordx4 v13, s[24:27], s70 offen lds
s_mov_b32 m0, 38912
s_nop 0
buffer_load_dwordx4 v14, s[24:27], s70 offen lds
s_mov_b32 m0, 39936
s_nop 0
buffer_load_dwordx4 v15, s[24:27], s70 offen lds
s_mov_b32 m0, 40960
s_nop 0
buffer_load_dwordx4 v16, s[24:27], s70 offen lds
s_mov_b32 m0, 41984
s_nop 0
buffer_load_dwordx4 v17, s[24:27], s70 offen lds
s_mov_b32 m0, 43008
s_nop 0
buffer_load_dwordx4 v18, s[24:27], s70 offen lds
s_mov_b32 m0, 44032
s_nop 0
buffer_load_dwordx4 v19, s[24:27], s70 offen lds
s_mov_b32 m0, 45056
s_nop 0
buffer_load_dwordx4 v20, s[24:27], s70 offen lds
s_mov_b32 m0, 46080
s_nop 0
buffer_load_dwordx4 v21, s[24:27], s70 offen lds
s_mov_b32 m0, 47104
s_nop 0
buffer_load_dwordx4 v22, s[24:27], s70 offen lds
s_mov_b32 m0, 48128
s_nop 0
buffer_load_dwordx4 v23, s[24:27], s70 offen lds
s_add_u32 s70, s64, 6
s_and_b32 s70, s70, 7
s_mul_i32 s70, s70, 176128
s_mov_b32 m0, 49152
s_nop 0
buffer_load_dwordx4 v12, s[24:27], s70 offen lds
s_mov_b32 m0, 50176
s_nop 0
buffer_load_dwordx4 v13, s[24:27], s70 offen lds
s_mov_b32 m0, 51200
s_nop 0
buffer_load_dwordx4 v14, s[24:27], s70 offen lds
s_mov_b32 m0, 52224
s_nop 0
buffer_load_dwordx4 v15, s[24:27], s70 offen lds
s_mov_b32 m0, 53248
s_nop 0
buffer_load_dwordx4 v16, s[24:27], s70 offen lds
s_mov_b32 m0, 54272
s_nop 0
buffer_load_dwordx4 v17, s[24:27], s70 offen lds
s_mov_b32 m0, 55296
s_nop 0
buffer_load_dwordx4 v18, s[24:27], s70 offen lds
s_mov_b32 m0, 56320
s_nop 0
buffer_load_dwordx4 v19, s[24:27], s70 offen lds
s_mov_b32 m0, 57344
s_nop 0
buffer_load_dwordx4 v20, s[24:27], s70 offen lds
s_mov_b32 m0, 58368
s_nop 0
buffer_load_dwordx4 v21, s[24:27], s70 offen lds
s_mov_b32 m0, 59392
s_nop 0
buffer_load_dwordx4 v22, s[24:27], s70 offen lds
s_mov_b32 m0, 60416
s_nop 0
buffer_load_dwordx4 v23, s[24:27], s70 offen lds
s_add_u32 s70, s64, 7
s_and_b32 s70, s70, 7
s_mul_i32 s70, s70, 176128
s_mov_b32 m0, 98304
s_nop 0
buffer_load_dwordx4 v12, s[24:27], s70 offen lds
s_mov_b32 m0, 99328
s_nop 0
buffer_load_dwordx4 v13, s[24:27], s70 offen lds
s_mov_b32 m0, 100352
s_nop 0
buffer_load_dwordx4 v14, s[24:27], s70 offen lds
s_mov_b32 m0, 101376
s_nop 0
buffer_load_dwordx4 v15, s[24:27], s70 offen lds
s_mov_b32 m0, 102400
s_nop 0
buffer_load_dwordx4 v16, s[24:27], s70 offen lds
s_mov_b32 m0, 103424
s_nop 0
buffer_load_dwordx4 v17, s[24:27], s70 offen lds
s_mov_b32 m0, 104448
s_nop 0
buffer_load_dwordx4 v18, s[24:27], s70 offen lds
s_mov_b32 m0, 105472
s_nop 0
buffer_load_dwordx4 v19, s[24:27], s70 offen lds
s_mov_b32 m0, 106496
s_nop 0
buffer_load_dwordx4 v20, s[24:27], s70 offen lds
s_mov_b32 m0, 107520
s_nop 0
buffer_load_dwordx4 v21, s[24:27], s70 offen lds
s_mov_b32 m0, 108544
s_nop 0
buffer_load_dwordx4 v22, s[24:27], s70 offen lds
s_mov_b32 m0, 109568
s_nop 0
buffer_load_dwordx4 v23, s[24:27], s70 offen lds
s_waitcnt vmcnt(63)
s_lshr_b32 s68, s2, 3
s_and_b32 s69, s2, 7
v_add_f32 v26, v26, v27
v_add_f32 v42, v42, v43
v_add_f32 v28, v28, v29
v_add_f32 v44, v44, v45
v_add_f32 v30, v30, v31
v_add_f32 v46, v46, v47
v_add_f32 v32, v32, v33
v_add_f32 v48, v48, v49
v_add_f32 v34, v34, v35
v_add_f32 v50, v50, v51
v_add_f32 v36, v36, v37
v_add_f32 v52, v52, v53
v_add_f32 v38, v38, v39
v_add_f32 v54, v54, v55
v_add_f32 v40, v40, v41
v_add_f32 v56, v56, v57
v_add_f32 v26, v26, v28
v_add_f32 v42, v42, v44
v_add_f32 v30, v30, v32
v_add_f32 v46, v46, v48
v_add_f32 v34, v34, v36
v_add_f32 v50, v50, v52
v_add_f32 v38, v38, v40
v_add_f32 v54, v54, v56
v_add_f32 v26, v26, v30
v_add_f32 v42, v42, v46
v_add_f32 v34, v34, v38
v_add_f32 v50, v50, v54
v_add_f32 v26, v26, v34
v_add_f32 v42, v42, v50
v_cvt_pk_bf16_f32 v26, v26, v26
v_cvt_pk_bf16_f32 v42, v42, v42
v_lshlrev_b32 v25, 1, v1
s_lshl_b32 s70, s68, 10
s_lshl_b32 s71, s69, 7
s_add_u32 s70, s70, s71
s_add_u32 s70, s70, 2162688
buffer_store_short v26, v25, s[40:43], s70 offen sc1
s_cmp_eq_u32 s69, 0
s_cbranch_scc0 L_noz_26
s_lshl_b32 s70, s68, 7
s_add_u32 s70, s70, 2195456
buffer_store_short v42, v25, s[40:43], s70 offen sc1
L_noz_26:
s_waitcnt vmcnt(1)
s_barrier
s_waitcnt vmcnt(0)
s_lshl_b32 s70, s2, 2
s_add_u32 s70, s70, 20480
v_mov_b32 v24, s6
v_mov_b32 v25, s70
s_mov_b64 exec, 1
buffer_store_dword v24, v25, s[40:43], 0 offen sc1
s_mov_b64 exec, -1
s_barrier
v_lshlrev_b32 v8, 3, v1
v_add_u32 v8, 90112, v8
s_mov_b32 exec_hi, 0xffff
ds_read_b64 v[104:105], v8 offset:0
ds_read_b64 v[106:107], v8 offset:384
ds_read_b64 v[108:109], v8 offset:768
ds_read_b64 v[110:111], v8 offset:1152
s_waitcnt lgkmcnt(0)
v_pk_add_f32 v[104:105], v[104:105], v[106:107]
v_pk_add_f32 v[108:109], v[108:109], v[110:111]
v_pk_add_f32 v[104:105], v[104:105], v[108:109]
ds_write_b64 v8, v[104:105] offset:2048
s_waitcnt lgkmcnt(0)
s_mov_b64 exec, -1
s_barrier
s_cmp_eq_u32 s2, 0
s_cbranch_scc0 L_fi_27
v_lshlrev_b32 v60, 5, v1
v_add_u32 v60, 4096, v60
buffer_load_dwordx4 v[64:67], v60, s[40:43], 0 offen sc1
buffer_load_dwordx4 v[68:71], v60, s[40:43], 0 offen offset:16 sc1
L_fi_27:
s_barrier
s_barrier
s_barrier
s_barrier
s_cmp_eq_u32 s2, 0
s_cbranch_scc0 L_fin_28
v_lshlrev_b32 v60, 5, v1
v_add_u32 v60, 4096, v60
s_mov_b32 s79, 0
s_waitcnt vmcnt(0)
s_branch L_ec_30
L_ep_29:
buffer_load_dwordx4 v[64:67], v60, s[40:43], 0 offen sc1
buffer_load_dwordx4 v[68:71], v60, s[40:43], 0 offen offset:16 sc1
s_add_u32 s79, s79, 1
s_cmp_gt_u32 s79, 200000
s_waitcnt vmcnt(0)
s_cbranch_scc1 L_fin_28
L_ec_30:
v_cmp_ne_u32 vcc, s6, v64
v_cmp_ne_u32 s[68:69], s6, v66
s_nop 1
s_or_b64 vcc, vcc, s[68:69]
v_cmp_ne_u32 s[68:69], s6, v68
s_nop 1
s_or_b64 vcc, vcc, s[68:69]
v_cmp_ne_u32 s[68:69], s6, v70
s_nop 1
s_or_b64 vcc, vcc, s[68:69]
s_cbranch_vccnz L_ep_29
v_mov_b32 v62, s6
v_mov_b32 v63, 0
s_mov_b64 exec, 1
buffer_store_dword v62, v63, s[40:43], 0 offen sc1
s_mov_b64 exec, -1
L_fin_28:
s_barrier
s_barrier
s_barrier
s_lshl_b32 s94, s76, 1
s_add_u32 s94, s94, s3
s_add_u32 s94, s94, s77
s_mov_b32 s95, s94
s_sub_u32 s70, s95, 5
s_cmp_ge_u32 s95, 5
s_cselect_b32 s95, s70, s95
s_sub_u32 s70, s95, 5
s_cmp_ge_u32 s95, 5
s_cselect_b32 s95, s70, s95
s_sub_u32 s70, s95, 5
s_cmp_ge_u32 s95, 5
s_cselect_b32 s95, s70, s95
s_sub_u32 s70, s95, 5
s_cmp_ge_u32 s95, 5
s_cselect_b32 s95, s70, s95
s_add_u32 s72, s94, 0
s_and_b32 s72, s72, 7
s_lshl_b32 s72, s72, 1
s_mul_i32 s68, s72, 3
s_add_u32 s68, s68, 0
s_lshl_b32 s71, s72, 1
s_add_u32 s71, s71, 11
s_cmp_lt_u32 s72, 11
s_cselect_b32 s68, s68, s71
s_add_u32 s72, s72, 1
s_mul_i32 s69, s72, 3
s_add_u32 s69, s69, 0
s_lshl_b32 s71, s72, 1
s_add_u32 s71, s71, 11
s_cmp_lt_u32 s72, 11
s_cselect_b32 s69, s69, s71
s_mov_b32 m0, 0
s_lshl_b32 s70, s68, 15
buffer_load_dwordx4 v6, s[28:31], s70 offen lds
s_add_u32 m0, m0, 1024
s_add_u32 s70, s70, 8192
buffer_load_dwordx4 v6, s[28:31], s70 offen lds
s_add_u32 m0, m0, 1024
s_add_u32 s70, s70, 8192
buffer_load_dwordx4 v6, s[28:31], s70 offen lds
s_add_u32 m0, m0, 1024
s_add_u32 s70, s70, 8192
buffer_load_dwordx4 v6, s[28:31], s70 offen lds
s_lshl_b32 s70, s69, 15
s_add_u32 m0, m0, 1024
s_nop 0
buffer_load_dwordx4 v6, s[28:31], s70 offen lds
s_add_u32 m0, m0, 1024
s_add_u32 s70, s70, 8192
buffer_load_dwordx4 v6, s[28:31], s70 offen lds
s_add_u32 m0, m0, 1024
s_add_u32 s70, s70, 8192
buffer_load_dwordx4 v6, s[28:31], s70 offen lds
s_add_u32 m0, m0, 1024
s_add_u32 s70, s70, 8192
buffer_load_dwordx4 v6, s[28:31], s70 offen lds
s_add_u32 s72, s94, 1
s_and_b32 s72, s72, 7
s_lshl_b32 s72, s72, 1
s_mul_i32 s68, s72, 3
s_add_u32 s68, s68, 0
s_lshl_b32 s71, s72, 1
s_add_u32 s71, s71, 11
s_cmp_lt_u32 s72, 11
s_cselect_b32 s68, s68, s71
s_add_u32 s72, s72, 1
s_mul_i32 s69, s72, 3
s_add_u32 s69, s69, 0
s_lshl_b32 s71, s72, 1
s_add_u32 s71, s71, 11
s_cmp_lt_u32 s72, 11
s_cselect_b32 s69, s69, s71
s_mov_b32 m0, 8192
s_lshl_b32 s70, s68, 15
buffer_load_dwordx4 v6, s[28:31], s70 offen lds
s_add_u32 m0, m0, 1024
s_add_u32 s70, s70, 8192
buffer_load_dwordx4 v6, s[28:31], s70 offen lds
s_add_u32 m0, m0, 1024
s_add_u32 s70, s70, 8192
buffer_load_dwordx4 v6, s[28:31], s70 offen lds
s_add_u32 m0, m0, 1024
s_add_u32 s70, s70, 8192
buffer_load_dwordx4 v6, s[28:31], s70 offen lds
s_lshl_b32 s70, s69, 15
s_add_u32 m0, m0, 1024
s_nop 0
buffer_load_dwordx4 v6, s[28:31], s70 offen lds
s_add_u32 m0, m0, 1024
s_add_u32 s70, s70, 8192
buffer_load_dwordx4 v6, s[28:31], s70 offen lds
s_add_u32 m0, m0, 1024
s_add_u32 s70, s70, 8192
buffer_load_dwordx4 v6, s[28:31], s70 offen lds
s_add_u32 m0, m0, 1024
s_add_u32 s70, s70, 8192
buffer_load_dwordx4 v6, s[28:31], s70 offen lds
s_add_u32 s72, s94, 2
s_and_b32 s72, s72, 7
s_lshl_b32 s72, s72, 1
s_mul_i32 s68, s72, 3
s_add_u32 s68, s68, 0
s_lshl_b32 s71, s72, 1
s_add_u32 s71, s71, 11
s_cmp_lt_u32 s72, 11
s_cselect_b32 s68, s68, s71
s_add_u32 s72, s72, 1
s_mul_i32 s69, s72, 3
s_add_u32 s69, s69, 0
s_lshl_b32 s71, s72, 1
s_add_u32 s71, s71, 11
s_cmp_lt_u32 s72, 11
s_cselect_b32 s69, s69, s71
s_mov_b32 m0, 16384
s_lshl_b32 s70, s68, 15
buffer_load_dwordx4 v6, s[28:31], s70 offen lds
s_add_u32 m0, m0, 1024
s_add_u32 s70, s70, 8192
buffer_load_dwordx4 v6, s[28:31], s70 offen lds
s_add_u32 m0, m0, 1024
s_add_u32 s70, s70, 8192
buffer_load_dwordx4 v6, s[28:31], s70 offen lds
s_add_u32 m0, m0, 1024
s_add_u32 s70, s70, 8192
buffer_load_dwordx4 v6, s[28:31], s70 offen lds
s_lshl_b32 s70, s69, 15
s_add_u32 m0, m0, 1024
s_nop 0
buffer_load_dwordx4 v6, s[28:31], s70 offen lds
s_add_u32 m0, m0, 1024
s_add_u32 s70, s70, 8192
buffer_load_dwordx4 v6, s[28:31], s70 offen lds
s_add_u32 m0, m0, 1024
s_add_u32 s70, s70, 8192
buffer_load_dwordx4 v6, s[28:31], s70 offen lds
s_add_u32 m0, m0, 1024
s_add_u32 s70, s70, 8192
buffer_load_dwordx4 v6, s[28:31], s70 offen lds
s_add_u32 s72, s94, 3
s_and_b32 s72, s72, 7
s_lshl_b32 s72, s72, 1
s_mul_i32 s68, s72, 3
s_add_u32 s68, s68, 0
s_lshl_b32 s71, s72, 1
s_add_u32 s71, s71, 11
s_cmp_lt_u32 s72, 11
s_cselect_b32 s68, s68, s71
s_add_u32 s72, s72, 1
s_mul_i32 s69, s72, 3
s_add_u32 s69, s69, 0
s_lshl_b32 s71, s72, 1
s_add_u32 s71, s71, 11
s_cmp_lt_u32 s72, 11
s_cselect_b32 s69, s69, s71
s_mov_b32 m0, 24576
s_lshl_b32 s70, s68, 15
buffer_load_dwordx4 v6, s[28:31], s70 offen lds
s_add_u32 m0, m0, 1024
s_add_u32 s70, s70, 8192
buffer_load_dwordx4 v6, s[28:31], s70 offen lds
s_add_u32 m0, m0, 1024
s_add_u32 s70, s70, 8192
buffer_load_dwordx4 v6, s[28:31], s70 offen lds
s_add_u32 m0, m0, 1024
s_add_u32 s70, s70, 8192
buffer_load_dwordx4 v6, s[28:31], s70 offen lds
s_lshl_b32 s70, s69, 15
s_add_u32 m0, m0, 1024
s_nop 0
buffer_load_dwordx4 v6, s[28:31], s70 offen lds
s_add_u32 m0, m0, 1024
s_add_u32 s70, s70, 8192
buffer_load_dwordx4 v6, s[28:31], s70 offen lds
s_add_u32 m0, m0, 1024
s_add_u32 s70, s70, 8192
buffer_load_dwordx4 v6, s[28:31], s70 offen lds
s_add_u32 m0, m0, 1024
s_add_u32 s70, s70, 8192
buffer_load_dwordx4 v6, s[28:31], s70 offen lds
s_add_u32 s72, s94, 4
s_and_b32 s72, s72, 7
s_lshl_b32 s72, s72, 1
s_mul_i32 s68, s72, 3
s_add_u32 s68, s68, 0
s_lshl_b32 s71, s72, 1
s_add_u32 s71, s71, 11
s_cmp_lt_u32 s72, 11
s_cselect_b32 s68, s68, s71
s_add_u32 s72, s72, 1
s_mul_i32 s69, s72, 3
s_add_u32 s69, s69, 0
s_lshl_b32 s71, s72, 1
s_add_u32 s71, s71, 11
s_cmp_lt_u32 s72, 11
s_cselect_b32 s69, s69, s71
s_mov_b32 m0, 32768
s_lshl_b32 s70, s68, 15
buffer_load_dwordx4 v6, s[28:31], s70 offen lds
s_add_u32 m0, m0, 1024
s_add_u32 s70, s70, 8192
buffer_load_dwordx4 v6, s[28:31], s70 offen lds
s_add_u32 m0, m0, 1024
s_add_u32 s70, s70, 8192
buffer_load_dwordx4 v6, s[28:31], s70 offen lds
s_add_u32 m0, m0, 1024
s_add_u32 s70, s70, 8192
buffer_load_dwordx4 v6, s[28:31], s70 offen lds
s_lshl_b32 s70, s69, 15
s_add_u32 m0, m0, 1024
s_nop 0
buffer_load_dwordx4 v6, s[28:31], s70 offen lds
s_add_u32 m0, m0, 1024
s_add_u32 s70, s70, 8192
buffer_load_dwordx4 v6, s[28:31], s70 offen lds
s_add_u32 m0, m0, 1024
s_add_u32 s70, s70, 8192
buffer_load_dwordx4 v6, s[28:31], s70 offen lds
s_add_u32 m0, m0, 1024
s_add_u32 s70, s70, 8192
buffer_load_dwordx4 v6, s[28:31], s70 offen lds
s_add_u32 s72, s94, 5
s_and_b32 s72, s72, 7
s_lshl_b32 s72, s72, 1
s_mul_i32 s68, s72, 3
s_add_u32 s68, s68, 0
s_lshl_b32 s71, s72, 1
s_add_u32 s71, s71, 11
s_cmp_lt_u32 s72, 11
s_cselect_b32 s68, s68, s71
s_add_u32 s72, s72, 1
s_mul_i32 s69, s72, 3
s_add_u32 s69, s69, 0
s_lshl_b32 s71, s72, 1
s_add_u32 s71, s71, 11
s_cmp_lt_u32 s72, 11
s_cselect_b32 s69, s69, s71
s_mov_b32 m0, 40960
s_lshl_b32 s70, s68, 15
buffer_load_dwordx4 v6, s[28:31], s70 offen lds
s_add_u32 m0, m0, 1024
s_add_u32 s70, s70, 8192
buffer_load_dwordx4 v6, s[28:31], s70 offen lds
s_add_u32 m0, m0, 1024
s_add_u32 s70, s70, 8192
buffer_load_dwordx4 v6, s[28:31], s70 offen lds
s_add_u32 m0, m0, 1024
s_add_u32 s70, s70, 8192
buffer_load_dwordx4 v6, s[28:31], s70 offen lds
s_lshl_b32 s70, s69, 15
s_add_u32 m0, m0, 1024
s_nop 0
buffer_load_dwordx4 v6, s[28:31], s70 offen lds
s_add_u32 m0, m0, 1024
s_add_u32 s70, s70, 8192
buffer_load_dwordx4 v6, s[28:31], s70 offen lds
s_add_u32 m0, m0, 1024
s_add_u32 s70, s70, 8192
buffer_load_dwordx4 v6, s[28:31], s70 offen lds
s_add_u32 m0, m0, 1024
s_add_u32 s70, s70, 8192
buffer_load_dwordx4 v6, s[28:31], s70 offen lds
s_waitcnt vmcnt(40)
s_barrier
s_add_u32 s72, s94, 6
s_and_b32 s72, s72, 7
s_lshl_b32 s72, s72, 1
s_mul_i32 s68, s72, 3
s_add_u32 s68, s68, 0
s_lshl_b32 s71, s72, 1
s_add_u32 s71, s71, 11
s_cmp_lt_u32 s72, 11
s_cselect_b32 s68, s68, s71
s_add_u32 s72, s72, 1
s_mul_i32 s69, s72, 3
s_add_u32 s69, s69, 0
s_lshl_b32 s71, s72, 1
s_add_u32 s71, s71, 11
s_cmp_lt_u32 s72, 11
s_cselect_b32 s69, s69, s71
s_mov_b32 m0, 49152
s_lshl_b32 s70, s68, 15
buffer_load_dwordx4 v6, s[28:31], s70 offen lds
s_add_u32 m0, m0, 1024
s_add_u32 s70, s70, 8192
buffer_load_dwordx4 v6, s[28:31], s70 offen lds
s_add_u32 m0, m0, 1024
s_add_u32 s70, s70, 8192
buffer_load_dwordx4 v6, s[28:31], s70 offen lds
s_add_u32 m0, m0, 1024
s_add_u32 s70, s70, 8192
buffer_load_dwordx4 v6, s[28:31], s70 offen lds
s_lshl_b32 s70, s69, 15
s_add_u32 m0, m0, 1024
s_nop 0
buffer_load_dwordx4 v6, s[28:31], s70 offen lds
s_add_u32 m0, m0, 1024
s_add_u32 s70, s70, 8192
buffer_load_dwordx4 v6, s[28:31], s70 offen lds
s_add_u32 m0, m0, 1024
s_add_u32 s70, s70, 8192
buffer_load_dwordx4 v6, s[28:31], s70 offen lds
s_add_u32 m0, m0, 1024
s_add_u32 s70, s70, 8192
buffer_load_dwordx4 v6, s[28:31], s70 offen lds
s_add_u32 s72, s94, 7
s_and_b32 s72, s72, 7
s_lshl_b32 s72, s72, 1
s_mul_i32 s68, s72, 3
s_add_u32 s68, s68, 0
s_lshl_b32 s71, s72, 1
s_add_u32 s71, s71, 11
s_cmp_lt_u32 s72, 11
s_cselect_b32 s68, s68, s71
s_add_u32 s72, s72, 1
s_mul_i32 s69, s72, 3
s_add_u32 s69, s69, 0
s_lshl_b32 s71, s72, 1
s_add_u32 s71, s71, 11
s_cmp_lt_u32 s72, 11
s_cselect_b32 s69, s69, s71
s_mov_b32 m0, 57344
s_lshl_b32 s70, s68, 15
buffer_load_dwordx4 v6, s[28:31], s70 offen lds
s_add_u32 m0, m0, 1024
s_add_u32 s70, s70, 8192
buffer_load_dwordx4 v6, s[28:31], s70 offen lds
s_add_u32 m0, m0, 1024
s_add_u32 s70, s70, 8192
buffer_load_dwordx4 v6, s[28:31], s70 offen lds
s_add_u32 m0, m0, 1024
s_add_u32 s70, s70, 8192
buffer_load_dwordx4 v6, s[28:31], s70 offen lds
s_lshl_b32 s70, s69, 15
s_add_u32 m0, m0, 1024
s_nop 0
buffer_load_dwordx4 v6, s[28:31], s70 offen lds
s_add_u32 m0, m0, 1024
s_add_u32 s70, s70, 8192
buffer_load_dwordx4 v6, s[28:31], s70 offen lds
s_add_u32 m0, m0, 1024
s_add_u32 s70, s70, 8192
buffer_load_dwordx4 v6, s[28:31], s70 offen lds
s_add_u32 m0, m0, 1024
s_add_u32 s70, s70, 8192
buffer_load_dwordx4 v6, s[28:31], s70 offen lds
s_waitcnt vmcnt(48)
s_barrier
s_add_u32 s72, s94, 0
s_and_b32 s72, s72, 7
s_lshl_b32 s72, s72, 1
s_mul_i32 s68, s72, 3
s_add_u32 s68, s68, 1
s_lshl_b32 s71, s72, 1
s_add_u32 s71, s71, 12
s_cmp_lt_u32 s72, 11
s_cselect_b32 s68, s68, s71
s_add_u32 s72, s72, 1
s_mul_i32 s69, s72, 3
s_add_u32 s69, s69, 1
s_lshl_b32 s71, s72, 1
s_add_u32 s71, s71, 12
s_cmp_lt_u32 s72, 11
s_cselect_b32 s69, s69, s71
s_mov_b32 m0, 65536
s_lshl_b32 s70, s68, 15
buffer_load_dwordx4 v6, s[28:31], s70 offen lds
s_add_u32 m0, m0, 1024
s_add_u32 s70, s70, 8192
buffer_load_dwordx4 v6, s[28:31], s70 offen lds
s_add_u32 m0, m0, 1024
s_add_u32 s70, s70, 8192
buffer_load_dwordx4 v6, s[28:31], s70 offen lds
s_add_u32 m0, m0, 1024
s_add_u32 s70, s70, 8192
buffer_load_dwordx4 v6, s[28:31], s70 offen lds
s_lshl_b32 s70, s69, 15
s_add_u32 m0, m0, 1024
s_nop 0
buffer_load_dwordx4 v6, s[28:31], s70 offen lds
s_add_u32 m0, m0, 1024
s_add_u32 s70, s70, 8192
buffer_load_dwordx4 v6, s[28:31], s70 offen lds
s_add_u32 m0, m0, 1024
s_add_u32 s70, s70, 8192
buffer_load_dwordx4 v6, s[28:31], s70 offen lds
s_add_u32 m0, m0, 1024
s_add_u32 s70, s70, 8192
buffer_load_dwordx4 v6, s[28:31], s70 offen lds
s_add_u32 s72, s94, 1
s_and_b32 s72, s72, 7
s_lshl_b32 s72, s72, 1
s_mul_i32 s68, s72, 3
s_add_u32 s68, s68, 1
s_lshl_b32 s71, s72, 1
s_add_u32 s71, s71, 12
s_cmp_lt_u32 s72, 11
s_cselect_b32 s68, s68, s71
s_add_u32 s72, s72, 1
s_mul_i32 s69, s72, 3
s_add_u32 s69, s69, 1
s_lshl_b32 s71, s72, 1
s_add_u32 s71, s71, 12
s_cmp_lt_u32 s72, 11
s_cselect_b32 s69, s69, s71
s_mov_b32 m0, 73728
s_lshl_b32 s70, s68, 15
buffer_load_dwordx4 v6, s[28:31], s70 offen lds
s_add_u32 m0, m0, 1024
s_add_u32 s70, s70, 8192
buffer_load_dwordx4 v6, s[28:31], s70 offen lds
s_add_u32 m0, m0, 1024
s_add_u32 s70, s70, 8192
buffer_load_dwordx4 v6, s[28:31], s70 offen lds
s_add_u32 m0, m0, 1024
s_add_u32 s70, s70, 8192
buffer_load_dwordx4 v6, s[28:31], s70 offen lds
s_lshl_b32 s70, s69, 15
s_add_u32 m0, m0, 1024
s_nop 0
buffer_load_dwordx4 v6, s[28:31], s70 offen lds
s_add_u32 m0, m0, 1024
s_add_u32 s70, s70, 8192
buffer_load_dwordx4 v6, s[28:31], s70 offen lds
s_add_u32 m0, m0, 1024
s_add_u32 s70, s70, 8192
buffer_load_dwordx4 v6, s[28:31], s70 offen lds
s_add_u32 m0, m0, 1024
s_add_u32 s70, s70, 8192
buffer_load_dwordx4 v6, s[28:31], s70 offen lds
s_waitcnt vmcnt(56)
s_barrier
s_add_u32 s72, s94, 2
s_and_b32 s72, s72, 7
s_lshl_b32 s72, s72, 1
s_mul_i32 s68, s72, 3
s_add_u32 s68, s68, 1
s_lshl_b32 s71, s72, 1
s_add_u32 s71, s71, 12
s_cmp_lt_u32 s72, 11
s_cselect_b32 s68, s68, s71
s_add_u32 s72, s72, 1
s_mul_i32 s69, s72, 3
s_add_u32 s69, s69, 1
s_lshl_b32 s71, s72, 1
s_add_u32 s71, s71, 12
s_cmp_lt_u32 s72, 11
s_cselect_b32 s69, s69, s71
s_mov_b32 m0, 81920
s_lshl_b32 s70, s68, 15
buffer_load_dwordx4 v6, s[28:31], s70 offen lds
s_add_u32 m0, m0, 1024
s_add_u32 s70, s70, 8192
buffer_load_dwordx4 v6, s[28:31], s70 offen lds
s_add_u32 m0, m0, 1024
s_add_u32 s70, s70, 8192
buffer_load_dwordx4 v6, s[28:31], s70 offen lds
s_add_u32 m0, m0, 1024
s_add_u32 s70, s70, 8192
buffer_load_dwordx4 v6, s[28:31], s70 offen lds
s_lshl_b32 s70, s69, 15
s_add_u32 m0, m0, 1024
s_nop 0
buffer_load_dwordx4 v6, s[28:31], s70 offen lds
s_add_u32 m0, m0, 1024
s_add_u32 s70, s70, 8192
buffer_load_dwordx4 v6, s[28:31], s70 offen lds
s_add_u32 m0, m0, 1024
s_add_u32 s70, s70, 8192
buffer_load_dwordx4 v6, s[28:31], s70 offen lds
s_add_u32 m0, m0, 1024
s_add_u32 s70, s70, 8192
buffer_load_dwordx4 v6, s[28:31], s70 offen lds
s_waitcnt vmcnt(56)
s_barrier
s_add_u32 s72, s94, 3
s_and_b32 s72, s72, 7
s_lshl_b32 s72, s72, 1
s_mul_i32 s68, s72, 3
s_add_u32 s68, s68, 1
s_lshl_b32 s71, s72, 1
s_add_u32 s71, s71, 12
s_cmp_lt_u32 s72, 11
s_cselect_b32 s68, s68, s71
s_add_u32 s72, s72, 1
s_mul_i32 s69, s72, 3
s_add_u32 s69, s69, 1
s_lshl_b32 s71, s72, 1
s_add_u32 s71, s71, 12
s_cmp_lt_u32 s72, 11
s_cselect_b32 s69, s69, s71
s_mov_b32 m0, 90112
s_lshl_b32 s70, s68, 15
buffer_load_dwordx4 v6, s[28:31], s70 offen lds
s_add_u32 m0, m0, 1024
s_add_u32 s70, s70, 8192
buffer_load_dwordx4 v6, s[28:31], s70 offen lds
s_add_u32 m0, m0, 1024
s_add_u32 s70, s70, 8192
buffer_load_dwordx4 v6, s[28:31], s70 offen lds
s_add_u32 m0, m0, 1024
s_add_u32 s70, s70, 8192
buffer_load_dwordx4 v6, s[28:31], s70 offen lds
s_lshl_b32 s70, s69, 15
s_add_u32 m0, m0, 1024
s_nop 0
buffer_load_dwordx4 v6, s[28:31], s70 offen lds
s_add_u32 m0, m0, 1024
s_add_u32 s70, s70, 8192
buffer_load_dwordx4 v6, s[28:31], s70 offen lds
s_add_u32 m0, m0, 1024
s_add_u32 s70, s70, 8192
buffer_load_dwordx4 v6, s[28:31], s70 offen lds
s_add_u32 m0, m0, 1024
s_add_u32 s70, s70, 8192
buffer_load_dwordx4 v6, s[28:31], s70 offen lds
s_waitcnt vmcnt(56)
s_barrier
s_add_u32 s72, s94, 4
s_and_b32 s72, s72, 7
s_lshl_b32 s72, s72, 1
s_mul_i32 s68, s72, 3
s_add_u32 s68, s68, 1
s_lshl_b32 s71, s72, 1
s_add_u32 s71, s71, 12
s_cmp_lt_u32 s72, 11
s_cselect_b32 s68, s68, s71
s_add_u32 s72, s72, 1
s_mul_i32 s69, s72, 3
s_add_u32 s69, s69, 1
s_lshl_b32 s71, s72, 1
s_add_u32 s71, s71, 12
s_cmp_lt_u32 s72, 11
s_cselect_b32 s69, s69, s71
s_mov_b32 m0, 0
s_lshl_b32 s70, s68, 15
buffer_load_dwordx4 v6, s[28:31], s70 offen lds
s_add_u32 m0, m0, 1024
s_add_u32 s70, s70, 8192
buffer_load_dwordx4 v6, s[28:31], s70 offen lds
s_add_u32 m0, m0, 1024
s_add_u32 s70, s70, 8192
buffer_load_dwordx4 v6, s[28:31], s70 offen lds
s_add_u32 m0, m0, 1024
s_add_u32 s70, s70, 8192
buffer_load_dwordx4 v6, s[28:31], s70 offen lds
s_lshl_b32 s70, s69, 15
s_add_u32 m0, m0, 1024
s_nop 0
buffer_load_dwordx4 v6, s[28:31], s70 offen lds
s_add_u32 m0, m0, 1024
s_add_u32 s70, s70, 8192
buffer_load_dwordx4 v6, s[28:31], s70 offen lds
s_add_u32 m0, m0, 1024
s_add_u32 s70, s70, 8192
buffer_load_dwordx4 v6, s[28:31], s70 offen lds
s_add_u32 m0, m0, 1024
s_add_u32 s70, s70, 8192
buffer_load_dwordx4 v6, s[28:31], s70 offen lds
s_waitcnt vmcnt(56)
s_barrier
s_add_u32 s72, s94, 5
s_and_b32 s72, s72, 7
s_lshl_b32 s72, s72, 1
s_mul_i32 s68, s72, 3
s_add_u32 s68, s68, 1
s_lshl_b32 s71, s72, 1
s_add_u32 s71, s71, 12
s_cmp_lt_u32 s72, 11
s_cselect_b32 s68, s68, s71
s_add_u32 s72, s72, 1
s_mul_i32 s69, s72, 3
s_add_u32 s69, s69, 1
s_lshl_b32 s71, s72, 1
s_add_u32 s71, s71, 12
s_cmp_lt_u32 s72, 11
s_cselect_b32 s69, s69, s71
s_mov_b32 m0, 8192
s_lshl_b32 s70, s68, 15
buffer_load_dwordx4 v6, s[28:31], s70 offen lds
s_add_u32 m0, m0, 1024
s_add_u32 s70, s70, 8192
buffer_load_dwordx4 v6, s[28:31], s70 offen lds
s_add_u32 m0, m0, 1024
s_add_u32 s70, s70, 8192
buffer_load_dwordx4 v6, s[28:31], s70 offen lds
s_add_u32 m0, m0, 1024
s_add_u32 s70, s70, 8192
buffer_load_dwordx4 v6, s[28:31], s70 offen lds
s_lshl_b32 s70, s69, 15
s_add_u32 m0, m0, 1024
s_nop 0
buffer_load_dwordx4 v6, s[28:31], s70 offen lds
s_add_u32 m0, m0, 1024
s_add_u32 s70, s70, 8192
buffer_load_dwordx4 v6, s[28:31], s70 offen lds
s_add_u32 m0, m0, 1024
s_add_u32 s70, s70, 8192
buffer_load_dwordx4 v6, s[28:31], s70 offen lds
s_add_u32 m0, m0, 1024
s_add_u32 s70, s70, 8192
buffer_load_dwordx4 v6, s[28:31], s70 offen lds
s_waitcnt vmcnt(56)
s_barrier
s_add_u32 s72, s94, 6
s_and_b32 s72, s72, 7
s_lshl_b32 s72, s72, 1
s_mul_i32 s68, s72, 3
s_add_u32 s68, s68, 1
s_lshl_b32 s71, s72, 1
s_add_u32 s71, s71, 12
s_cmp_lt_u32 s72, 11
s_cselect_b32 s68, s68, s71
s_add_u32 s72, s72, 1
s_mul_i32 s69, s72, 3
s_add_u32 s69, s69, 1
s_lshl_b32 s71, s72, 1
s_add_u32 s71, s71, 12
s_cmp_lt_u32 s72, 11
s_cselect_b32 s69, s69, s71
s_mov_b32 m0, 16384
s_lshl_b32 s70, s68, 15
buffer_load_dwordx4 v6, s[28:31], s70 offen lds
s_add_u32 m0, m0, 1024
s_add_u32 s70, s70, 8192
buffer_load_dwordx4 v6, s[28:31], s70 offen lds
s_add_u32 m0, m0, 1024
s_add_u32 s70, s70, 8192
buffer_load_dwordx4 v6, s[28:31], s70 offen lds
s_add_u32 m0, m0, 1024
s_add_u32 s70, s70, 8192
buffer_load_dwordx4 v6, s[28:31], s70 offen lds
s_lshl_b32 s70, s69, 15
s_add_u32 m0, m0, 1024
s_nop 0
buffer_load_dwordx4 v6, s[28:31], s70 offen lds
s_add_u32 m0, m0, 1024
s_add_u32 s70, s70, 8192
buffer_load_dwordx4 v6, s[28:31], s70 offen lds
s_add_u32 m0, m0, 1024
s_add_u32 s70, s70, 8192
buffer_load_dwordx4 v6, s[28:31], s70 offen lds
s_add_u32 m0, m0, 1024
s_add_u32 s70, s70, 8192
buffer_load_dwordx4 v6, s[28:31], s70 offen lds
s_waitcnt vmcnt(56)
s_barrier
s_add_u32 s72, s94, 7
s_and_b32 s72, s72, 7
s_lshl_b32 s72, s72, 1
s_mul_i32 s68, s72, 3
s_add_u32 s68, s68, 1
s_lshl_b32 s71, s72, 1
s_add_u32 s71, s71, 12
s_cmp_lt_u32 s72, 11
s_cselect_b32 s68, s68, s71
s_add_u32 s72, s72, 1
s_mul_i32 s69, s72, 3
s_add_u32 s69, s69, 1
s_lshl_b32 s71, s72, 1
s_add_u32 s71, s71, 12
s_cmp_lt_u32 s72, 11
s_cselect_b32 s69, s69, s71
s_mov_b32 m0, 24576
s_lshl_b32 s70, s68, 15
buffer_load_dwordx4 v6, s[28:31], s70 offen lds
s_add_u32 m0, m0, 1024
s_add_u32 s70, s70, 8192
buffer_load_dwordx4 v6, s[28:31], s70 offen lds
s_add_u32 m0, m0, 1024
s_add_u32 s70, s70, 8192
buffer_load_dwordx4 v6, s[28:31], s70 offen lds
s_add_u32 m0, m0, 1024
s_add_u32 s70, s70, 8192
buffer_load_dwordx4 v6, s[28:31], s70 offen lds
s_lshl_b32 s70, s69, 15
s_add_u32 m0, m0, 1024
s_nop 0
buffer_load_dwordx4 v6, s[28:31], s70 offen lds
s_add_u32 m0, m0, 1024
s_add_u32 s70, s70, 8192
buffer_load_dwordx4 v6, s[28:31], s70 offen lds
s_add_u32 m0, m0, 1024
s_add_u32 s70, s70, 8192
buffer_load_dwordx4 v6, s[28:31], s70 offen lds
s_add_u32 m0, m0, 1024
s_add_u32 s70, s70, 8192
buffer_load_dwordx4 v6, s[28:31], s70 offen lds
s_waitcnt vmcnt(56)
s_barrier
s_add_u32 s72, s95, 0
s_sub_u32 s71, s72, 5
s_cmp_ge_u32 s72, 5
s_cselect_b32 s72, s71, s72
s_mul_i32 s68, s72, 6
s_add_u32 s68, s68, 2
s_add_u32 s69, s68, 3
s_mov_b32 m0, 32768
s_lshl_b32 s70, s68, 15
buffer_load_dwordx4 v6, s[28:31], s70 offen lds
s_add_u32 m0, m0, 1024
s_add_u32 s70, s70, 8192
buffer_load_dwordx4 v6, s[28:31], s70 offen lds
s_add_u32 m0, m0, 1024
s_add_u32 s70, s70, 8192
buffer_load_dwordx4 v6, s[28:31], s70 offen lds
s_add_u32 m0, m0, 1024
s_add_u32 s70, s70, 8192
buffer_load_dwordx4 v6, s[28:31], s70 offen lds
s_lshl_b32 s70, s69, 15
s_add_u32 m0, m0, 1024
s_nop 0
buffer_load_dwordx4 v6, s[28:31], s70 offen lds
s_add_u32 m0, m0, 1024
s_add_u32 s70, s70, 8192
buffer_load_dwordx4 v6, s[28:31], s70 offen lds
s_add_u32 m0, m0, 1024
s_add_u32 s70, s70, 8192
buffer_load_dwordx4 v6, s[28:31], s70 offen lds
s_add_u32 m0, m0, 1024
s_add_u32 s70, s70, 8192
buffer_load_dwordx4 v6, s[28:31], s70 offen lds
s_waitcnt vmcnt(56)
s_barrier
s_add_u32 s72, s95, 1
s_sub_u32 s71, s72, 5
s_cmp_ge_u32 s72, 5
s_cselect_b32 s72, s71, s72
s_mul_i32 s68, s72, 6
s_add_u32 s68, s68, 2
s_add_u32 s69, s68, 3
s_mov_b32 m0, 40960
s_lshl_b32 s70, s68, 15
buffer_load_dwordx4 v6, s[28:31], s70 offen lds
s_add_u32 m0, m0, 1024
s_add_u32 s70, s70, 8192
buffer_load_dwordx4 v6, s[28:31], s70 offen lds
s_add_u32 m0, m0, 1024
s_add_u32 s70, s70, 8192
buffer_load_dwordx4 v6, s[28:31], s70 offen lds
s_add_u32 m0, m0, 1024
s_add_u32 s70, s70, 8192
buffer_load_dwordx4 v6, s[28:31], s70 offen lds
s_lshl_b32 s70, s69, 15
s_add_u32 m0, m0, 1024
s_nop 0
buffer_load_dwordx4 v6, s[28:31], s70 offen lds
s_add_u32 m0, m0, 1024
s_add_u32 s70, s70, 8192
buffer_load_dwordx4 v6, s[28:31], s70 offen lds
s_add_u32 m0, m0, 1024
s_add_u32 s70, s70, 8192
buffer_load_dwordx4 v6, s[28:31], s70 offen lds
s_add_u32 m0, m0, 1024
s_add_u32 s70, s70, 8192
buffer_load_dwordx4 v6, s[28:31], s70 offen lds
s_waitcnt vmcnt(56)
s_barrier
s_add_u32 s72, s95, 2
s_sub_u32 s71, s72, 5
s_cmp_ge_u32 s72, 5
s_cselect_b32 s72, s71, s72
s_mul_i32 s68, s72, 6
s_add_u32 s68, s68, 2
s_add_u32 s69, s68, 3
s_mov_b32 m0, 49152
s_lshl_b32 s70, s68, 15
buffer_load_dwordx4 v6, s[28:31], s70 offen lds
s_add_u32 m0, m0, 1024
s_add_u32 s70, s70, 8192
buffer_load_dwordx4 v6, s[28:31], s70 offen lds
s_add_u32 m0, m0, 1024
s_add_u32 s70, s70, 8192
buffer_load_dwordx4 v6, s[28:31], s70 offen lds
s_add_u32 m0, m0, 1024
s_add_u32 s70, s70, 8192
buffer_load_dwordx4 v6, s[28:31], s70 offen lds
s_lshl_b32 s70, s69, 15
s_add_u32 m0, m0, 1024
s_nop 0
buffer_load_dwordx4 v6, s[28:31], s70 offen lds
s_add_u32 m0, m0, 1024
s_add_u32 s70, s70, 8192
buffer_load_dwordx4 v6, s[28:31], s70 offen lds
s_add_u32 m0, m0, 1024
s_add_u32 s70, s70, 8192
buffer_load_dwordx4 v6, s[28:31], s70 offen lds
s_add_u32 m0, m0, 1024
s_add_u32 s70, s70, 8192
buffer_load_dwordx4 v6, s[28:31], s70 offen lds
s_waitcnt vmcnt(56)
s_barrier
s_add_u32 s72, s95, 3
s_sub_u32 s71, s72, 5
s_cmp_ge_u32 s72, 5
s_cselect_b32 s72, s71, s72
s_mul_i32 s68, s72, 6
s_add_u32 s68, s68, 2
s_add_u32 s69, s68, 3
s_mov_b32 m0, 57344
s_lshl_b32 s70, s68, 15
buffer_load_dwordx4 v6, s[28:31], s70 offen lds
s_add_u32 m0, m0, 1024
s_add_u32 s70, s70, 8192
buffer_load_dwordx4 v6, s[28:31], s70 offen lds
s_add_u32 m0, m0, 1024
s_add_u32 s70, s70, 8192
buffer_load_dwordx4 v6, s[28:31], s70 offen lds
s_add_u32 m0, m0, 1024
s_add_u32 s70, s70, 8192
buffer_load_dwordx4 v6, s[28:31], s70 offen lds
s_lshl_b32 s70, s69, 15
s_add_u32 m0, m0, 1024
s_nop 0
buffer_load_dwordx4 v6, s[28:31], s70 offen lds
s_add_u32 m0, m0, 1024
s_add_u32 s70, s70, 8192
buffer_load_dwordx4 v6, s[28:31], s70 offen lds
s_add_u32 m0, m0, 1024
s_add_u32 s70, s70, 8192
buffer_load_dwordx4 v6, s[28:31], s70 offen lds
s_add_u32 m0, m0, 1024
s_add_u32 s70, s70, 8192
buffer_load_dwordx4 v6, s[28:31], s70 offen lds
s_waitcnt vmcnt(56)
s_barrier
s_add_u32 s72, s95, 4
s_sub_u32 s71, s72, 5
s_cmp_ge_u32 s72, 5
s_cselect_b32 s72, s71, s72
s_mul_i32 s68, s72, 6
s_add_u32 s68, s68, 2
s_add_u32 s69, s68, 3
s_mov_b32 m0, 65536
s_lshl_b32 s70, s68, 15
buffer_load_dwordx4 v6, s[28:31], s70 offen lds
s_add_u32 m0, m0, 1024
s_add_u32 s70, s70, 8192
buffer_load_dwordx4 v6, s[28:31], s70 offen lds
s_add_u32 m0, m0, 1024
s_add_u32 s70, s70, 8192
buffer_load_dwordx4 v6, s[28:31], s70 offen lds
s_add_u32 m0, m0, 1024
s_add_u32 s70, s70, 8192
buffer_load_dwordx4 v6, s[28:31], s70 offen lds
s_lshl_b32 s70, s69, 15
s_add_u32 m0, m0, 1024
s_nop 0
buffer_load_dwordx4 v6, s[28:31], s70 offen lds
s_add_u32 m0, m0, 1024
s_add_u32 s70, s70, 8192
buffer_load_dwordx4 v6, s[28:31], s70 offen lds
s_add_u32 m0, m0, 1024
s_add_u32 s70, s70, 8192
buffer_load_dwordx4 v6, s[28:31], s70 offen lds
s_add_u32 m0, m0, 1024
s_add_u32 s70, s70, 8192
buffer_load_dwordx4 v6, s[28:31], s70 offen lds
s_waitcnt vmcnt(56)
s_barrier
s_mov_b32 s68, 32
s_mov_b32 m0, 73728
s_lshl_b32 s70, s68, 15
buffer_load_dwordx4 v6, s[28:31], s70 offen lds
s_add_u32 m0, m0, 1024
s_add_u32 s70, s70, 8192
buffer_load_dwordx4 v6, s[28:31], s70 offen lds
s_add_u32 m0, m0, 1024
s_add_u32 s70, s70, 8192
buffer_load_dwordx4 v6, s[28:31], s70 offen lds
s_add_u32 m0, m0, 1024
s_add_u32 s70, s70, 8192
buffer_load_dwordx4 v6, s[28:31], s70 offen lds
s_waitcnt vmcnt(52)
s_barrier
s_add_u32 s70, s94, 0
s_and_b32 s70, s70, 7
s_lshl_b32 s70, s70, 16
s_mov_b32 m0, 81920
s_nop 0
buffer_load_dwordx4 v6, s[32:35], s70 offen lds
s_add_u32 m0, m0, 1024
s_add_u32 s70, s70, 8192
buffer_load_dwordx4 v6, s[32:35], s70 offen lds
s_add_u32 m0, m0, 1024
s_add_u32 s70, s70, 8192
buffer_load_dwordx4 v6, s[32:35], s70 offen lds
s_add_u32 m0, m0, 1024
s_add_u32 s70, s70, 8192
buffer_load_dwordx4 v6, s[32:35], s70 offen lds
s_add_u32 m0, m0, 1024
s_add_u32 s70, s70, 8192
buffer_load_dwordx4 v6, s[32:35], s70 offen lds
s_add_u32 m0, m0, 1024
s_add_u32 s70, s70, 8192
buffer_load_dwordx4 v6, s[32:35], s70 offen lds
s_add_u32 m0, m0, 1024
s_add_u32 s70, s70, 8192
buffer_load_dwordx4 v6, s[32:35], s70 offen lds
s_add_u32 m0, m0, 1024
s_add_u32 s70, s70, 8192
buffer_load_dwordx4 v6, s[32:35], s70 offen lds
s_waitcnt vmcnt(52)
s_barrier
s_add_u32 s70, s94, 1
s_and_b32 s70, s70, 7
s_lshl_b32 s70, s70, 16
s_mov_b32 m0, 90112
s_nop 0
buffer_load_dwordx4 v6, s[32:35], s70 offen lds
s_add_u32 m0, m0, 1024
s_add_u32 s70, s70, 8192
buffer_load_dwordx4 v6, s[32:35], s70 offen lds
s_add_u32 m0, m0, 1024
s_add_u32 s70, s70, 8192
buffer_load_dwordx4 v6, s[32:35], s70 offen lds
s_add_u32 m0, m0, 1024
s_add_u32 s70, s70, 8192
buffer_load_dwordx4 v6, s[32:35], s70 offen lds
s_add_u32 m0, m0, 1024
s_add_u32 s70, s70, 8192
buffer_load_dwordx4 v6, s[32:35], s70 offen lds
s_add_u32 m0, m0, 1024
s_add_u32 s70, s70, 8192
buffer_load_dwordx4 v6, s[32:35], s70 offen lds
s_add_u32 m0, m0, 1024
s_add_u32 s70, s70, 8192
buffer_load_dwordx4 v6, s[32:35], s70 offen lds
s_add_u32 m0, m0, 1024
s_add_u32 s70, s70, 8192
buffer_load_dwordx4 v6, s[32:35], s70 offen lds
s_waitcnt vmcnt(52)
s_barrier
s_add_u32 s70, s94, 2
s_and_b32 s70, s70, 7
s_lshl_b32 s70, s70, 16
s_mov_b32 m0, 0
s_nop 0
buffer_load_dwordx4 v6, s[32:35], s70 offen lds
s_add_u32 m0, m0, 1024
s_add_u32 s70, s70, 8192
buffer_load_dwordx4 v6, s[32:35], s70 offen lds
s_add_u32 m0, m0, 1024
s_add_u32 s70, s70, 8192
buffer_load_dwordx4 v6, s[32:35], s70 offen lds
s_add_u32 m0, m0, 1024
s_add_u32 s70, s70, 8192
buffer_load_dwordx4 v6, s[32:35], s70 offen lds
s_add_u32 m0, m0, 1024
s_add_u32 s70, s70, 8192
buffer_load_dwordx4 v6, s[32:35], s70 offen lds
s_add_u32 m0, m0, 1024
s_add_u32 s70, s70, 8192
buffer_load_dwordx4 v6, s[32:35], s70 offen lds
s_add_u32 m0, m0, 1024
s_add_u32 s70, s70, 8192
buffer_load_dwordx4 v6, s[32:35], s70 offen lds
s_add_u32 m0, m0, 1024
s_add_u32 s70, s70, 8192
buffer_load_dwordx4 v6, s[32:35], s70 offen lds
s_waitcnt vmcnt(52)
s_barrier
s_add_u32 s70, s94, 3
s_and_b32 s70, s70, 7
s_lshl_b32 s70, s70, 16
s_mov_b32 m0, 8192
s_nop 0
buffer_load_dwordx4 v6, s[32:35], s70 offen lds
s_add_u32 m0, m0, 1024
s_add_u32 s70, s70, 8192
buffer_load_dwordx4 v6, s[32:35], s70 offen lds
s_add_u32 m0, m0, 1024
s_add_u32 s70, s70, 8192
buffer_load_dwordx4 v6, s[32:35], s70 offen lds
s_add_u32 m0, m0, 1024
s_add_u32 s70, s70, 8192
buffer_load_dwordx4 v6, s[32:35], s70 offen lds
s_add_u32 m0, m0, 1024
s_add_u32 s70, s70, 8192
buffer_load_dwordx4 v6, s[32:35], s70 offen lds
s_add_u32 m0, m0, 1024
s_add_u32 s70, s70, 8192
buffer_load_dwordx4 v6, s[32:35], s70 offen lds
s_add_u32 m0, m0, 1024
s_add_u32 s70, s70, 8192
buffer_load_dwordx4 v6, s[32:35], s70 offen lds
s_add_u32 m0, m0, 1024
s_add_u32 s70, s70, 8192
buffer_load_dwordx4 v6, s[32:35], s70 offen lds
s_waitcnt vmcnt(52)
s_barrier
s_add_u32 s70, s94, 4
s_and_b32 s70, s70, 7
s_lshl_b32 s70, s70, 16
s_mov_b32 m0, 16384
s_nop 0
buffer_load_dwordx4 v6, s[32:35], s70 offen lds
s_add_u32 m0, m0, 1024
s_add_u32 s70, s70, 8192
buffer_load_dwordx4 v6, s[32:35], s70 offen lds
s_add_u32 m0, m0, 1024
s_add_u32 s70, s70, 8192
buffer_load_dwordx4 v6, s[32:35], s70 offen lds
s_add_u32 m0, m0, 1024
s_add_u32 s70, s70, 8192
buffer_load_dwordx4 v6, s[32:35], s70 offen lds
s_add_u32 m0, m0, 1024
s_add_u32 s70, s70, 8192
buffer_load_dwordx4 v6, s[32:35], s70 offen lds
s_add_u32 m0, m0, 1024
s_add_u32 s70, s70, 8192
buffer_load_dwordx4 v6, s[32:35], s70 offen lds
s_add_u32 m0, m0, 1024
s_add_u32 s70, s70, 8192
buffer_load_dwordx4 v6, s[32:35], s70 offen lds
s_add_u32 m0, m0, 1024
s_add_u32 s70, s70, 8192
buffer_load_dwordx4 v6, s[32:35], s70 offen lds
s_waitcnt vmcnt(52)
s_barrier
s_add_u32 s70, s94, 5
s_and_b32 s70, s70, 7
s_lshl_b32 s70, s70, 16
s_mov_b32 m0, 24576
s_nop 0
buffer_load_dwordx4 v6, s[32:35], s70 offen lds
s_add_u32 m0, m0, 1024
s_add_u32 s70, s70, 8192
buffer_load_dwordx4 v6, s[32:35], s70 offen lds
s_add_u32 m0, m0, 1024
s_add_u32 s70, s70, 8192
buffer_load_dwordx4 v6, s[32:35], s70 offen lds
s_add_u32 m0, m0, 1024
s_add_u32 s70, s70, 8192
buffer_load_dwordx4 v6, s[32:35], s70 offen lds
s_add_u32 m0, m0, 1024
s_add_u32 s70, s70, 8192
buffer_load_dwordx4 v6, s[32:35], s70 offen lds
s_add_u32 m0, m0, 1024
s_add_u32 s70, s70, 8192
buffer_load_dwordx4 v6, s[32:35], s70 offen lds
s_add_u32 m0, m0, 1024
s_add_u32 s70, s70, 8192
buffer_load_dwordx4 v6, s[32:35], s70 offen lds
s_add_u32 m0, m0, 1024
s_add_u32 s70, s70, 8192
buffer_load_dwordx4 v6, s[32:35], s70 offen lds
s_waitcnt vmcnt(52)
s_barrier
s_add_u32 s70, s94, 6
s_and_b32 s70, s70, 7
s_lshl_b32 s70, s70, 16
s_mov_b32 m0, 32768
s_nop 0
buffer_load_dwordx4 v6, s[32:35], s70 offen lds
s_add_u32 m0, m0, 1024
s_add_u32 s70, s70, 8192
buffer_load_dwordx4 v6, s[32:35], s70 offen lds
s_add_u32 m0, m0, 1024
s_add_u32 s70, s70, 8192
buffer_load_dwordx4 v6, s[32:35], s70 offen lds
s_add_u32 m0, m0, 1024
s_add_u32 s70, s70, 8192
buffer_load_dwordx4 v6, s[32:35], s70 offen lds
s_add_u32 m0, m0, 1024
s_add_u32 s70, s70, 8192
buffer_load_dwordx4 v6, s[32:35], s70 offen lds
s_add_u32 m0, m0, 1024
s_add_u32 s70, s70, 8192
buffer_load_dwordx4 v6, s[32:35], s70 offen lds
s_add_u32 m0, m0, 1024
s_add_u32 s70, s70, 8192
buffer_load_dwordx4 v6, s[32:35], s70 offen lds
s_add_u32 m0, m0, 1024
s_add_u32 s70, s70, 8192
buffer_load_dwordx4 v6, s[32:35], s70 offen lds
s_waitcnt vmcnt(56)
s_barrier
s_add_u32 s70, s94, 7
s_and_b32 s70, s70, 7
s_lshl_b32 s70, s70, 16
s_mov_b32 m0, 40960
s_nop 0
buffer_load_dwordx4 v6, s[32:35], s70 offen lds
s_add_u32 m0, m0, 1024
s_add_u32 s70, s70, 8192
buffer_load_dwordx4 v6, s[32:35], s70 offen lds
s_add_u32 m0, m0, 1024
s_add_u32 s70, s70, 8192
buffer_load_dwordx4 v6, s[32:35], s70 offen lds
s_add_u32 m0, m0, 1024
s_add_u32 s70, s70, 8192
buffer_load_dwordx4 v6, s[32:35], s70 offen lds
s_add_u32 m0, m0, 1024
s_add_u32 s70, s70, 8192
buffer_load_dwordx4 v6, s[32:35], s70 offen lds
s_add_u32 m0, m0, 1024
s_add_u32 s70, s70, 8192
buffer_load_dwordx4 v6, s[32:35], s70 offen lds
s_add_u32 m0, m0, 1024
s_add_u32 s70, s70, 8192
buffer_load_dwordx4 v6, s[32:35], s70 offen lds
s_add_u32 m0, m0, 1024
s_add_u32 s70, s70, 8192
buffer_load_dwordx4 v6, s[32:35], s70 offen lds
s_waitcnt vmcnt(56)
s_barrier
s_waitcnt vmcnt(48)
s_barrier
s_waitcnt vmcnt(40)
s_barrier
s_waitcnt vmcnt(32)
s_barrier
s_waitcnt vmcnt(24)
s_barrier
s_waitcnt vmcnt(16)
s_barrier
s_waitcnt vmcnt(8)
s_barrier
s_waitcnt vmcnt(0)
s_barrier
s_endpgm
L_compute:
s_waitcnt lgkmcnt(0)
s_getpc_b64 s[92:93]
L_pc0:
s_sub_u32 s92, s92, L_pc0-L_kstart
s_subb_u32 s93, s93, 0
s_lshl_b32 s94, s4, 2
s_add_u32 s94, s94, s5
s_lshl_b32 s94, s94, 9
v_lshlrev_b32 v252, 7, v1
v_add_u32 v252, s94, v252
v_cmp_gt_u32 vcc, L_kend-L_kstart, v252
s_nop 1
s_and_b64 exec, vcc, 15
s_cbranch_execz L_npf_31
global_load_dword v253, v252, s[92:93]
L_npf_31:
s_mov_b64 exec, -1
s_getreg_b32 s62, hwreg(HW_REG_XCC_ID)
s_lshr_b32 s59, s5, 1
s_and_b32 s60, s5, 1
s_mov_b32 s8, s64
s_and_b32 s9, s65, 0xffff
s_mov_b32 s10, 2097152
s_mov_b32 s11, 0x20000
s_mov_b32 s52, s82
s_and_b32 s53, s83, 0xffff
s_mov_b32 s54, 1024
s_mov_b32 s55, 0x20000
s_mov_b32 s40, s88
s_and_b32 s41, s89, 0xffff
s_mov_b32 s42, 4194304
s_mov_b32 s43, 0x20000
s_load_dword s6, s[88:89], 0
s_lshl_b32 s92, s3, 8
s_lshl_b32 s93, s4, 3
s_add_u32 s92, s92, s93
s_lshl_b32 s93, s5, 1
s_add_u32 s92, s92, s93
v_add_u32 v58, s92, v3
v_lshlrev_b32 v57, 5, v2
v_lshlrev_b32 v56, 10, v58
v_add_u32 v56, v56, v57
buffer_load_dwordx4 v[208:211], v56, s[8:11], 0 offen
buffer_load_dwordx4 v[212:215], v56, s[8:11], 0 offen offset:16
buffer_load_dwordx4 v[216:219], v57, s[52:55], 0 offen
buffer_load_dwordx4 v[220:223], v57, s[52:55], 0 offen offset:16
s_mov_b32 s48, s68
s_and_b32 s49, s69, 0xffff
s_mov_b32 s50, 16384
s_mov_b32 s51, 0x20000
s_add_u32 s36, s88, 4194304
s_addc_u32 s37, s89, 0
s_and_b32 s37, s37, 0xffff
s_mov_b32 s38, 16777216
s_mov_b32 s39, 0x20000
s_mov_b32 s44, s84
s_and_b32 s45, s85, 0xffff
s_mov_b32 s46, 2097152
s_mov_b32 s47, 0x20000
s_mov_b32 s12, s66
s_and_b32 s13, s67, 0xffff
s_mov_b32 s14, 1572864
s_mov_b32 s15, 0x20000
s_mov_b32 s16, s74
s_and_b32 s17, s75, 0xffff
s_mov_b32 s18, 524288
s_mov_b32 s19, 0x20000
s_mov_b32 s32, s70
s_and_b32 s33, s71, 0xffff
s_mov_b32 s34, 524288
s_mov_b32 s35, 0x20000
s_mov_b32 s20, s76
s_and_b32 s21, s77, 0xffff
s_mov_b32 s22, 524288
s_mov_b32 s23, 0x20000
s_mov_b32 s24, s78
s_and_b32 s25, s79, 0xffff
s_mov_b32 s26, 1409024
s_mov_b32 s27, 0x20000
s_mov_b32 s28, s80
s_and_b32 s29, s81, 0xffff
s_mov_b32 s30, 1409024
s_mov_b32 s31, 0x20000
v_lshrrev_b32 v56, 2, v2
v_and_b32 v56, 1, v56
v_lshrrev_b32 v57, 3, v2
v_lshlrev_b32 v57, 2, v57
v_and_b32 v59, 3, v2
v_add_u32 v57, v57, v59
v_lshlrev_b32 v57, 1, v57
s_lshl_b32 s68, s57, 2
s_lshl_b32 s69, s60, 1
s_add_u32 s68, s68, s69
s_lshl_b32 s68, s68, 9
v_lshlrev_b32 v59, 9, v3
v_add_u32 v57, v57, v59
v_add_u32 v57, s68, v57
v_cmp_eq_u32 vcc, v56, v3
v_mov_b32 v59, 0x7fff0000
s_nop 0
v_cndmask_b32 v57, v59, v57, vcc
buffer_load_ushort v144, v57, s[48:51], 0 offen offset:0
buffer_load_ushort v160, v57, s[48:51], 0 offen offset:32
buffer_load_ushort v145, v57, s[48:51], 0 offen offset:64
buffer_load_ushort v161, v57, s[48:51], 0 offen offset:96
buffer_load_ushort v146, v57, s[48:51], 0 offen offset:128
buffer_load_ushort v162, v57, s[48:51], 0 offen offset:160
buffer_load_ushort v147, v57, s[48:51], 0 offen offset:192
buffer_load_ushort v163, v57, s[48:51], 0 offen offset:224
buffer_load_ushort v148, v57, s[48:51], 0 offen offset:256
buffer_load_ushort v164, v57, s[48:51], 0 offen offset:288
buffer_load_ushort v149, v57, s[48:51], 0 offen offset:320
buffer_load_ushort v165, v57, s[48:51], 0 offen offset:352
buffer_load_ushort v150, v57, s[48:51], 0 offen offset:384
buffer_load_ushort v166, v57, s[48:51], 0 offen offset:416
buffer_load_ushort v151, v57, s[48:51], 0 offen offset:448
buffer_load_ushort v167, v57, s[48:51], 0 offen offset:480
s_and_b32 s76, s4, 3
s_lshr_b32 s77, s4, 2
s_lshr_b32 s78, s4, 1
s_mul_i32 s68, s78, 3
s_lshl_b32 s69, s78, 1
s_add_u32 s69, s69, 11
s_cmp_lt_u32 s78, 11
s_cselect_b32 s87, s68, s69
s_mov_b32 s74, 1069066811
s_mov_b32 s75, 1069066811
s_mov_b32 s80, 3184710632
s_mov_b32 s81, 3184710632
s_mov_b32 s82, 1.0
s_mov_b32 s83, 1.0
s_mov_b32 s94, 36864
s_mov_b32 s93, 36864
s_waitcnt lgkmcnt(0)
s_add_u32 s6, s6, 1
s_cmp_eq_u32 s5, 0
s_cbranch_scc0 L_nx_32
s_lshl_b32 s68, s3, 5
s_add_u32 s68, s68, s4
s_lshl_b32 s68, s68, 3
s_add_u32 s68, s68, 4096
v_mov_b32 v60, s6
v_mov_b32 v61, s62
v_mov_b32 v62, s68
s_mov_b64 exec, 1
buffer_store_dwordx2 v[60:61], v62, s[40:43], 0 offen sc1
s_mov_b64 exec, -1
L_nx_32:
s_lshl_b32 s68, s59, 6
v_add_u32 v56, s68, v2
v_lshlrev_b32 v56, 7, v56
v_lshrrev_b32 v57, 1, v2
v_and_b32 v57, 7, v57
v_add_u32 v59, 0, v3
v_xor_b32 v59, v59, v57
v_lshlrev_b32 v59, 4, v59
v_add_u32 v12, v56, v59
v_add_u32 v16, 0x10000, v12
v_add_u32 v59, 2, v3
v_xor_b32 v59, v59, v57
v_lshlrev_b32 v59, 4, v59
v_add_u32 v13, v56, v59
v_add_u32 v17, 0x10000, v13
v_add_u32 v59, 4, v3
v_xor_b32 v59, v59, v57
v_lshlrev_b32 v59, 4, v59
v_add_u32 v14, v56, v59
v_add_u32 v18, 0x10000, v14
v_add_u32 v59, 6, v3
v_xor_b32 v59, v59, v57
v_lshlrev_b32 v59, 4, v59
v_add_u32 v15, v56, v59
v_add_u32 v19, 0x10000, v15
v_lshrrev_b32 v56, 4, v1
v_lshrrev_b32 v57, 1, v56
v_lshlrev_b32 v57, 3, v57
v_and_b32 v59, 15, v1
v_lshrrev_b32 v59, 2, v59
v_add_u32 v57, v57, v59
v_mul_u32_u24 v57, 128, v57
v_lshrrev_b32 v59, 1, v59
v_and_b32 v59, 1, v59
v_xor_b32 v59, s60, v59
v_lshlrev_b32 v59, 6, v59
v_add_u32 v57, v57, v59
v_and_b32 v59, 1, v1
v_lshlrev_b32 v59, 5, v59
v_add_u32 v57, v57, v59
v_and_b32 v59, 1, v56
v_lshlrev_b32 v59, 4, v59
v_add_u32 v57, v57, v59
v_and_b32 v59, 2, v1
v_lshlrev_b32 v59, 2, v59
v_add_u32 v20, v57, v59
v_add_u32 v21, 0x10000, v20
v_mov_b32 v205, v20
v_lshrrev_b32 v59, 2, v2
v_and_b32 v59, 3, v59
s_lshl_b32 s68, s59, 5
v_add_u32 v57, s68, v2
v_lshlrev_b32 v57, 6, v57
s_lshl_b32 s68, s5, 5
v_add_u32 v56, s68, v2
v_lshlrev_b32 v56, 6, v56
v_add_u32 v56, 114688, v56
v_add_u32 v60, 0, v3
v_xor_b32 v60, v60, v59
v_lshlrev_b32 v60, 4, v60
v_add_u32 v203, v57, v60
v_add_u32 v4, v56, v60
v_add_u32 v60, 2, v3
v_xor_b32 v60, v60, v59
v_lshlrev_b32 v60, 4, v60
v_add_u32 v204, v57, v60
v_add_u32 v5, v56, v60
v_lshrrev_b32 v56, 4, v1
v_lshrrev_b32 v57, 1, v56
v_lshlrev_b32 v57, 3, v57
v_and_b32 v59, 15, v1
v_lshrrev_b32 v59, 2, v59
v_add_u32 v57, v57, v59
v_mul_u32_u24 v57, 192, v57
v_and_b32 v59, 1, v1
v_lshlrev_b32 v59, 5, v59
v_add_u32 v57, v57, v59
v_and_b32 v59, 1, v56
v_lshlrev_b32 v59, 4, v59
v_add_u32 v57, v57, v59
v_and_b32 v59, 2, v1
v_lshlrev_b32 v59, 2, v59
v_add_u32 v6, v57, v59
v_add_u32 v7, 0x10000, v6
v_and_b32 v56, 15, v1
v_lshlrev_b32 v56, 6, v56
v_lshrrev_b32 v57, 4, v1
v_lshlrev_b32 v57, 4, v57
v_add_u32 v206, v56, v57
s_waitcnt vmcnt(16)
v_lshlrev_b32 v224, 16, v208
v_and_b32 v225, 0xffff0000, v208
v_lshlrev_b32 v24, 16, v216
v_and_b32 v25, 0xffff0000, v216
v_lshlrev_b32 v226, 16, v209
v_and_b32 v227, 0xffff0000, v209
v_lshlrev_b32 v26, 16, v217
v_and_b32 v27, 0xffff0000, v217
v_lshlrev_b32 v228, 16, v210
v_and_b32 v229, 0xffff0000, v210
v_lshlrev_b32 v28, 16, v218
v_and_b32 v29, 0xffff0000, v218
v_lshlrev_b32 v230, 16, v211
v_and_b32 v231, 0xffff0000, v211
v_lshlrev_b32 v30, 16, v219
v_and_b32 v31, 0xffff0000, v219
v_lshlrev_b32 v232, 16, v212
v_and_b32 v233, 0xffff0000, v212
v_lshlrev_b32 v32, 16, v220
v_and_b32 v33, 0xffff0000, v220
v_lshlrev_b32 v234, 16, v213
v_and_b32 v235, 0xffff0000, v213
v_lshlrev_b32 v34, 16, v221
v_and_b32 v35, 0xffff0000, v221
v_lshlrev_b32 v236, 16, v214
v_and_b32 v237, 0xffff0000, v214
v_lshlrev_b32 v36, 16, v222
v_and_b32 v37, 0xffff0000, v222
v_lshlrev_b32 v238, 16, v215
v_and_b32 v239, 0xffff0000, v215
v_lshlrev_b32 v38, 16, v223
v_and_b32 v39, 0xffff0000, v223
v_pk_mul_f32 v[40:41], v[224:225], v[24:25]
v_pk_mul_f32 v[42:43], v[226:227], v[26:27]
v_pk_mul_f32 v[44:45], v[228:229], v[28:29]
v_pk_mul_f32 v[46:47], v[230:231], v[30:31]
v_pk_mul_f32 v[48:49], v[232:233], v[32:33]
v_pk_mul_f32 v[50:51], v[234:235], v[34:35]
v_pk_mul_f32 v[52:53], v[236:237], v[36:37]
v_pk_mul_f32 v[54:55], v[238:239], v[38:39]
v_cvt_pk_bf16_f32 v208, v40, v41
v_cvt_pk_bf16_f32 v209, v42, v43
v_cvt_pk_bf16_f32 v210, v44, v45
v_cvt_pk_bf16_f32 v211, v46, v47
v_cvt_pk_bf16_f32 v212, v48, v49
v_cvt_pk_bf16_f32 v213, v50, v51
v_cvt_pk_bf16_f32 v214, v52, v53
v_cvt_pk_bf16_f32 v215, v54, v55
v_lshlrev_b32 v40, 16, v208
v_and_b32 v41, 0xffff0000, v208
v_lshlrev_b32 v42, 16, v209
v_and_b32 v43, 0xffff0000, v209
v_lshlrev_b32 v44, 16, v210
v_and_b32 v45, 0xffff0000, v210
v_lshlrev_b32 v46, 16, v211
v_and_b32 v47, 0xffff0000, v211
v_lshlrev_b32 v48, 16, v212
v_and_b32 v49, 0xffff0000, v212
v_lshlrev_b32 v50, 16, v213
v_and_b32 v51, 0xffff0000, v213
v_lshlrev_b32 v52, 16, v214
v_and_b32 v53, 0xffff0000, v214
v_lshlrev_b32 v54, 16, v215
v_and_b32 v55, 0xffff0000, v215
v_pk_add_f32 v[240:241], v[224:225], v[226:227]
v_pk_mul_f32 v[242:243], v[224:225], v[224:225]
v_pk_add_f32 v[244:245], v[40:41], v[42:43]
v_pk_fma_f32 v[242:243], v[226:227], v[226:227], v[242:243]
v_pk_add_f32 v[240:241], v[240:241], v[228:229]
v_pk_fma_f32 v[242:243], v[228:229], v[228:229], v[242:243]
v_pk_add_f32 v[244:245], v[244:245], v[44:45]
v_pk_add_f32 v[240:241], v[240:241], v[230:231]
v_pk_fma_f32 v[242:243], v[230:231], v[230:231], v[242:243]
v_pk_add_f32 v[244:245], v[244:245], v[46:47]
v_pk_add_f32 v[240:241], v[240:241], v[232:233]
v_pk_fma_f32 v[242:243], v[232:233], v[232:233], v[242:243]
v_pk_add_f32 v[244:245], v[244:245], v[48:49]
v_pk_add_f32 v[240:241], v[240:241], v[234:235]
v_pk_fma_f32 v[242:243], v[234:235], v[234:235], v[242:243]
v_pk_add_f32 v[244:245], v[244:245], v[50:51]
v_pk_add_f32 v[240:241], v[240:241], v[236:237]
v_pk_fma_f32 v[242:243], v[236:237], v[236:237], v[242:243]
v_pk_add_f32 v[244:245], v[244:245], v[52:53]
v_pk_add_f32 v[240:241], v[240:241], v[238:239]
v_pk_fma_f32 v[242:243], v[238:239], v[238:239], v[242:243]
v_pk_add_f32 v[244:245], v[244:245], v[54:55]
v_add_f32 v240, v240, v241
v_add_f32 v242, v242, v243
v_add_f32 v244, v244, v245
v_add_f32_dpp v240, v240, v240 quad_perm:[1,0,3,2] row_mask:0xf bank_mask:0xf
v_add_f32_dpp v242, v242, v242 quad_perm:[1,0,3,2] row_mask:0xf bank_mask:0xf
v_add_f32_dpp v244, v244, v244 quad_perm:[1,0,3,2] row_mask:0xf bank_mask:0xf
v_add_f32_dpp v240, v240, v240 quad_perm:[2,3,0,1] row_mask:0xf bank_mask:0xf
v_add_f32_dpp v242, v242, v242 quad_perm:[2,3,0,1] row_mask:0xf bank_mask:0xf
v_add_f32_dpp v244, v244, v244 quad_perm:[2,3,0,1] row_mask:0xf bank_mask:0xf
v_add_f32_dpp v240, v240, v240 row_half_mirror row_mask:0xf bank_mask:0xf
v_add_f32_dpp v242, v242, v242 row_half_mirror row_mask:0xf bank_mask:0xf
v_add_f32_dpp v244, v244, v244 row_half_mirror row_mask:0xf bank_mask:0xf
v_add_f32_dpp v240, v240, v240 row_mirror row_mask:0xf bank_mask:0xf
v_add_f32_dpp v242, v242, v242 row_mirror row_mask:0xf bank_mask:0xf
v_add_f32_dpp v244, v244, v244 row_mirror row_mask:0xf bank_mask:0xf
v_mov_b32 v241, v240
v_mov_b32 v243, v242
v_mov_b32 v245, v244
v_permlane16_swap_b32 v240, v241
v_permlane16_swap_b32 v242, v243
v_permlane16_swap_b32 v244, v245
v_add_f32 v240, v240, v241
v_add_f32 v242, v242, v243
v_add_f32 v244, v244, v245
v_mul_f32 v240, 989855744, v240
v_mul_f32 v242, 989855744, v242
v_fma_f32 v242, -v240, v240, v242
v_max_f32 v242, 0, v242
v_cvt_pk_bf16_f32 v248, v242, v242
v_lshlrev_b32 v242, 16, v248
v_cvt_pk_bf16_f32 v249, v240, v240
v_lshlrev_b32 v240, 16, v249
v_add_f32 v242, 925353388, v242
v_cvt_pk_bf16_f32 v248, v242, v242
v_lshlrev_b32 v242, 16, v248
v_sqrt_f32 v242, v242
s_nop 0
v_cvt_pk_bf16_f32 v248, v242, v242
v_lshlrev_b32 v242, 16, v248
v_rcp_f32 v246, v242
s_nop 0
v_mul_f32 v247, v240, v246
v_sub_f32 v247, 0, v247
v_cvt_pk_bf16_f32 v248, v244, v244
v_lshlrev_b32 v244, 16, v248
v_mul_f32 v244, s74, v244
v_sub_f32 v244, 0, v244
v_exp_f32 v244, v244
s_nop 0
v_add_f32 v244, 1.0, v244
v_rcp_f32 v244, v244
s_nop 0
v_cvt_pk_bf16_f32 v248, v244, v244
v_lshlrev_b32 v244, 16, v248
v_lshlrev_b32 v56, 3, v58
v_lshlrev_b32 v57, 2, v58
s_mov_b32 s68, 2228224
s_mov_b32 s69, 2244608
s_mov_b32 exec_lo, 1
s_mov_b32 exec_hi, 1
buffer_store_dwordx2 v[246:247], v56, s[40:43], s68 offen sc1
buffer_store_dword v244, v57, s[40:43], s69 offen sc1
s_mov_b64 exec, -1
v_mov_b32 v152, 0x3f803f80
v_mov_b32 v153, 0x3f803f80
v_mov_b32 v154, 0x3f803f80
v_mov_b32 v155, 0x3f803f80
v_mov_b32 v200, 3222493025
v_mov_b32 v201, 3222493025
s_cmp_eq_u32 s58, 0
s_cselect_b64 vcc, -1, 0
s_barrier
ds_read_b128 v[24:27], v12 offset:0
ds_read_b64_tr_b16 v[32:33], v20 offset:16384
ds_read_b64_tr_b16 v[34:35], v20 offset:16896
ds_read_b128 v[28:31], v12 offset:4096
ds_read_b64_tr_b16 v[36:37], v20 offset:24576
ds_read_b64_tr_b16 v[38:39], v20 offset:25088
ds_read_b128 v[40:43], v13 offset:0
ds_read_b64_tr_b16 v[48:49], v20 offset:18432
ds_read_b64_tr_b16 v[50:51], v20 offset:18944
ds_read_b128 v[44:47], v13 offset:4096
ds_read_b64_tr_b16 v[52:53], v20 offset:26624
ds_read_b64_tr_b16 v[54:55], v20 offset:27136
s_waitcnt lgkmcnt(6)
v_mfma_f32_32x32x16_bf16 v[64:79], v[32:35], v[24:27], 0
ds_read_b128 v[216:219], v14 offset:0
ds_read_b64_tr_b16 v[224:225], v20 offset:20480
v_mfma_f32_32x32x16_bf16 v[80:95], v[32:35], v[28:31], 0
ds_read_b64_tr_b16 v[226:227], v20 offset:20992
ds_read_b128 v[220:223], v14 offset:4096
v_mfma_f32_32x32x16_bf16 v[96:111], v[36:39], v[24:27], 0
ds_read_b64_tr_b16 v[228:229], v20 offset:28672
v_mfma_f32_32x32x16_bf16 v[112:127], v[36:39], v[28:31], 0
ds_read_b64_tr_b16 v[230:231], v20 offset:29184
s_cbranch_vccnz L_cs_33
v_mfma_f32_32x32x16_bf16 v[128:143], v[36:39], v[152:155], 0
L_cs_33:
s_waitcnt lgkmcnt(6)
v_mfma_f32_32x32x16_bf16 v[64:79], v[48:51], v[40:43], v[64:79]
ds_read_b128 v[24:27], v15 offset:0
ds_read_b64_tr_b16 v[32:33], v20 offset:22528
v_mfma_f32_32x32x16_bf16 v[80:95], v[48:51], v[44:47], v[80:95]
ds_read_b64_tr_b16 v[34:35], v20 offset:23040
ds_read_b128 v[28:31], v15 offset:4096
v_mfma_f32_32x32x16_bf16 v[96:111], v[52:55], v[40:43], v[96:111]
ds_read_b64_tr_b16 v[36:37], v20 offset:30720
v_mfma_f32_32x32x16_bf16 v[112:127], v[52:55], v[44:47], v[112:127]
ds_read_b64_tr_b16 v[38:39], v20 offset:31232
s_cbranch_vccnz L_cs_34
v_mfma_f32_32x32x16_bf16 v[128:143], v[52:55], v[152:155], v[128:143]
L_cs_34:
s_waitcnt lgkmcnt(0)
s_barrier
v_mfma_f32_32x32x16_bf16 v[64:79], v[224:227], v[216:219], v[64:79]
ds_read_b128 v[40:43], v12 offset:32768
ds_read_b64_tr_b16 v[48:49], v20 offset:49152
v_mfma_f32_32x32x16_bf16 v[80:95], v[224:227], v[220:223], v[80:95]
ds_read_b64_tr_b16 v[50:51], v20 offset:49664
ds_read_b128 v[44:47], v12 offset:36864
v_mfma_f32_32x32x16_bf16 v[96:111], v[228:231], v[216:219], v[96:111]
ds_read_b64_tr_b16 v[52:53], v20 offset:57344
v_mfma_f32_32x32x16_bf16 v[112:127], v[228:231], v[220:223], v[112:127]
ds_read_b64_tr_b16 v[54:55], v20 offset:57856
s_cbranch_vccnz L_cs_35
v_mfma_f32_32x32x16_bf16 v[128:143], v[228:231], v[152:155], v[128:143]
L_cs_35:
v_mfma_f32_32x32x16_bf16 v[64:79], v[32:35], v[24:27], v[64:79]
ds_read_b128 v[216:219], v13 offset:32768
ds_read_b64_tr_b16 v[224:225], v20 offset:51200
v_mfma_f32_32x32x16_bf16 v[80:95], v[32:35], v[28:31], v[80:95]
ds_read_b64_tr_b16 v[226:227], v20 offset:51712
ds_read_b128 v[220:223], v13 offset:36864
v_mfma_f32_32x32x16_bf16 v[96:111], v[36:39], v[24:27], v[96:111]
ds_read_b64_tr_b16 v[228:229], v20 offset:59392
v_mfma_f32_32x32x16_bf16 v[112:127], v[36:39], v[28:31], v[112:127]
ds_read_b64_tr_b16 v[230:231], v20 offset:59904
s_cbranch_vccnz L_cs_36
v_mfma_f32_32x32x16_bf16 v[128:143], v[36:39], v[152:155], v[128:143]
L_cs_36:
s_waitcnt lgkmcnt(6)
s_waitcnt vmcnt(0)
s_lshl_b32 s68, s3, 9
s_lshl_b32 s69, s4, 4
s_add_u32 s68, s68, s69
s_lshl_b32 s69, s5, 2
s_add_u32 s68, s68, s69
s_add_u32 s68, s68, 8192
v_mov_b32 v208, s6
v_mov_b32 v209, s68
s_mov_b64 exec, 1
buffer_store_dword v208, v209, s[40:43], 0 offen sc1
s_mov_b64 exec, -1
v_mfma_f32_32x32x16_bf16 v[64:79], v[48:51], v[40:43], v[64:79]
ds_read_b128 v[24:27], v14 offset:32768
ds_read_b64_tr_b16 v[32:33], v20 offset:53248
v_mfma_f32_32x32x16_bf16 v[80:95], v[48:51], v[44:47], v[80:95]
ds_read_b64_tr_b16 v[34:35], v20 offset:53760
ds_read_b128 v[28:31], v14 offset:36864
v_mfma_f32_32x32x16_bf16 v[96:111], v[52:55], v[40:43], v[96:111]
ds_read_b64_tr_b16 v[36:37], v20 offset:61440
v_mfma_f32_32x32x16_bf16 v[112:127], v[52:55], v[44:47], v[112:127]
ds_read_b64_tr_b16 v[38:39], v20 offset:61952
s_cbranch_vccnz L_cs_37
v_mfma_f32_32x32x16_bf16 v[128:143], v[52:55], v[152:155], v[128:143]
L_cs_37:
s_waitcnt lgkmcnt(6)
v_mfma_f32_32x32x16_bf16 v[64:79], v[224:227], v[216:219], v[64:79]
ds_read_b128 v[40:43], v15 offset:32768
ds_read_b64_tr_b16 v[48:49], v20 offset:55296
v_mfma_f32_32x32x16_bf16 v[80:95], v[224:227], v[220:223], v[80:95]
ds_read_b64_tr_b16 v[50:51], v20 offset:55808
ds_read_b128 v[44:47], v15 offset:36864
v_mfma_f32_32x32x16_bf16 v[96:111], v[228:231], v[216:219], v[96:111]
ds_read_b64_tr_b16 v[52:53], v20 offset:63488
v_mfma_f32_32x32x16_bf16 v[112:127], v[228:231], v[220:223], v[112:127]
ds_read_b64_tr_b16 v[54:55], v20 offset:64000
s_cbranch_vccnz L_cs_38
v_mfma_f32_32x32x16_bf16 v[128:143], v[228:231], v[152:155], v[128:143]
L_cs_38:
s_waitcnt lgkmcnt(0)
s_barrier
v_mfma_f32_32x32x16_bf16 v[64:79], v[32:35], v[24:27], v[64:79]
ds_read_b128 v[216:219], v16 offset:0
ds_read_b64_tr_b16 v[224:225], v21 offset:16384
v_mfma_f32_32x32x16_bf16 v[80:95], v[32:35], v[28:31], v[80:95]
ds_read_b64_tr_b16 v[226:227], v21 offset:16896
ds_read_b128 v[220:223], v16 offset:4096
v_mfma_f32_32x32x16_bf16 v[96:111], v[36:39], v[24:27], v[96:111]
ds_read_b64_tr_b16 v[228:229], v21 offset:24576
v_mfma_f32_32x32x16_bf16 v[112:127], v[36:39], v[28:31], v[112:127]
ds_read_b64_tr_b16 v[230:231], v21 offset:25088
s_cbranch_vccnz L_cs_39
v_mfma_f32_32x32x16_bf16 v[128:143], v[36:39], v[152:155], v[128:143]
L_cs_39:
v_mfma_f32_32x32x16_bf16 v[64:79], v[48:51], v[40:43], v[64:79]
ds_read_b128 v[24:27], v17 offset:0
ds_read_b64_tr_b16 v[32:33], v21 offset:18432
v_mfma_f32_32x32x16_bf16 v[80:95], v[48:51], v[44:47], v[80:95]
ds_read_b64_tr_b16 v[34:35], v21 offset:18944
ds_read_b128 v[28:31], v17 offset:4096
v_mfma_f32_32x32x16_bf16 v[96:111], v[52:55], v[40:43], v[96:111]
ds_read_b64_tr_b16 v[36:37], v21 offset:26624
v_mfma_f32_32x32x16_bf16 v[112:127], v[52:55], v[44:47], v[112:127]
ds_read_b64_tr_b16 v[38:39], v21 offset:27136
s_cbranch_vccnz L_cs_40
v_mfma_f32_32x32x16_bf16 v[128:143], v[52:55], v[152:155], v[128:143]
L_cs_40:
s_waitcnt lgkmcnt(6)
v_mfma_f32_32x32x16_bf16 v[64:79], v[224:227], v[216:219], v[64:79]
ds_read_b128 v[40:43], v18 offset:0
ds_read_b64_tr_b16 v[48:49], v21 offset:20480
v_mfma_f32_32x32x16_bf16 v[80:95], v[224:227], v[220:223], v[80:95]
ds_read_b64_tr_b16 v[50:51], v21 offset:20992
ds_read_b128 v[44:47], v18 offset:4096
v_mfma_f32_32x32x16_bf16 v[96:111], v[228:231], v[216:219], v[96:111]
ds_read_b64_tr_b16 v[52:53], v21 offset:28672
v_mfma_f32_32x32x16_bf16 v[112:127], v[228:231], v[220:223], v[112:127]
ds_read_b64_tr_b16 v[54:55], v21 offset:29184
s_cbranch_vccnz L_cs_41
v_mfma_f32_32x32x16_bf16 v[128:143], v[228:231], v[152:155], v[128:143]
L_cs_41:
s_waitcnt lgkmcnt(6)
v_mfma_f32_32x32x16_bf16 v[64:79], v[32:35], v[24:27], v[64:79]
ds_read_b128 v[216:219], v19 offset:0
ds_read_b64_tr_b16 v[224:225], v21 offset:22528
v_mfma_f32_32x32x16_bf16 v[80:95], v[32:35], v[28:31], v[80:95]
ds_read_b64_tr_b16 v[226:227], v21 offset:23040
ds_read_b128 v[220:223], v19 offset:4096
v_mfma_f32_32x32x16_bf16 v[96:111], v[36:39], v[24:27], v[96:111]
ds_read_b64_tr_b16 v[228:229], v21 offset:30720
v_mfma_f32_32x32x16_bf16 v[112:127], v[36:39], v[28:31], v[112:127]
ds_read_b64_tr_b16 v[230:231], v21 offset:31232
s_cbranch_vccnz L_cs_42
v_mfma_f32_32x32x16_bf16 v[128:143], v[36:39], v[152:155], v[128:143]
L_cs_42:
s_waitcnt lgkmcnt(0)
s_barrier
v_mfma_f32_32x32x16_bf16 v[64:79], v[48:51], v[40:43], v[64:79]
ds_read_b128 v[24:27], v12 offset:0
ds_read_b64_tr_b16 v[32:33], v20 offset:16384
v_mfma_f32_32x32x16_bf16 v[80:95], v[48:51], v[44:47], v[80:95]
ds_read_b64_tr_b16 v[34:35], v20 offset:16896
ds_read_b128 v[28:31], v12 offset:4096
v_mfma_f32_32x32x16_bf16 v[96:111], v[52:55], v[40:43], v[96:111]
ds_read_b64_tr_b16 v[36:37], v20 offset:24576
v_mfma_f32_32x32x16_bf16 v[112:127], v[52:55], v[44:47], v[112:127]
ds_read_b64_tr_b16 v[38:39], v20 offset:25088
s_cbranch_vccnz L_cs_43
v_mfma_f32_32x32x16_bf16 v[128:143], v[52:55], v[152:155], v[128:143]
L_cs_43:
v_mfma_f32_32x32x16_bf16 v[64:79], v[224:227], v[216:219], v[64:79]
ds_read_b128 v[40:43], v13 offset:0
ds_read_b64_tr_b16 v[48:49], v20 offset:18432
v_mfma_f32_32x32x16_bf16 v[80:95], v[224:227], v[220:223], v[80:95]
ds_read_b64_tr_b16 v[50:51], v20 offset:18944
ds_read_b128 v[44:47], v13 offset:4096
v_mfma_f32_32x32x16_bf16 v[96:111], v[228:231], v[216:219], v[96:111]
ds_read_b64_tr_b16 v[52:53], v20 offset:26624
v_mfma_f32_32x32x16_bf16 v[112:127], v[228:231], v[220:223], v[112:127]
ds_read_b64_tr_b16 v[54:55], v20 offset:27136
s_cbranch_vccnz L_cs_44
v_mfma_f32_32x32x16_bf16 v[128:143], v[228:231], v[152:155], v[128:143]
L_cs_44:
s_waitcnt lgkmcnt(6)
s_lshl_b32 s68, s3, 8
s_add_u32 s68, s68, 4096
v_lshlrev_b32 v208, 3, v2
v_add_u32 v208, s68, v208
buffer_load_dwordx2 v[210:211], v208, s[40:43], 0 offen sc1
s_lshl_b32 s68, s56, 1
s_add_u32 s68, s68, s59
s_lshl_b32 s68, s68, 7
s_lshl_b32 s69, s3, 9
s_add_u32 s68, s68, s69
s_add_u32 s68, s68, 8192
v_lshlrev_b32 v209, 2, v2
v_add_u32 v209, s68, v209
buffer_load_dword v212, v209, s[40:43], 0 offen sc1
v_mfma_f32_32x32x16_bf16 v[64:79], v[32:35], v[24:27], v[64:79]
ds_read_b128 v[216:219], v14 offset:0
ds_read_b64_tr_b16 v[224:225], v20 offset:20480
v_mfma_f32_32x32x16_bf16 v[80:95], v[32:35], v[28:31], v[80:95]
ds_read_b64_tr_b16 v[226:227], v20 offset:20992
ds_read_b128 v[220:223], v14 offset:4096
v_mfma_f32_32x32x16_bf16 v[96:111], v[36:39], v[24:27], v[96:111]
ds_read_b64_tr_b16 v[228:229], v20 offset:28672
v_mfma_f32_32x32x16_bf16 v[112:127], v[36:39], v[28:31], v[112:127]
ds_read_b64_tr_b16 v[230:231], v20 offset:29184
s_cbranch_vccnz L_cs_45
v_mfma_f32_32x32x16_bf16 v[128:143], v[36:39], v[152:155], v[128:143]
L_cs_45:
s_waitcnt lgkmcnt(6)
v_mfma_f32_32x32x16_bf16 v[64:79], v[48:51], v[40:43], v[64:79]
ds_read_b128 v[24:27], v15 offset:0
ds_read_b64_tr_b16 v[32:33], v20 offset:22528
v_mfma_f32_32x32x16_bf16 v[80:95], v[48:51], v[44:47], v[80:95]
ds_read_b64_tr_b16 v[34:35], v20 offset:23040
ds_read_b128 v[28:31], v15 offset:4096
v_mfma_f32_32x32x16_bf16 v[96:111], v[52:55], v[40:43], v[96:111]
ds_read_b64_tr_b16 v[36:37], v20 offset:30720
v_mfma_f32_32x32x16_bf16 v[112:127], v[52:55], v[44:47], v[112:127]
ds_read_b64_tr_b16 v[38:39], v20 offset:31232
s_cbranch_vccnz L_cs_46
v_mfma_f32_32x32x16_bf16 v[128:143], v[52:55], v[152:155], v[128:143]
L_cs_46:
s_waitcnt lgkmcnt(0)
s_barrier
v_mfma_f32_32x32x16_bf16 v[64:79], v[224:227], v[216:219], v[64:79]
ds_read_b128 v[40:43], v12 offset:32768
ds_read_b64_tr_b16 v[48:49], v20 offset:49152
v_mfma_f32_32x32x16_bf16 v[80:95], v[224:227], v[220:223], v[80:95]
ds_read_b64_tr_b16 v[50:51], v20 offset:49664
ds_read_b128 v[44:47], v12 offset:36864
v_mfma_f32_32x32x16_bf16 v[96:111], v[228:231], v[216:219], v[96:111]
ds_read_b64_tr_b16 v[52:53], v20 offset:57344
v_mfma_f32_32x32x16_bf16 v[112:127], v[228:231], v[220:223], v[112:127]
ds_read_b64_tr_b16 v[54:55], v20 offset:57856
s_cbranch_vccnz L_cs_47
v_mfma_f32_32x32x16_bf16 v[128:143], v[228:231], v[152:155], v[128:143]
L_cs_47:
v_mfma_f32_32x32x16_bf16 v[64:79], v[32:35], v[24:27], v[64:79]
ds_read_b128 v[216:219], v13 offset:32768
ds_read_b64_tr_b16 v[224:225], v20 offset:51200
v_mfma_f32_32x32x16_bf16 v[80:95], v[32:35], v[28:31], v[80:95]
ds_read_b64_tr_b16 v[226:227], v20 offset:51712
ds_read_b128 v[220:223], v13 offset:36864
v_mfma_f32_32x32x16_bf16 v[96:111], v[36:39], v[24:27], v[96:111]
ds_read_b64_tr_b16 v[228:229], v20 offset:59392
v_mfma_f32_32x32x16_bf16 v[112:127], v[36:39], v[28:31], v[112:127]
ds_read_b64_tr_b16 v[230:231], v20 offset:59904
s_cbranch_vccnz L_cs_48
v_mfma_f32_32x32x16_bf16 v[128:143], v[36:39], v[152:155], v[128:143]
L_cs_48:
s_waitcnt lgkmcnt(6)
v_mfma_f32_32x32x16_bf16 v[64:79], v[48:51], v[40:43], v[64:79]
ds_read_b128 v[24:27], v14 offset:32768
ds_read_b64_tr_b16 v[32:33], v20 offset:53248
v_mfma_f32_32x32x16_bf16 v[80:95], v[48:51], v[44:47], v[80:95]
ds_read_b64_tr_b16 v[34:35], v20 offset:53760
ds_read_b128 v[28:31], v14 offset:36864
v_mfma_f32_32x32x16_bf16 v[96:111], v[52:55], v[40:43], v[96:111]
ds_read_b64_tr_b16 v[36:37], v20 offset:61440
v_mfma_f32_32x32x16_bf16 v[112:127], v[52:55], v[44:47], v[112:127]
ds_read_b64_tr_b16 v[38:39], v20 offset:61952
s_cbranch_vccnz L_cs_49
v_mfma_f32_32x32x16_bf16 v[128:143], v[52:55], v[152:155], v[128:143]
L_cs_49:
s_waitcnt lgkmcnt(6)
v_mfma_f32_32x32x16_bf16 v[64:79], v[224:227], v[216:219], v[64:79]
ds_read_b128 v[40:43], v15 offset:32768
ds_read_b64_tr_b16 v[48:49], v20 offset:55296
v_mfma_f32_32x32x16_bf16 v[80:95], v[224:227], v[220:223], v[80:95]
ds_read_b64_tr_b16 v[50:51], v20 offset:55808
ds_read_b128 v[44:47], v15 offset:36864
v_mfma_f32_32x32x16_bf16 v[96:111], v[228:231], v[216:219], v[96:111]
ds_read_b64_tr_b16 v[52:53], v20 offset:63488
v_mfma_f32_32x32x16_bf16 v[112:127], v[228:231], v[220:223], v[112:127]
ds_read_b64_tr_b16 v[54:55], v20 offset:64000
s_cbranch_vccnz L_cs_50
v_mfma_f32_32x32x16_bf16 v[128:143], v[228:231], v[152:155], v[128:143]
L_cs_50:
s_waitcnt lgkmcnt(0)
s_barrier
v_mfma_f32_32x32x16_bf16 v[64:79], v[32:35], v[24:27], v[64:79]
ds_read_b128 v[216:219], v16 offset:0
ds_read_b64_tr_b16 v[224:225], v21 offset:16384
v_mfma_f32_32x32x16_bf16 v[80:95], v[32:35], v[28:31], v[80:95]
ds_read_b64_tr_b16 v[226:227], v21 offset:16896
ds_read_b128 v[220:223], v16 offset:4096
v_mfma_f32_32x32x16_bf16 v[96:111], v[36:39], v[24:27], v[96:111]
ds_read_b64_tr_b16 v[228:229], v21 offset:24576
v_mfma_f32_32x32x16_bf16 v[112:127], v[36:39], v[28:31], v[112:127]
ds_read_b64_tr_b16 v[230:231], v21 offset:25088
s_cbranch_vccnz L_cs_51
v_mfma_f32_32x32x16_bf16 v[128:143], v[36:39], v[152:155], v[128:143]
L_cs_51:
v_mfma_f32_32x32x16_bf16 v[64:79], v[48:51], v[40:43], v[64:79]
ds_read_b128 v[24:27], v17 offset:0
ds_read_b64_tr_b16 v[32:33], v21 offset:18432
v_mfma_f32_32x32x16_bf16 v[80:95], v[48:51], v[44:47], v[80:95]
ds_read_b64_tr_b16 v[34:35], v21 offset:18944
ds_read_b128 v[28:31], v17 offset:4096
v_mfma_f32_32x32x16_bf16 v[96:111], v[52:55], v[40:43], v[96:111]
ds_read_b64_tr_b16 v[36:37], v21 offset:26624
v_mfma_f32_32x32x16_bf16 v[112:127], v[52:55], v[44:47], v[112:127]
ds_read_b64_tr_b16 v[38:39], v21 offset:27136
s_cbranch_vccnz L_cs_52
v_mfma_f32_32x32x16_bf16 v[128:143], v[52:55], v[152:155], v[128:143]
L_cs_52:
s_waitcnt lgkmcnt(6)
s_waitcnt vmcnt(1)
v_cmp_ne_u32 vcc, s6, v210
s_nop 0
s_cbranch_vccz L_xd_54
s_mov_b32 s79, 0
L_xp_53:
buffer_load_dwordx2 v[210:211], v208, s[40:43], 0 offen sc1
s_add_u32 s79, s79, 1
s_cmp_gt_u32 s79, 200000
s_waitcnt vmcnt(0)
s_cbranch_scc1 L_xd_54
v_cmp_ne_u32 vcc, s6, v210
s_nop 0
s_cbranch_vccnz L_xp_53
L_xd_54:
v_cmp_ne_u32 vcc, s62, v211
s_nop 1
s_cmp_lg_u64 vcc, 0
s_cselect_b32 s7, 1, 0
s_waitcnt vmcnt(0)
v_cmp_ne_u32 vcc, s6, v212
s_nop 0
s_cbranch_vccz L_pdone_56
s_mov_b32 s79, 0
L_poll_55:
buffer_load_dword v212, v209, s[40:43], 0 offen sc1
s_add_u32 s79, s79, 1
s_cmp_gt_u32 s79, 200000
s_waitcnt vmcnt(0)
s_cbranch_scc1 L_pdone_56
v_cmp_ne_u32 vcc, s6, v212
s_nop 0
s_cbranch_vccnz L_poll_55
L_pdone_56:
s_lshl_b32 s68, s56, 1
s_add_u32 s68, s68, s59
s_lshl_b32 s68, s68, 6
s_lshl_b32 s69, s3, 8
s_add_u32 s68, s68, s69
v_add_u32 v208, s68, v2
v_lshlrev_b32 v208, 3, v208
s_mov_b32 s68, 2228224
buffer_load_dwordx2 v[156:157], v208, s[40:43], s68 offen sc1
buffer_load_dwordx2 v[158:159], v208, s[40:43], s68 offen offset:256 sc1
s_cmp_eq_u32 s58, 0
s_cbranch_scc1 L_npt_57
s_lshl_b32 s68, s56, 1
s_add_u32 s68, s68, s59
s_add_u32 s69, s57, 2
s_and_b32 s69, s69, 7
s_lshl_b32 s69, s69, 1
s_add_u32 s69, s69, s60
s_lshl_b32 s70, s69, 14
s_lshl_b32 s71, s68, 12
s_add_u32 s70, s70, s71
s_add_u32 s70, s70, s63
s_add_u32 s70, s70, 0
v_lshlrev_b32 v252, 7, v1
s_mov_b32 exec_lo, 0xffffffff
s_mov_b32 exec_hi, 0x0
buffer_load_dword v253, v252, s[36:39], s70 offen sc1
s_mov_b64 exec, -1
L_npt_57:
s_lshl_b32 s68, s77, 1
s_add_u32 s68, s68, s60
s_lshl_b32 s69, s76, 1
s_add_u32 s69, s69, s59
s_lshl_b32 s70, s68, 14
s_lshl_b32 s71, s69, 11
s_add_u32 s70, s70, s71
s_add_u32 s70, s70, s63
s_add_u32 s70, s70, 262144
v_lshlrev_b32 v252, 7, v1
s_mov_b32 exec_lo, 0xffff
s_mov_b32 exec_hi, 0x0
buffer_load_dword v253, v252, s[36:39], s70 offen sc1
s_mov_b64 exec, -1
s_lshl_b32 s70, s68, 11
s_lshl_b32 s71, s69, 8
s_add_u32 s70, s70, s71
s_add_u32 s70, s70, s63
s_add_u32 s70, s70, 1540096
v_lshlrev_b32 v252, 7, v1
s_mov_b32 exec_lo, 0x3
s_mov_b32 exec_hi, 0x0
buffer_load_dword v253, v252, s[36:39], s70 offen sc1
s_mov_b64 exec, -1
s_cmp_eq_u32 s58, 0
s_cselect_b64 vcc, -1, 0
v_mfma_f32_32x32x16_bf16 v[64:79], v[224:227], v[216:219], v[64:79]
ds_read_b128 v[40:43], v18 offset:0
ds_read_b64_tr_b16 v[48:49], v21 offset:20480
v_mfma_f32_32x32x16_bf16 v[80:95], v[224:227], v[220:223], v[80:95]
ds_read_b64_tr_b16 v[50:51], v21 offset:20992
ds_read_b128 v[44:47], v18 offset:4096
v_mfma_f32_32x32x16_bf16 v[96:111], v[228:231], v[216:219], v[96:111]
ds_read_b64_tr_b16 v[52:53], v21 offset:28672
v_mfma_f32_32x32x16_bf16 v[112:127], v[228:231], v[220:223], v[112:127]
ds_read_b64_tr_b16 v[54:55], v21 offset:29184
s_cbranch_vccnz L_cs_58
v_mfma_f32_32x32x16_bf16 v[128:143], v[228:231], v[152:155], v[128:143]
L_cs_58:
s_waitcnt lgkmcnt(6)
v_mfma_f32_32x32x16_bf16 v[64:79], v[32:35], v[24:27], v[64:79]
ds_read_b128 v[216:219], v19 offset:0
ds_read_b64_tr_b16 v[224:225], v21 offset:22528
v_mfma_f32_32x32x16_bf16 v[80:95], v[32:35], v[28:31], v[80:95]
ds_read_b64_tr_b16 v[226:227], v21 offset:23040
ds_read_b128 v[220:223], v19 offset:4096
v_mfma_f32_32x32x16_bf16 v[96:111], v[36:39], v[24:27], v[96:111]
ds_read_b64_tr_b16 v[228:229], v21 offset:30720
v_mfma_f32_32x32x16_bf16 v[112:127], v[36:39], v[28:31], v[112:127]
ds_read_b64_tr_b16 v[230:231], v21 offset:31232
s_cbranch_vccnz L_cs_59
v_mfma_f32_32x32x16_bf16 v[128:143], v[36:39], v[152:155], v[128:143]
L_cs_59:
s_waitcnt lgkmcnt(0)
s_barrier
v_mfma_f32_32x32x16_bf16 v[64:79], v[48:51], v[40:43], v[64:79]
ds_read_b128 v[24:27], v12 offset:0
ds_read_b64_tr_b16 v[32:33], v20 offset:16384
v_mfma_f32_32x32x16_bf16 v[80:95], v[48:51], v[44:47], v[80:95]
ds_read_b64_tr_b16 v[34:35], v20 offset:16896
ds_read_b128 v[28:31], v12 offset:4096
v_mfma_f32_32x32x16_bf16 v[96:111], v[52:55], v[40:43], v[96:111]
ds_read_b64_tr_b16 v[36:37], v20 offset:24576
v_mfma_f32_32x32x16_bf16 v[112:127], v[52:55], v[44:47], v[112:127]
ds_read_b64_tr_b16 v[38:39], v20 offset:25088
s_cbranch_vccnz L_cs_60
v_mfma_f32_32x32x16_bf16 v[128:143], v[52:55], v[152:155], v[128:143]
L_cs_60:
v_mfma_f32_32x32x16_bf16 v[64:79], v[224:227], v[216:219], v[64:79]
ds_read_b128 v[40:43], v13 offset:0
ds_read_b64_tr_b16 v[48:49], v20 offset:18432
v_mfma_f32_32x32x16_bf16 v[80:95], v[224:227], v[220:223], v[80:95]
ds_read_b64_tr_b16 v[50:51], v20 offset:18944
ds_read_b128 v[44:47], v13 offset:4096
v_mfma_f32_32x32x16_bf16 v[96:111], v[228:231], v[216:219], v[96:111]
ds_read_b64_tr_b16 v[52:53], v20 offset:26624
v_mfma_f32_32x32x16_bf16 v[112:127], v[228:231], v[220:223], v[112:127]
ds_read_b64_tr_b16 v[54:55], v20 offset:27136
s_cbranch_vccnz L_cs_61
v_mfma_f32_32x32x16_bf16 v[128:143], v[228:231], v[152:155], v[128:143]
L_cs_61:
s_waitcnt lgkmcnt(6)
v_mfma_f32_32x32x16_bf16 v[64:79], v[32:35], v[24:27], v[64:79]
ds_read_b128 v[216:219], v14 offset:0
ds_read_b64_tr_b16 v[224:225], v20 offset:20480
v_mfma_f32_32x32x16_bf16 v[80:95], v[32:35], v[28:31], v[80:95]
ds_read_b64_tr_b16 v[226:227], v20 offset:20992
ds_read_b128 v[220:223], v14 offset:4096
v_mfma_f32_32x32x16_bf16 v[96:111], v[36:39], v[24:27], v[96:111]
ds_read_b64_tr_b16 v[228:229], v20 offset:28672
v_mfma_f32_32x32x16_bf16 v[112:127], v[36:39], v[28:31], v[112:127]
ds_read_b64_tr_b16 v[230:231], v20 offset:29184
s_cbranch_vccnz L_cs_62
v_mfma_f32_32x32x16_bf16 v[128:143], v[36:39], v[152:155], v[128:143]
L_cs_62:
s_waitcnt lgkmcnt(6)
v_mfma_f32_32x32x16_bf16 v[64:79], v[48:51], v[40:43], v[64:79]
ds_read_b128 v[24:27], v15 offset:0
ds_read_b64_tr_b16 v[32:33], v20 offset:22528
v_mfma_f32_32x32x16_bf16 v[80:95], v[48:51], v[44:47], v[80:95]
ds_read_b64_tr_b16 v[34:35], v20 offset:23040
ds_read_b128 v[28:31], v15 offset:4096
v_mfma_f32_32x32x16_bf16 v[96:111], v[52:55], v[40:43], v[96:111]
ds_read_b64_tr_b16 v[36:37], v20 offset:30720
v_mfma_f32_32x32x16_bf16 v[112:127], v[52:55], v[44:47], v[112:127]
ds_read_b64_tr_b16 v[38:39], v20 offset:31232
s_cbranch_vccnz L_cs_63
v_mfma_f32_32x32x16_bf16 v[128:143], v[52:55], v[152:155], v[128:143]
L_cs_63:
s_waitcnt lgkmcnt(0)
s_barrier
v_mfma_f32_32x32x16_bf16 v[64:79], v[224:227], v[216:219], v[64:79]
ds_read_b128 v[40:43], v12 offset:32768
ds_read_b64_tr_b16 v[48:49], v20 offset:49152
v_mfma_f32_32x32x16_bf16 v[80:95], v[224:227], v[220:223], v[80:95]
ds_read_b64_tr_b16 v[50:51], v20 offset:49664
ds_read_b128 v[44:47], v12 offset:36864
v_mfma_f32_32x32x16_bf16 v[96:111], v[228:231], v[216:219], v[96:111]
ds_read_b64_tr_b16 v[52:53], v20 offset:57344
v_mfma_f32_32x32x16_bf16 v[112:127], v[228:231], v[220:223], v[112:127]
ds_read_b64_tr_b16 v[54:55], v20 offset:57856
s_cbranch_vccnz L_cs_64
v_mfma_f32_32x32x16_bf16 v[128:143], v[228:231], v[152:155], v[128:143]
L_cs_64:
v_mfma_f32_32x32x16_bf16 v[64:79], v[32:35], v[24:27], v[64:79]
ds_read_b128 v[216:219], v13 offset:32768
ds_read_b64_tr_b16 v[224:225], v20 offset:51200
v_mfma_f32_32x32x16_bf16 v[80:95], v[32:35], v[28:31], v[80:95]
ds_read_b64_tr_b16 v[226:227], v20 offset:51712
ds_read_b128 v[220:223], v13 offset:36864
v_mfma_f32_32x32x16_bf16 v[96:111], v[36:39], v[24:27], v[96:111]
ds_read_b64_tr_b16 v[228:229], v20 offset:59392
v_mfma_f32_32x32x16_bf16 v[112:127], v[36:39], v[28:31], v[112:127]
ds_read_b64_tr_b16 v[230:231], v20 offset:59904
s_cbranch_vccnz L_cs_65
v_mfma_f32_32x32x16_bf16 v[128:143], v[36:39], v[152:155], v[128:143]
L_cs_65:
s_waitcnt lgkmcnt(6)
v_mfma_f32_32x32x16_bf16 v[64:79], v[48:51], v[40:43], v[64:79]
ds_read_b128 v[24:27], v14 offset:32768
ds_read_b64_tr_b16 v[32:33], v20 offset:53248
v_mfma_f32_32x32x16_bf16 v[80:95], v[48:51], v[44:47], v[80:95]
ds_read_b64_tr_b16 v[34:35], v20 offset:53760
ds_read_b128 v[28:31], v14 offset:36864
v_mfma_f32_32x32x16_bf16 v[96:111], v[52:55], v[40:43], v[96:111]
ds_read_b64_tr_b16 v[36:37], v20 offset:61440
v_mfma_f32_32x32x16_bf16 v[112:127], v[52:55], v[44:47], v[112:127]
ds_read_b64_tr_b16 v[38:39], v20 offset:61952
s_cbranch_vccnz L_cs_66
v_mfma_f32_32x32x16_bf16 v[128:143], v[52:55], v[152:155], v[128:143]
L_cs_66:
s_waitcnt lgkmcnt(6)
v_mfma_f32_32x32x16_bf16 v[64:79], v[224:227], v[216:219], v[64:79]
ds_read_b128 v[40:43], v15 offset:32768
ds_read_b64_tr_b16 v[48:49], v20 offset:55296
v_mfma_f32_32x32x16_bf16 v[80:95], v[224:227], v[220:223], v[80:95]
ds_read_b64_tr_b16 v[50:51], v20 offset:55808
ds_read_b128 v[44:47], v15 offset:36864
v_mfma_f32_32x32x16_bf16 v[96:111], v[228:231], v[216:219], v[96:111]
ds_read_b64_tr_b16 v[52:53], v20 offset:63488
v_mfma_f32_32x32x16_bf16 v[112:127], v[228:231], v[220:223], v[112:127]
ds_read_b64_tr_b16 v[54:55], v20 offset:64000
s_cbranch_vccnz L_cs_67
v_mfma_f32_32x32x16_bf16 v[128:143], v[228:231], v[152:155], v[128:143]
L_cs_67:
s_waitcnt lgkmcnt(6)
v_mfma_f32_32x32x16_bf16 v[64:79], v[32:35], v[24:27], v[64:79]
v_mfma_f32_32x32x16_bf16 v[80:95], v[32:35], v[28:31], v[80:95]
v_mfma_f32_32x32x16_bf16 v[96:111], v[36:39], v[24:27], v[96:111]
v_mfma_f32_32x32x16_bf16 v[112:127], v[36:39], v[28:31], v[112:127]
s_cbranch_vccnz L_cs_68
v_mfma_f32_32x32x16_bf16 v[128:143], v[36:39], v[152:155], v[128:143]
L_cs_68:
s_waitcnt lgkmcnt(0)
v_mfma_f32_32x32x16_bf16 v[64:79], v[48:51], v[40:43], v[64:79]
v_mfma_f32_32x32x16_bf16 v[80:95], v[48:51], v[44:47], v[80:95]
v_mfma_f32_32x32x16_bf16 v[96:111], v[52:55], v[40:43], v[96:111]
v_mfma_f32_32x32x16_bf16 v[112:127], v[52:55], v[44:47], v[112:127]
s_cbranch_vccnz L_cs_69
v_mfma_f32_32x32x16_bf16 v[128:143], v[52:55], v[152:155], v[128:143]
L_cs_69:
s_waitcnt lgkmcnt(0)
v_lshl_or_b32 v144, v160, 16, v144
v_lshl_or_b32 v145, v161, 16, v145
v_lshl_or_b32 v146, v162, 16, v146
v_lshl_or_b32 v147, v163, 16, v147
v_lshl_or_b32 v148, v164, 16, v148
v_lshl_or_b32 v149, v165, 16, v149
v_lshl_or_b32 v150, v166, 16, v150
v_lshl_or_b32 v151, v167, 16, v151
s_cmp_eq_u32 s58, 0
s_cbranch_scc0 L_typeB_70
s_lshl_b32 s68, s60, 1
v_add_u32 v59, s68, v3
s_lshl_b32 s68, s59, 6
v_add_u32 v58, s68, v2
v_lshlrev_b32 v58, 5, v58
v_lshlrev_b32 v56, 13, v59
v_add_u32 v56, v56, v58
v_lshlrev_b32 v57, 12, v59
v_add_u32 v57, v57, v58
v_add_u32 v57, 65536, v57
v_cvt_pk_bf16_f32 v24, v64, v65
v_cvt_pk_bf16_f32 v25, v66, v67
v_cvt_pk_bf16_f32 v26, v68, v69
v_cvt_pk_bf16_f32 v27, v70, v71
v_cvt_pk_bf16_f32 v28, v72, v73
v_cvt_pk_bf16_f32 v29, v74, v75
v_cvt_pk_bf16_f32 v30, v76, v77
v_cvt_pk_bf16_f32 v31, v78, v79
v_mfma_f32_32x32x16_bf16 v[128:143], v[144:147], v[24:27], 0
s_nop 0
v_mfma_f32_32x32x16_bf16 v[128:143], v[148:151], v[28:31], v[128:143]
v_cvt_pk_bf16_f32 v32, v80, v81
v_cvt_pk_bf16_f32 v33, v82, v83
v_cvt_pk_bf16_f32 v34, v84, v85
v_cvt_pk_bf16_f32 v35, v86, v87
v_cvt_pk_bf16_f32 v36, v88, v89
v_cvt_pk_bf16_f32 v37, v90, v91
v_cvt_pk_bf16_f32 v38, v92, v93
v_cvt_pk_bf16_f32 v39, v94, v95
v_mfma_f32_32x32x16_bf16 v[208:223], v[144:147], v[32:35], 0
s_nop 0
v_mfma_f32_32x32x16_bf16 v[208:223], v[148:151], v[36:39], v[208:223]
v_cvt_pk_bf16_f32 v224, v96, v97
v_cvt_pk_bf16_f32 v225, v98, v99
v_cvt_pk_bf16_f32 v226, v100, v101
v_cvt_pk_bf16_f32 v227, v102, v103
v_cvt_pk_bf16_f32 v228, v104, v105
v_cvt_pk_bf16_f32 v229, v106, v107
v_cvt_pk_bf16_f32 v230, v108, v109
v_cvt_pk_bf16_f32 v231, v110, v111
ds_write_b128 v57, v[224:227] offset:0
ds_write_b128 v57, v[228:231] offset:16
v_cvt_pk_bf16_f32 v224, v112, v113
v_cvt_pk_bf16_f32 v225, v114, v115
v_cvt_pk_bf16_f32 v226, v116, v117
v_cvt_pk_bf16_f32 v227, v118, v119
v_cvt_pk_bf16_f32 v228, v120, v121
v_cvt_pk_bf16_f32 v229, v122, v123
v_cvt_pk_bf16_f32 v230, v124, v125
v_cvt_pk_bf16_f32 v231, v126, v127
ds_write_b128 v57, v[224:227] offset:1024
ds_write_b128 v57, v[228:231] offset:1040
v_cvt_pk_bf16_f32 v232, v128, v129
v_cvt_pk_bf16_f32 v233, v130, v131
v_cvt_pk_bf16_f32 v234, v132, v133
v_cvt_pk_bf16_f32 v235, v134, v135
v_cvt_pk_bf16_f32 v236, v136, v137
v_cvt_pk_bf16_f32 v237, v138, v139
v_cvt_pk_bf16_f32 v238, v140, v141
v_cvt_pk_bf16_f32 v239, v142, v143
v_lshlrev_b32 v128, 16, v232
v_and_b32 v129, 0xffff0000, v232
v_lshlrev_b32 v130, 16, v233
v_and_b32 v131, 0xffff0000, v233
v_lshlrev_b32 v132, 16, v234
v_and_b32 v133, 0xffff0000, v234
v_lshlrev_b32 v134, 16, v235
v_and_b32 v135, 0xffff0000, v235
v_lshlrev_b32 v136, 16, v236
v_and_b32 v137, 0xffff0000, v236
v_lshlrev_b32 v138, 16, v237
v_and_b32 v139, 0xffff0000, v237
v_lshlrev_b32 v140, 16, v238
v_and_b32 v141, 0xffff0000, v238
v_lshlrev_b32 v142, 16, v239
v_and_b32 v143, 0xffff0000, v239
v_max3_f32 v232, v128, v129, v130
v_min3_f32 v233, v128, v129, v130
v_max3_f32 v234, v131, v132, v133
v_min3_f32 v235, v131, v132, v133
v_max3_f32 v232, v232, v134, v135
v_min3_f32 v233, v233, v134, v135
v_max3_f32 v234, v234, v136, v137
v_min3_f32 v235, v235, v136, v137
v_max3_f32 v232, v232, v138, v139
v_min3_f32 v233, v233, v138, v139
v_max3_f32 v234, v234, v140, v141
v_min3_f32 v235, v235, v140, v141
v_max3_f32 v232, v232, v142, v143
v_min3_f32 v233, v233, v142, v143
v_max_f32 v232, v232, v234
v_min_f32 v233, v233, v235
v_mul_f32 v236, s74, v232
v_mul_f32 v238, s74, v233
v_pk_fma_f32 v[24:25], v[128:129], s[74:75], v[236:237] op_sel_hi:[1,1,0] neg_lo:[0,0,1] neg_hi:[0,0,1]
v_pk_fma_f32 v[26:27], v[130:131], s[74:75], v[236:237] op_sel_hi:[1,1,0] neg_lo:[0,0,1] neg_hi:[0,0,1]
v_pk_fma_f32 v[28:29], v[132:133], s[74:75], v[236:237] op_sel_hi:[1,1,0] neg_lo:[0,0,1] neg_hi:[0,0,1]
v_pk_fma_f32 v[30:31], v[134:135], s[74:75], v[236:237] op_sel_hi:[1,1,0] neg_lo:[0,0,1] neg_hi:[0,0,1]
v_pk_fma_f32 v[32:33], v[136:137], s[74:75], v[236:237] op_sel_hi:[1,1,0] neg_lo:[0,0,1] neg_hi:[0,0,1]
v_pk_fma_f32 v[34:35], v[138:139], s[74:75], v[236:237] op_sel_hi:[1,1,0] neg_lo:[0,0,1] neg_hi:[0,0,1]
v_pk_fma_f32 v[36:37], v[140:141], s[74:75], v[236:237] op_sel_hi:[1,1,0] neg_lo:[0,0,1] neg_hi:[0,0,1]
v_pk_fma_f32 v[38:39], v[142:143], s[74:75], v[236:237] op_sel_hi:[1,1,0] neg_lo:[0,0,1] neg_hi:[0,0,1]
v_pk_fma_f32 v[40:41], v[128:129], s[74:75], v[238:239] op_sel_hi:[1,1,0] neg_lo:[0,1,0] neg_hi:[0,1,0]
v_pk_fma_f32 v[42:43], v[130:131], s[74:75], v[238:239] op_sel_hi:[1,1,0] neg_lo:[0,1,0] neg_hi:[0,1,0]
v_pk_fma_f32 v[44:45], v[132:133], s[74:75], v[238:239] op_sel_hi:[1,1,0] neg_lo:[0,1,0] neg_hi:[0,1,0]
v_pk_fma_f32 v[46:47], v[134:135], s[74:75], v[238:239] op_sel_hi:[1,1,0] neg_lo:[0,1,0] neg_hi:[0,1,0]
v_pk_fma_f32 v[48:49], v[136:137], s[74:75], v[238:239] op_sel_hi:[1,1,0] neg_lo:[0,1,0] neg_hi:[0,1,0]
v_pk_fma_f32 v[50:51], v[138:139], s[74:75], v[238:239] op_sel_hi:[1,1,0] neg_lo:[0,1,0] neg_hi:[0,1,0]
v_pk_fma_f32 v[52:53], v[140:141], s[74:75], v[238:239] op_sel_hi:[1,1,0] neg_lo:[0,1,0] neg_hi:[0,1,0]
v_pk_fma_f32 v[54:55], v[142:143], s[74:75], v[238:239] op_sel_hi:[1,1,0] neg_lo:[0,1,0] neg_hi:[0,1,0]
v_exp_f32 v24, v24
v_exp_f32 v25, v25
v_exp_f32 v26, v26
v_exp_f32 v27, v27
v_exp_f32 v28, v28
v_exp_f32 v29, v29
v_exp_f32 v30, v30
v_exp_f32 v31, v31
v_exp_f32 v32, v32
v_exp_f32 v33, v33
v_exp_f32 v34, v34
v_exp_f32 v35, v35
v_exp_f32 v36, v36
v_exp_f32 v37, v37
v_exp_f32 v38, v38
v_exp_f32 v39, v39
v_exp_f32 v40, v40
v_exp_f32 v41, v41
v_exp_f32 v42, v42
v_exp_f32 v43, v43
v_exp_f32 v44, v44
v_exp_f32 v45, v45
v_exp_f32 v46, v46
v_exp_f32 v47, v47
v_exp_f32 v48, v48
v_exp_f32 v49, v49
v_exp_f32 v50, v50
v_exp_f32 v51, v51
v_exp_f32 v52, v52
v_exp_f32 v53, v53
v_exp_f32 v54, v54
v_exp_f32 v55, v55
v_pk_add_f32 v[128:129], v[24:25], v[26:27]
v_pk_add_f32 v[130:131], v[28:29], v[30:31]
v_pk_add_f32 v[132:133], v[32:33], v[34:35]
v_pk_add_f32 v[134:135], v[36:37], v[38:39]
v_pk_add_f32 v[136:137], v[40:41], v[42:43]
v_pk_add_f32 v[138:139], v[44:45], v[46:47]
v_pk_add_f32 v[140:141], v[48:49], v[50:51]
v_pk_add_f32 v[142:143], v[52:53], v[54:55]
v_pk_add_f32 v[128:129], v[128:129], v[130:131]
v_pk_add_f32 v[132:133], v[132:133], v[134:135]
v_pk_add_f32 v[136:137], v[136:137], v[138:139]
v_pk_add_f32 v[140:141], v[140:141], v[142:143]
v_pk_add_f32 v[128:129], v[128:129], v[132:133]
v_pk_add_f32 v[136:137], v[136:137], v[140:141]
v_add_f32 v128, v128, v129
v_add_f32 v136, v136, v137
v_rcp_f32 v128, v128
v_rcp_f32 v136, v136
v_pk_mul_f32 v[24:25], v[24:25], v[128:129] op_sel_hi:[1,0]
v_pk_mul_f32 v[26:27], v[26:27], v[128:129] op_sel_hi:[1,0]
v_pk_mul_f32 v[28:29], v[28:29], v[128:129] op_sel_hi:[1,0]
v_pk_mul_f32 v[30:31], v[30:31], v[128:129] op_sel_hi:[1,0]
v_pk_mul_f32 v[32:33], v[32:33], v[128:129] op_sel_hi:[1,0]
v_pk_mul_f32 v[34:35], v[34:35], v[128:129] op_sel_hi:[1,0]
v_pk_mul_f32 v[36:37], v[36:37], v[128:129] op_sel_hi:[1,0]
v_pk_mul_f32 v[38:39], v[38:39], v[128:129] op_sel_hi:[1,0]
v_pk_mul_f32 v[40:41], v[40:41], v[136:137] op_sel_hi:[1,0]
v_pk_mul_f32 v[42:43], v[42:43], v[136:137] op_sel_hi:[1,0]
v_pk_mul_f32 v[44:45], v[44:45], v[136:137] op_sel_hi:[1,0]
v_pk_mul_f32 v[46:47], v[46:47], v[136:137] op_sel_hi:[1,0]
v_pk_mul_f32 v[48:49], v[48:49], v[136:137] op_sel_hi:[1,0]
v_pk_mul_f32 v[50:51], v[50:51], v[136:137] op_sel_hi:[1,0]
v_pk_mul_f32 v[52:53], v[52:53], v[136:137] op_sel_hi:[1,0]
v_pk_mul_f32 v[54:55], v[54:55], v[136:137] op_sel_hi:[1,0]
v_cvt_pk_bf16_f32 v64, v24, v25
v_cvt_pk_bf16_f32 v65, v26, v27
v_cvt_pk_bf16_f32 v66, v28, v29
v_cvt_pk_bf16_f32 v67, v30, v31
v_cvt_pk_bf16_f32 v68, v32, v33
v_cvt_pk_bf16_f32 v69, v34, v35
v_cvt_pk_bf16_f32 v70, v36, v37
v_cvt_pk_bf16_f32 v71, v38, v39
v_cvt_pk_bf16_f32 v72, v40, v41
v_cvt_pk_bf16_f32 v73, v42, v43
v_cvt_pk_bf16_f32 v74, v44, v45
v_cvt_pk_bf16_f32 v75, v46, v47
v_cvt_pk_bf16_f32 v76, v48, v49
v_cvt_pk_bf16_f32 v77, v50, v51
v_cvt_pk_bf16_f32 v78, v52, v53
v_cvt_pk_bf16_f32 v79, v54, v55
ds_write_b128 v56, v[64:67] offset:0
ds_write_b128 v56, v[68:71] offset:16
ds_write_b128 v56, v[72:75] offset:4096
ds_write_b128 v56, v[76:79] offset:4112
v_cvt_pk_bf16_f32 v232, v208, v209
v_cvt_pk_bf16_f32 v233, v210, v211
v_cvt_pk_bf16_f32 v234, v212, v213
v_cvt_pk_bf16_f32 v235, v214, v215
v_cvt_pk_bf16_f32 v236, v216, v217
v_cvt_pk_bf16_f32 v237, v218, v219
v_cvt_pk_bf16_f32 v238, v220, v221
v_cvt_pk_bf16_f32 v239, v222, v223
v_lshlrev_b32 v208, 16, v232
v_and_b32 v209, 0xffff0000, v232
v_lshlrev_b32 v210, 16, v233
v_and_b32 v211, 0xffff0000, v233
v_lshlrev_b32 v212, 16, v234
v_and_b32 v213, 0xffff0000, v234
v_lshlrev_b32 v214, 16, v235
v_and_b32 v215, 0xffff0000, v235
v_lshlrev_b32 v216, 16, v236
v_and_b32 v217, 0xffff0000, v236
v_lshlrev_b32 v218, 16, v237
v_and_b32 v219, 0xffff0000, v237
v_lshlrev_b32 v220, 16, v238
v_and_b32 v221, 0xffff0000, v238
v_lshlrev_b32 v222, 16, v239
v_and_b32 v223, 0xffff0000, v239
v_max3_f32 v232, v208, v209, v210
v_min3_f32 v233, v208, v209, v210
v_max3_f32 v234, v211, v212, v213
v_min3_f32 v235, v211, v212, v213
v_max3_f32 v232, v232, v214, v215
v_min3_f32 v233, v233, v214, v215
v_max3_f32 v234, v234, v216, v217
v_min3_f32 v235, v235, v216, v217
v_max3_f32 v232, v232, v218, v219
v_min3_f32 v233, v233, v218, v219
v_max3_f32 v234, v234, v220, v221
v_min3_f32 v235, v235, v220, v221
v_max3_f32 v232, v232, v222, v223
v_min3_f32 v233, v233, v222, v223
v_max_f32 v232, v232, v234
v_min_f32 v233, v233, v235
v_mul_f32 v236, s74, v232
v_mul_f32 v238, s74, v233
v_pk_fma_f32 v[24:25], v[208:209], s[74:75], v[236:237] op_sel_hi:[1,1,0] neg_lo:[0,0,1] neg_hi:[0,0,1]
v_pk_fma_f32 v[26:27], v[210:211], s[74:75], v[236:237] op_sel_hi:[1,1,0] neg_lo:[0,0,1] neg_hi:[0,0,1]
v_pk_fma_f32 v[28:29], v[212:213], s[74:75], v[236:237] op_sel_hi:[1,1,0] neg_lo:[0,0,1] neg_hi:[0,0,1]
v_pk_fma_f32 v[30:31], v[214:215], s[74:75], v[236:237] op_sel_hi:[1,1,0] neg_lo:[0,0,1] neg_hi:[0,0,1]
v_pk_fma_f32 v[32:33], v[216:217], s[74:75], v[236:237] op_sel_hi:[1,1,0] neg_lo:[0,0,1] neg_hi:[0,0,1]
v_pk_fma_f32 v[34:35], v[218:219], s[74:75], v[236:237] op_sel_hi:[1,1,0] neg_lo:[0,0,1] neg_hi:[0,0,1]
v_pk_fma_f32 v[36:37], v[220:221], s[74:75], v[236:237] op_sel_hi:[1,1,0] neg_lo:[0,0,1] neg_hi:[0,0,1]
v_pk_fma_f32 v[38:39], v[222:223], s[74:75], v[236:237] op_sel_hi:[1,1,0] neg_lo:[0,0,1] neg_hi:[0,0,1]
v_pk_fma_f32 v[40:41], v[208:209], s[74:75], v[238:239] op_sel_hi:[1,1,0] neg_lo:[0,1,0] neg_hi:[0,1,0]
v_pk_fma_f32 v[42:43], v[210:211], s[74:75], v[238:239] op_sel_hi:[1,1,0] neg_lo:[0,1,0] neg_hi:[0,1,0]
v_pk_fma_f32 v[44:45], v[212:213], s[74:75], v[238:239] op_sel_hi:[1,1,0] neg_lo:[0,1,0] neg_hi:[0,1,0]
v_pk_fma_f32 v[46:47], v[214:215], s[74:75], v[238:239] op_sel_hi:[1,1,0] neg_lo:[0,1,0] neg_hi:[0,1,0]
v_pk_fma_f32 v[48:49], v[216:217], s[74:75], v[238:239] op_sel_hi:[1,1,0] neg_lo:[0,1,0] neg_hi:[0,1,0]
v_pk_fma_f32 v[50:51], v[218:219], s[74:75], v[238:239] op_sel_hi:[1,1,0] neg_lo:[0,1,0] neg_hi:[0,1,0]
v_pk_fma_f32 v[52:53], v[220:221], s[74:75], v[238:239] op_sel_hi:[1,1,0] neg_lo:[0,1,0] neg_hi:[0,1,0]
v_pk_fma_f32 v[54:55], v[222:223], s[74:75], v[238:239] op_sel_hi:[1,1,0] neg_lo:[0,1,0] neg_hi:[0,1,0]
v_exp_f32 v24, v24
v_exp_f32 v25, v25
v_exp_f32 v26, v26
v_exp_f32 v27, v27
v_exp_f32 v28, v28
v_exp_f32 v29, v29
v_exp_f32 v30, v30
v_exp_f32 v31, v31
v_exp_f32 v32, v32
v_exp_f32 v33, v33
v_exp_f32 v34, v34
v_exp_f32 v35, v35
v_exp_f32 v36, v36
v_exp_f32 v37, v37
v_exp_f32 v38, v38
v_exp_f32 v39, v39
v_exp_f32 v40, v40
v_exp_f32 v41, v41
v_exp_f32 v42, v42
v_exp_f32 v43, v43
v_exp_f32 v44, v44
v_exp_f32 v45, v45
v_exp_f32 v46, v46
v_exp_f32 v47, v47
v_exp_f32 v48, v48
v_exp_f32 v49, v49
v_exp_f32 v50, v50
v_exp_f32 v51, v51
v_exp_f32 v52, v52
v_exp_f32 v53, v53
v_exp_f32 v54, v54
v_exp_f32 v55, v55
v_pk_add_f32 v[208:209], v[24:25], v[26:27]
v_pk_add_f32 v[210:211], v[28:29], v[30:31]
v_pk_add_f32 v[212:213], v[32:33], v[34:35]
v_pk_add_f32 v[214:215], v[36:37], v[38:39]
v_pk_add_f32 v[216:217], v[40:41], v[42:43]
v_pk_add_f32 v[218:219], v[44:45], v[46:47]
v_pk_add_f32 v[220:221], v[48:49], v[50:51]
v_pk_add_f32 v[222:223], v[52:53], v[54:55]
v_pk_add_f32 v[208:209], v[208:209], v[210:211]
v_pk_add_f32 v[212:213], v[212:213], v[214:215]
v_pk_add_f32 v[216:217], v[216:217], v[218:219]
v_pk_add_f32 v[220:221], v[220:221], v[222:223]
v_pk_add_f32 v[208:209], v[208:209], v[212:213]
v_pk_add_f32 v[216:217], v[216:217], v[220:221]
v_add_f32 v208, v208, v209
v_add_f32 v216, v216, v217
v_rcp_f32 v208, v208
v_rcp_f32 v216, v216
v_pk_mul_f32 v[24:25], v[24:25], v[208:209] op_sel_hi:[1,0]
v_pk_mul_f32 v[26:27], v[26:27], v[208:209] op_sel_hi:[1,0]
v_pk_mul_f32 v[28:29], v[28:29], v[208:209] op_sel_hi:[1,0]
v_pk_mul_f32 v[30:31], v[30:31], v[208:209] op_sel_hi:[1,0]
v_pk_mul_f32 v[32:33], v[32:33], v[208:209] op_sel_hi:[1,0]
v_pk_mul_f32 v[34:35], v[34:35], v[208:209] op_sel_hi:[1,0]
v_pk_mul_f32 v[36:37], v[36:37], v[208:209] op_sel_hi:[1,0]
v_pk_mul_f32 v[38:39], v[38:39], v[208:209] op_sel_hi:[1,0]
v_pk_mul_f32 v[40:41], v[40:41], v[216:217] op_sel_hi:[1,0]
v_pk_mul_f32 v[42:43], v[42:43], v[216:217] op_sel_hi:[1,0]
v_pk_mul_f32 v[44:45], v[44:45], v[216:217] op_sel_hi:[1,0]
v_pk_mul_f32 v[46:47], v[46:47], v[216:217] op_sel_hi:[1,0]
v_pk_mul_f32 v[48:49], v[48:49], v[216:217] op_sel_hi:[1,0]
v_pk_mul_f32 v[50:51], v[50:51], v[216:217] op_sel_hi:[1,0]
v_pk_mul_f32 v[52:53], v[52:53], v[216:217] op_sel_hi:[1,0]
v_pk_mul_f32 v[54:55], v[54:55], v[216:217] op_sel_hi:[1,0]
v_cvt_pk_bf16_f32 v80, v24, v25
v_cvt_pk_bf16_f32 v81, v26, v27
v_cvt_pk_bf16_f32 v82, v28, v29
v_cvt_pk_bf16_f32 v83, v30, v31
v_cvt_pk_bf16_f32 v84, v32, v33
v_cvt_pk_bf16_f32 v85, v34, v35
v_cvt_pk_bf16_f32 v86, v36, v37
v_cvt_pk_bf16_f32 v87, v38, v39
v_cvt_pk_bf16_f32 v88, v40, v41
v_cvt_pk_bf16_f32 v89, v42, v43
v_cvt_pk_bf16_f32 v90, v44, v45
v_cvt_pk_bf16_f32 v91, v46, v47
v_cvt_pk_bf16_f32 v92, v48, v49
v_cvt_pk_bf16_f32 v93, v50, v51
v_cvt_pk_bf16_f32 v94, v52, v53
v_cvt_pk_bf16_f32 v95, v54, v55
ds_write_b128 v56, v[80:83] offset:1024
ds_write_b128 v56, v[84:87] offset:1040
ds_write_b128 v56, v[88:91] offset:5120
ds_write_b128 v56, v[92:95] offset:5136
s_waitcnt lgkmcnt(0)
s_barrier
v_lshrrev_b32 v58, 4, v1
v_lshlrev_b32 v58, 2, v58
v_and_b32 v59, 15, v1
v_lshrrev_b32 v59, 2, v59
v_add_u32 v58, v58, v59
v_lshlrev_b32 v58, 5, v58
v_and_b32 v59, 3, v1
v_lshlrev_b32 v59, 3, v59
v_add_u32 v58, v58, v59
s_lshl_b32 s68, s5, 13
v_add_u32 v56, s68, v58
s_lshl_b32 s68, s5, 12
s_add_u32 s68, s68, 65536
v_add_u32 v57, s68, v58
v_mov_b32 v208, 0
v_mov_b32 v209, 0
v_mov_b32 v210, 0
v_mov_b32 v211, 0
v_mov_b32 v212, 0
v_mov_b32 v213, 0
v_mov_b32 v214, 0
v_mov_b32 v215, 0
v_mov_b32 v216, 0
v_mov_b32 v217, 0
v_mov_b32 v218, 0
v_mov_b32 v219, 0
v_mov_b32 v220, 0
v_mov_b32 v221, 0
v_mov_b32 v222, 0
v_mov_b32 v223, 0
ds_read_b64_tr_b16 v[64:65], v56 offset:0
ds_read_b64_tr_b16 v[68:69], v56 offset:4096
ds_read_b64_tr_b16 v[72:73], v57 offset:0
ds_read_b64_tr_b16 v[66:67], v56 offset:512
ds_read_b64_tr_b16 v[70:71], v56 offset:4608
ds_read_b64_tr_b16 v[74:75], v57 offset:512
ds_read_b64_tr_b16 v[76:77], v56 offset:1024
ds_read_b64_tr_b16 v[80:81], v56 offset:5120
ds_read_b64_tr_b16 v[84:85], v57 offset:1024
ds_read_b64_tr_b16 v[78:79], v56 offset:1536
ds_read_b64_tr_b16 v[82:83], v56 offset:5632
ds_read_b64_tr_b16 v[86:87], v57 offset:1536
s_waitcnt lgkmcnt(6)
v_mfma_f32_16x16x32_bf16 v[208:211], v[64:67], v[72:75], v[208:211]
v_mfma_f32_16x16x32_bf16 v[212:215], v[68:71], v[72:75], v[212:215]
v_mfma_f32_16x16x32_bf16 v[216:219], v[152:155], v[64:67], v[216:219]
v_mfma_f32_16x16x32_bf16 v[220:223], v[152:155], v[68:71], v[220:223]
ds_read_b64_tr_b16 v[88:89], v56 offset:2048
ds_read_b64_tr_b16 v[92:93], v56 offset:6144
ds_read_b64_tr_b16 v[96:97], v57 offset:2048
ds_read_b64_tr_b16 v[90:91], v56 offset:2560
ds_read_b64_tr_b16 v[94:95], v56 offset:6656
ds_read_b64_tr_b16 v[98:99], v57 offset:2560
s_waitcnt lgkmcnt(6)
v_mfma_f32_16x16x32_bf16 v[208:211], v[76:79], v[84:87], v[208:211]
v_mfma_f32_16x16x32_bf16 v[212:215], v[80:83], v[84:87], v[212:215]
v_mfma_f32_16x16x32_bf16 v[216:219], v[152:155], v[76:79], v[216:219]
v_mfma_f32_16x16x32_bf16 v[220:223], v[152:155], v[80:83], v[220:223]
ds_read_b64_tr_b16 v[100:101], v56 offset:3072
ds_read_b64_tr_b16 v[104:105], v56 offset:7168
ds_read_b64_tr_b16 v[108:109], v57 offset:3072
ds_read_b64_tr_b16 v[102:103], v56 offset:3584
ds_read_b64_tr_b16 v[106:107], v56 offset:7680
ds_read_b64_tr_b16 v[110:111], v57 offset:3584
s_waitcnt lgkmcnt(6)
v_mfma_f32_16x16x32_bf16 v[208:211], v[88:91], v[96:99], v[208:211]
v_mfma_f32_16x16x32_bf16 v[212:215], v[92:95], v[96:99], v[212:215]
v_mfma_f32_16x16x32_bf16 v[216:219], v[152:155], v[88:91], v[216:219]
v_mfma_f32_16x16x32_bf16 v[220:223], v[152:155], v[92:95], v[220:223]
s_waitcnt lgkmcnt(0)
s_barrier
v_mfma_f32_16x16x32_bf16 v[208:211], v[100:103], v[108:111], v[208:211]
v_mfma_f32_16x16x32_bf16 v[212:215], v[104:107], v[108:111], v[212:215]
v_mfma_f32_16x16x32_bf16 v[216:219], v[152:155], v[100:103], v[216:219]
v_mfma_f32_16x16x32_bf16 v[220:223], v[152:155], v[104:107], v[220:223]
s_lshl_b32 s68, s3, 1
s_add_u32 s68, s68, s56
s_lshl_b32 s69, s57, 2
s_add_u32 s69, s69, s5
s_lshl_b32 s70, s68, 16
s_lshl_b32 s71, s69, 11
s_add_u32 s70, s70, s71
s_add_u32 s70, s70, 1048576
v_and_b32 v58, 15, v1
v_lshlrev_b32 v59, 7, v58
v_lshrrev_b32 v56, 4, v1
v_lshlrev_b32 v56, 4, v56
v_add_u32 v59, v59, v56
buffer_store_dwordx4 v[208:211], v59, s[40:43], s70 offen sc1
buffer_store_dwordx4 v[212:215], v59, s[40:43], s70 offen offset:64 sc1
s_lshl_b32 s70, s68, 12
s_lshl_b32 s71, s69, 7
s_add_u32 s70, s70, s71
s_add_u32 s70, s70, 2097152
v_lshlrev_b32 v58, 2, v58
s_mov_b64 exec, 0xffff
buffer_store_dword v216, v58, s[40:43], s70 offen sc1
buffer_store_dword v220, v58, s[40:43], s70 offen offset:64 sc1
s_mov_b64 exec, -1
s_lshl_b32 s69, s69, 6
s_lshl_b32 s68, s68, 2
s_add_u32 s68, s68, s69
s_add_u32 s93, s68, 18432
s_branch L_s1join_71
L_typeB_70:
s_lshl_b32 s68, s56, 1
s_add_u32 s68, s68, s59
s_cmp_eq_u32 s68, 0
s_cselect_b32 s84, 1, s7
s_cmp_eq_u32 s68, 3
s_cselect_b32 s85, 1, s7
s_add_u32 s69, s57, 2
s_and_b32 s69, s69, 7
s_lshl_b32 s69, s69, 1
s_add_u32 s69, s69, s60
s_lshl_b32 s70, s69, 14
s_lshl_b32 s71, s68, 12
s_add_u32 s70, s70, s71
s_add_u32 s70, s70, s63
s_add_u32 s70, s70, 0
s_waitcnt vmcnt(2)
v_pk_mul_f32 v[24:25], v[128:129], v[156:157] op_sel:[0,1] op_sel_hi:[1,1]
v_pk_mul_f32 v[26:27], v[130:131], v[156:157] op_sel:[0,1] op_sel_hi:[1,1]
v_pk_mul_f32 v[28:29], v[132:133], v[156:157] op_sel:[0,1] op_sel_hi:[1,1]
v_pk_mul_f32 v[30:31], v[134:135], v[156:157] op_sel:[0,1] op_sel_hi:[1,1]
v_pk_mul_f32 v[32:33], v[136:137], v[156:157] op_sel:[0,1] op_sel_hi:[1,1]
v_pk_mul_f32 v[34:35], v[138:139], v[156:157] op_sel:[0,1] op_sel_hi:[1,1]
v_pk_mul_f32 v[36:37], v[140:141], v[156:157] op_sel:[0,1] op_sel_hi:[1,1]
v_pk_mul_f32 v[38:39], v[142:143], v[156:157] op_sel:[0,1] op_sel_hi:[1,1]
v_pk_fma_f32 v[96:97], v[96:97], v[156:157], v[24:25] op_sel_hi:[1,0,1]
v_pk_fma_f32 v[98:99], v[98:99], v[156:157], v[26:27] op_sel_hi:[1,0,1]
v_pk_fma_f32 v[100:101], v[100:101], v[156:157], v[28:29] op_sel_hi:[1,0,1]
v_pk_fma_f32 v[102:103], v[102:103], v[156:157], v[30:31] op_sel_hi:[1,0,1]
v_pk_fma_f32 v[104:105], v[104:105], v[156:157], v[32:33] op_sel_hi:[1,0,1]
v_pk_fma_f32 v[106:107], v[106:107], v[156:157], v[34:35] op_sel_hi:[1,0,1]
v_pk_fma_f32 v[108:109], v[108:109], v[156:157], v[36:37] op_sel_hi:[1,0,1]
v_pk_fma_f32 v[110:111], v[110:111], v[156:157], v[38:39] op_sel_hi:[1,0,1]
v_pk_mul_f32 v[40:41], v[96:97], v[96:97]
v_pk_mul_f32 v[42:43], v[98:99], v[98:99]
v_pk_mul_f32 v[44:45], v[100:101], v[100:101]
v_pk_mul_f32 v[46:47], v[102:103], v[102:103]
v_pk_mul_f32 v[48:49], v[104:105], v[104:105]
v_pk_mul_f32 v[50:51], v[106:107], v[106:107]
v_pk_mul_f32 v[52:53], v[108:109], v[108:109]
v_pk_mul_f32 v[54:55], v[110:111], v[110:111]
v_pk_fma_f32 v[40:41], v[40:41], s[80:81], v[200:201]
v_pk_fma_f32 v[42:43], v[42:43], s[80:81], v[200:201]
v_pk_fma_f32 v[44:45], v[44:45], s[80:81], v[200:201]
v_pk_fma_f32 v[46:47], v[46:47], s[80:81], v[200:201]
v_pk_fma_f32 v[48:49], v[48:49], s[80:81], v[200:201]
v_pk_fma_f32 v[50:51], v[50:51], s[80:81], v[200:201]
v_pk_fma_f32 v[52:53], v[52:53], s[80:81], v[200:201]
v_pk_fma_f32 v[54:55], v[54:55], s[80:81], v[200:201]
v_pk_mul_f32 v[40:41], v[40:41], v[96:97]
v_pk_mul_f32 v[42:43], v[42:43], v[98:99]
v_pk_mul_f32 v[44:45], v[44:45], v[100:101]
v_pk_mul_f32 v[46:47], v[46:47], v[102:103]
v_pk_mul_f32 v[48:49], v[48:49], v[104:105]
v_pk_mul_f32 v[50:51], v[50:51], v[106:107]
v_pk_mul_f32 v[52:53], v[52:53], v[108:109]
v_pk_mul_f32 v[54:55], v[54:55], v[110:111]
v_exp_f32 v40, v40
v_exp_f32 v41, v41
v_exp_f32 v42, v42
v_exp_f32 v43, v43
v_exp_f32 v44, v44
v_exp_f32 v45, v45
v_exp_f32 v46, v46
v_exp_f32 v47, v47
v_exp_f32 v48, v48
v_exp_f32 v49, v49
v_exp_f32 v50, v50
v_exp_f32 v51, v51
v_exp_f32 v52, v52
v_exp_f32 v53, v53
v_exp_f32 v54, v54
v_exp_f32 v55, v55
v_pk_add_f32 v[40:41], v[40:41], s[82:83]
v_pk_add_f32 v[42:43], v[42:43], s[82:83]
v_pk_add_f32 v[44:45], v[44:45], s[82:83]
v_pk_add_f32 v[46:47], v[46:47], s[82:83]
v_pk_add_f32 v[48:49], v[48:49], s[82:83]
v_pk_add_f32 v[50:51], v[50:51], s[82:83]
v_pk_add_f32 v[52:53], v[52:53], s[82:83]
v_pk_add_f32 v[54:55], v[54:55], s[82:83]
v_rcp_f32 v40, v40
v_rcp_f32 v41, v41
v_rcp_f32 v42, v42
v_rcp_f32 v43, v43
v_rcp_f32 v44, v44
v_rcp_f32 v45, v45
v_rcp_f32 v46, v46
v_rcp_f32 v47, v47
v_rcp_f32 v48, v48
v_rcp_f32 v49, v49
v_rcp_f32 v50, v50
v_rcp_f32 v51, v51
v_rcp_f32 v52, v52
v_rcp_f32 v53, v53
v_rcp_f32 v54, v54
v_rcp_f32 v55, v55
v_pk_mul_f32 v[96:97], v[96:97], v[40:41]
v_pk_mul_f32 v[98:99], v[98:99], v[42:43]
v_pk_mul_f32 v[100:101], v[100:101], v[44:45]
v_pk_mul_f32 v[102:103], v[102:103], v[46:47]
v_pk_mul_f32 v[104:105], v[104:105], v[48:49]
v_pk_mul_f32 v[106:107], v[106:107], v[50:51]
v_pk_mul_f32 v[108:109], v[108:109], v[52:53]
v_pk_mul_f32 v[110:111], v[110:111], v[54:55]
v_cvt_pk_bf16_f32 v208, v96, v97
v_cvt_pk_bf16_f32 v209, v98, v99
v_cvt_pk_bf16_f32 v210, v100, v101
v_cvt_pk_bf16_f32 v211, v102, v103
v_cvt_pk_bf16_f32 v212, v104, v105
v_cvt_pk_bf16_f32 v213, v106, v107
v_cvt_pk_bf16_f32 v214, v108, v109
v_cvt_pk_bf16_f32 v215, v110, v111
v_permlane16_swap_b32 v208, v212
v_permlane16_swap_b32 v209, v213
v_permlane16_swap_b32 v210, v214
v_permlane16_swap_b32 v211, v215
s_cmp_lg_u32 s84, 0
s_cbranch_scc1 L_sc_72
buffer_store_dwordx4 v[208:211], v206, s[36:39], s70 offen offset:0
s_branch L_sj_73
L_sc_72:
buffer_store_dwordx4 v[208:211], v206, s[36:39], s70 offen offset:0 sc1
L_sj_73:
s_cmp_lg_u32 s7, 0
s_cbranch_scc1 L_sc_74
buffer_store_dwordx4 v[212:215], v206, s[36:39], s70 offen offset:1024
s_branch L_sj_75
L_sc_74:
buffer_store_dwordx4 v[212:215], v206, s[36:39], s70 offen offset:1024 sc1
L_sj_75:
v_pk_mul_f32 v[24:25], v[128:129], v[158:159] op_sel:[0,1] op_sel_hi:[1,1]
v_pk_mul_f32 v[26:27], v[130:131], v[158:159] op_sel:[0,1] op_sel_hi:[1,1]
v_pk_mul_f32 v[28:29], v[132:133], v[158:159] op_sel:[0,1] op_sel_hi:[1,1]
v_pk_mul_f32 v[30:31], v[134:135], v[158:159] op_sel:[0,1] op_sel_hi:[1,1]
v_pk_mul_f32 v[32:33], v[136:137], v[158:159] op_sel:[0,1] op_sel_hi:[1,1]
v_pk_mul_f32 v[34:35], v[138:139], v[158:159] op_sel:[0,1] op_sel_hi:[1,1]
v_pk_mul_f32 v[36:37], v[140:141], v[158:159] op_sel:[0,1] op_sel_hi:[1,1]
v_pk_mul_f32 v[38:39], v[142:143], v[158:159] op_sel:[0,1] op_sel_hi:[1,1]
v_pk_fma_f32 v[112:113], v[112:113], v[158:159], v[24:25] op_sel_hi:[1,0,1]
v_pk_fma_f32 v[114:115], v[114:115], v[158:159], v[26:27] op_sel_hi:[1,0,1]
v_pk_fma_f32 v[116:117], v[116:117], v[158:159], v[28:29] op_sel_hi:[1,0,1]
v_pk_fma_f32 v[118:119], v[118:119], v[158:159], v[30:31] op_sel_hi:[1,0,1]
v_pk_fma_f32 v[120:121], v[120:121], v[158:159], v[32:33] op_sel_hi:[1,0,1]
v_pk_fma_f32 v[122:123], v[122:123], v[158:159], v[34:35] op_sel_hi:[1,0,1]
v_pk_fma_f32 v[124:125], v[124:125], v[158:159], v[36:37] op_sel_hi:[1,0,1]
v_pk_fma_f32 v[126:127], v[126:127], v[158:159], v[38:39] op_sel_hi:[1,0,1]
v_pk_mul_f32 v[40:41], v[112:113], v[112:113]
v_pk_mul_f32 v[42:43], v[114:115], v[114:115]
v_pk_mul_f32 v[44:45], v[116:117], v[116:117]
v_pk_mul_f32 v[46:47], v[118:119], v[118:119]
v_pk_mul_f32 v[48:49], v[120:121], v[120:121]
v_pk_mul_f32 v[50:51], v[122:123], v[122:123]
v_pk_mul_f32 v[52:53], v[124:125], v[124:125]
v_pk_mul_f32 v[54:55], v[126:127], v[126:127]
v_pk_fma_f32 v[40:41], v[40:41], s[80:81], v[200:201]
v_pk_fma_f32 v[42:43], v[42:43], s[80:81], v[200:201]
v_pk_fma_f32 v[44:45], v[44:45], s[80:81], v[200:201]
v_pk_fma_f32 v[46:47], v[46:47], s[80:81], v[200:201]
v_pk_fma_f32 v[48:49], v[48:49], s[80:81], v[200:201]
v_pk_fma_f32 v[50:51], v[50:51], s[80:81], v[200:201]
v_pk_fma_f32 v[52:53], v[52:53], s[80:81], v[200:201]
v_pk_fma_f32 v[54:55], v[54:55], s[80:81], v[200:201]
v_pk_mul_f32 v[40:41], v[40:41], v[112:113]
v_pk_mul_f32 v[42:43], v[42:43], v[114:115]
v_pk_mul_f32 v[44:45], v[44:45], v[116:117]
v_pk_mul_f32 v[46:47], v[46:47], v[118:119]
v_pk_mul_f32 v[48:49], v[48:49], v[120:121]
v_pk_mul_f32 v[50:51], v[50:51], v[122:123]
v_pk_mul_f32 v[52:53], v[52:53], v[124:125]
v_pk_mul_f32 v[54:55], v[54:55], v[126:127]
v_exp_f32 v40, v40
v_exp_f32 v41, v41
v_exp_f32 v42, v42
v_exp_f32 v43, v43
v_exp_f32 v44, v44
v_exp_f32 v45, v45
v_exp_f32 v46, v46
v_exp_f32 v47, v47
v_exp_f32 v48, v48
v_exp_f32 v49, v49
v_exp_f32 v50, v50
v_exp_f32 v51, v51
v_exp_f32 v52, v52
v_exp_f32 v53, v53
v_exp_f32 v54, v54
v_exp_f32 v55, v55
v_pk_add_f32 v[40:41], v[40:41], s[82:83]
v_pk_add_f32 v[42:43], v[42:43], s[82:83]
v_pk_add_f32 v[44:45], v[44:45], s[82:83]
v_pk_add_f32 v[46:47], v[46:47], s[82:83]
v_pk_add_f32 v[48:49], v[48:49], s[82:83]
v_pk_add_f32 v[50:51], v[50:51], s[82:83]
v_pk_add_f32 v[52:53], v[52:53], s[82:83]
v_pk_add_f32 v[54:55], v[54:55], s[82:83]
v_rcp_f32 v40, v40
v_rcp_f32 v41, v41
v_rcp_f32 v42, v42
v_rcp_f32 v43, v43
v_rcp_f32 v44, v44
v_rcp_f32 v45, v45
v_rcp_f32 v46, v46
v_rcp_f32 v47, v47
v_rcp_f32 v48, v48
v_rcp_f32 v49, v49
v_rcp_f32 v50, v50
v_rcp_f32 v51, v51
v_rcp_f32 v52, v52
v_rcp_f32 v53, v53
v_rcp_f32 v54, v54
v_rcp_f32 v55, v55
v_pk_mul_f32 v[112:113], v[112:113], v[40:41]
v_pk_mul_f32 v[114:115], v[114:115], v[42:43]
v_pk_mul_f32 v[116:117], v[116:117], v[44:45]
v_pk_mul_f32 v[118:119], v[118:119], v[46:47]
v_pk_mul_f32 v[120:121], v[120:121], v[48:49]
v_pk_mul_f32 v[122:123], v[122:123], v[50:51]
v_pk_mul_f32 v[124:125], v[124:125], v[52:53]
v_pk_mul_f32 v[126:127], v[126:127], v[54:55]
v_cvt_pk_bf16_f32 v216, v112, v113
v_cvt_pk_bf16_f32 v217, v114, v115
v_cvt_pk_bf16_f32 v218, v116, v117
v_cvt_pk_bf16_f32 v219, v118, v119
v_cvt_pk_bf16_f32 v220, v120, v121
v_cvt_pk_bf16_f32 v221, v122, v123
v_cvt_pk_bf16_f32 v222, v124, v125
v_cvt_pk_bf16_f32 v223, v126, v127
v_permlane16_swap_b32 v216, v220
v_permlane16_swap_b32 v217, v221
v_permlane16_swap_b32 v218, v222
v_permlane16_swap_b32 v219, v223
s_add_u32 s70, s70, 2048
s_cmp_lg_u32 s7, 0
s_cbranch_scc1 L_sc_76
buffer_store_dwordx4 v[216:219], v206, s[36:39], s70 offen offset:0
s_branch L_sj_77
L_sc_76:
buffer_store_dwordx4 v[216:219], v206, s[36:39], s70 offen offset:0 sc1
L_sj_77:
s_cmp_lg_u32 s85, 0
s_cbranch_scc1 L_sc_78
buffer_store_dwordx4 v[220:223], v206, s[36:39], s70 offen offset:1024
s_branch L_sj_79
L_sc_78:
buffer_store_dwordx4 v[220:223], v206, s[36:39], s70 offen offset:1024 sc1
L_sj_79:
s_lshl_b32 s70, s3, 8
s_lshl_b32 s71, s68, 6
s_add_u32 s70, s70, s71
s_lshl_b32 s71, s69, 2
s_add_u32 s70, s70, s71
s_add_u32 s70, s70, 24576
s_lshl_b32 s72, s3, 7
s_add_u32 s72, s72, s71
s_add_u32 s72, s72, 16384
s_cmp_eq_u32 s68, 3
s_cselect_b32 s71, 64, 0
s_add_u32 s72, s72, s71
s_mov_b32 s86, s68
v_cvt_pk_bf16_f32 v224, v64, v65
v_cvt_pk_bf16_f32 v225, v66, v67
v_cvt_pk_bf16_f32 v226, v68, v69
v_cvt_pk_bf16_f32 v227, v70, v71
v_cvt_pk_bf16_f32 v228, v72, v73
v_cvt_pk_bf16_f32 v229, v74, v75
v_cvt_pk_bf16_f32 v230, v76, v77
v_cvt_pk_bf16_f32 v231, v78, v79
v_cvt_pk_bf16_f32 v232, v80, v81
v_cvt_pk_bf16_f32 v233, v82, v83
v_cvt_pk_bf16_f32 v234, v84, v85
v_cvt_pk_bf16_f32 v235, v86, v87
v_cvt_pk_bf16_f32 v236, v88, v89
v_cvt_pk_bf16_f32 v237, v90, v91
v_cvt_pk_bf16_f32 v238, v92, v93
v_cvt_pk_bf16_f32 v239, v94, v95
v_mfma_f32_32x32x16_bf16 v[96:111], v[144:147], v[224:227], 0
v_mfma_f32_32x32x16_bf16 v[96:111], v[148:151], v[228:231], v[96:111]
v_mfma_f32_32x32x16_bf16 v[112:127], v[144:147], v[232:235], 0
v_mfma_f32_32x32x16_bf16 v[112:127], v[148:151], v[236:239], v[112:127]
s_nop 9
v_cvt_pk_bf16_f32 v240, v96, v97
v_cvt_pk_bf16_f32 v241, v98, v99
v_cvt_pk_bf16_f32 v242, v100, v101
v_cvt_pk_bf16_f32 v243, v102, v103
v_cvt_pk_bf16_f32 v244, v104, v105
v_cvt_pk_bf16_f32 v245, v106, v107
v_cvt_pk_bf16_f32 v246, v108, v109
v_cvt_pk_bf16_f32 v247, v110, v111
v_lshlrev_b32 v96, 16, v240
v_and_b32 v97, 0xffff0000, v240
v_lshlrev_b32 v98, 16, v241
v_and_b32 v99, 0xffff0000, v241
v_lshlrev_b32 v100, 16, v242
v_and_b32 v101, 0xffff0000, v242
v_lshlrev_b32 v102, 16, v243
v_and_b32 v103, 0xffff0000, v243
v_lshlrev_b32 v104, 16, v244
v_and_b32 v105, 0xffff0000, v244
v_lshlrev_b32 v106, 16, v245
v_and_b32 v107, 0xffff0000, v245
v_lshlrev_b32 v108, 16, v246
v_and_b32 v109, 0xffff0000, v246
v_lshlrev_b32 v110, 16, v247
v_and_b32 v111, 0xffff0000, v247
v_max3_f32 v240, v96, v97, v98
v_min3_f32 v241, v96, v97, v98
v_max3_f32 v242, v99, v100, v101
v_min3_f32 v243, v99, v100, v101
v_max3_f32 v240, v240, v102, v103
v_min3_f32 v241, v241, v102, v103
v_max3_f32 v242, v242, v104, v105
v_min3_f32 v243, v243, v104, v105
v_max3_f32 v240, v240, v106, v107
v_min3_f32 v241, v241, v106, v107
v_max3_f32 v242, v242, v108, v109
v_min3_f32 v243, v243, v108, v109
v_max3_f32 v240, v240, v110, v111
v_min3_f32 v241, v241, v110, v111
v_max_f32 v240, v240, v242
v_min_f32 v241, v241, v243
v_mul_f32 v244, s74, v240
v_mul_f32 v246, s74, v241
v_pk_fma_f32 v[24:25], v[96:97], s[74:75], v[244:245] op_sel_hi:[1,1,0] neg_lo:[0,0,1] neg_hi:[0,0,1]
v_pk_fma_f32 v[26:27], v[98:99], s[74:75], v[244:245] op_sel_hi:[1,1,0] neg_lo:[0,0,1] neg_hi:[0,0,1]
v_pk_fma_f32 v[28:29], v[100:101], s[74:75], v[244:245] op_sel_hi:[1,1,0] neg_lo:[0,0,1] neg_hi:[0,0,1]
v_pk_fma_f32 v[30:31], v[102:103], s[74:75], v[244:245] op_sel_hi:[1,1,0] neg_lo:[0,0,1] neg_hi:[0,0,1]
v_pk_fma_f32 v[32:33], v[104:105], s[74:75], v[244:245] op_sel_hi:[1,1,0] neg_lo:[0,0,1] neg_hi:[0,0,1]
v_pk_fma_f32 v[34:35], v[106:107], s[74:75], v[244:245] op_sel_hi:[1,1,0] neg_lo:[0,0,1] neg_hi:[0,0,1]
v_pk_fma_f32 v[36:37], v[108:109], s[74:75], v[244:245] op_sel_hi:[1,1,0] neg_lo:[0,0,1] neg_hi:[0,0,1]
v_pk_fma_f32 v[38:39], v[110:111], s[74:75], v[244:245] op_sel_hi:[1,1,0] neg_lo:[0,0,1] neg_hi:[0,0,1]
v_pk_fma_f32 v[40:41], v[96:97], s[74:75], v[246:247] op_sel_hi:[1,1,0] neg_lo:[0,1,0] neg_hi:[0,1,0]
v_pk_fma_f32 v[42:43], v[98:99], s[74:75], v[246:247] op_sel_hi:[1,1,0] neg_lo:[0,1,0] neg_hi:[0,1,0]
v_pk_fma_f32 v[44:45], v[100:101], s[74:75], v[246:247] op_sel_hi:[1,1,0] neg_lo:[0,1,0] neg_hi:[0,1,0]
v_pk_fma_f32 v[46:47], v[102:103], s[74:75], v[246:247] op_sel_hi:[1,1,0] neg_lo:[0,1,0] neg_hi:[0,1,0]
v_pk_fma_f32 v[48:49], v[104:105], s[74:75], v[246:247] op_sel_hi:[1,1,0] neg_lo:[0,1,0] neg_hi:[0,1,0]
v_pk_fma_f32 v[50:51], v[106:107], s[74:75], v[246:247] op_sel_hi:[1,1,0] neg_lo:[0,1,0] neg_hi:[0,1,0]
v_pk_fma_f32 v[52:53], v[108:109], s[74:75], v[246:247] op_sel_hi:[1,1,0] neg_lo:[0,1,0] neg_hi:[0,1,0]
v_pk_fma_f32 v[54:55], v[110:111], s[74:75], v[246:247] op_sel_hi:[1,1,0] neg_lo:[0,1,0] neg_hi:[0,1,0]
v_exp_f32 v24, v24
v_exp_f32 v25, v25
v_exp_f32 v26, v26
v_exp_f32 v27, v27
v_exp_f32 v28, v28
v_exp_f32 v29, v29
v_exp_f32 v30, v30
v_exp_f32 v31, v31
v_exp_f32 v32, v32
v_exp_f32 v33, v33
v_exp_f32 v34, v34
v_exp_f32 v35, v35
v_exp_f32 v36, v36
v_exp_f32 v37, v37
v_exp_f32 v38, v38
v_exp_f32 v39, v39
s_waitcnt vmcnt(0)
v_mov_b32 v250, s6
v_mov_b32 v251, s70
s_mov_b64 exec, 1
s_cmp_lg_u32 s7, 0
s_cbranch_scc1 L_sc_80
buffer_store_dword v250, v251, s[40:43], 0 offen
s_branch L_sj_81
L_sc_80:
buffer_store_dword v250, v251, s[40:43], 0 offen sc1
L_sj_81:
s_mov_b64 exec, -1
s_cmp_eq_u32 s86, 0
s_cselect_b32 s71, 1, 0
s_cmp_eq_u32 s86, 3
s_cselect_b32 s71, 1, s71
s_cmp_eq_u32 s71, 0
s_cbranch_scc1 L_ne_82
v_mov_b32 v250, s6
v_mov_b32 v251, s72
s_mov_b64 exec, 1
buffer_store_dword v250, v251, s[40:43], 0 offen sc1
s_mov_b64 exec, -1
L_ne_82:
v_exp_f32 v40, v40
v_exp_f32 v41, v41
v_exp_f32 v42, v42
v_exp_f32 v43, v43
v_exp_f32 v44, v44
v_exp_f32 v45, v45
v_exp_f32 v46, v46
v_exp_f32 v47, v47
v_exp_f32 v48, v48
v_exp_f32 v49, v49
v_exp_f32 v50, v50
v_exp_f32 v51, v51
v_exp_f32 v52, v52
v_exp_f32 v53, v53
v_exp_f32 v54, v54
v_exp_f32 v55, v55
v_pk_add_f32 v[96:97], v[24:25], v[26:27]
v_pk_add_f32 v[98:99], v[28:29], v[30:31]
v_pk_add_f32 v[100:101], v[32:33], v[34:35]
v_pk_add_f32 v[102:103], v[36:37], v[38:39]
v_pk_add_f32 v[104:105], v[40:41], v[42:43]
v_pk_add_f32 v[106:107], v[44:45], v[46:47]
v_pk_add_f32 v[108:109], v[48:49], v[50:51]
v_pk_add_f32 v[110:111], v[52:53], v[54:55]
v_pk_add_f32 v[96:97], v[96:97], v[98:99]
v_pk_add_f32 v[100:101], v[100:101], v[102:103]
v_pk_add_f32 v[104:105], v[104:105], v[106:107]
v_pk_add_f32 v[108:109], v[108:109], v[110:111]
v_pk_add_f32 v[96:97], v[96:97], v[100:101]
v_pk_add_f32 v[104:105], v[104:105], v[108:109]
v_add_f32 v96, v96, v97
v_add_f32 v104, v104, v105
v_rcp_f32 v96, v96
v_rcp_f32 v104, v104
v_pk_mul_f32 v[24:25], v[24:25], v[96:97] op_sel_hi:[1,0]
v_pk_mul_f32 v[26:27], v[26:27], v[96:97] op_sel_hi:[1,0]
v_pk_mul_f32 v[28:29], v[28:29], v[96:97] op_sel_hi:[1,0]
v_pk_mul_f32 v[30:31], v[30:31], v[96:97] op_sel_hi:[1,0]
v_pk_mul_f32 v[32:33], v[32:33], v[96:97] op_sel_hi:[1,0]
v_pk_mul_f32 v[34:35], v[34:35], v[96:97] op_sel_hi:[1,0]
v_pk_mul_f32 v[36:37], v[36:37], v[96:97] op_sel_hi:[1,0]
v_pk_mul_f32 v[38:39], v[38:39], v[96:97] op_sel_hi:[1,0]
v_pk_mul_f32 v[40:41], v[40:41], v[104:105] op_sel_hi:[1,0]
v_pk_mul_f32 v[42:43], v[42:43], v[104:105] op_sel_hi:[1,0]
v_pk_mul_f32 v[44:45], v[44:45], v[104:105] op_sel_hi:[1,0]
v_pk_mul_f32 v[46:47], v[46:47], v[104:105] op_sel_hi:[1,0]
v_pk_mul_f32 v[48:49], v[48:49], v[104:105] op_sel_hi:[1,0]
v_pk_mul_f32 v[50:51], v[50:51], v[104:105] op_sel_hi:[1,0]
v_pk_mul_f32 v[52:53], v[52:53], v[104:105] op_sel_hi:[1,0]
v_pk_mul_f32 v[54:55], v[54:55], v[104:105] op_sel_hi:[1,0]
v_cvt_pk_bf16_f32 v160, v24, v25
v_cvt_pk_bf16_f32 v161, v26, v27
v_cvt_pk_bf16_f32 v162, v28, v29
v_cvt_pk_bf16_f32 v163, v30, v31
v_cvt_pk_bf16_f32 v164, v32, v33
v_cvt_pk_bf16_f32 v165, v34, v35
v_cvt_pk_bf16_f32 v166, v36, v37
v_cvt_pk_bf16_f32 v167, v38, v39
v_cvt_pk_bf16_f32 v168, v40, v41
v_cvt_pk_bf16_f32 v169, v42, v43
v_cvt_pk_bf16_f32 v170, v44, v45
v_cvt_pk_bf16_f32 v171, v46, v47
v_cvt_pk_bf16_f32 v172, v48, v49
v_cvt_pk_bf16_f32 v173, v50, v51
v_cvt_pk_bf16_f32 v174, v52, v53
v_cvt_pk_bf16_f32 v175, v54, v55
s_barrier
s_barrier
v_cvt_pk_bf16_f32 v240, v112, v113
v_cvt_pk_bf16_f32 v241, v114, v115
v_cvt_pk_bf16_f32 v242, v116, v117
v_cvt_pk_bf16_f32 v243, v118, v119
v_cvt_pk_bf16_f32 v244, v120, v121
v_cvt_pk_bf16_f32 v245, v122, v123
v_cvt_pk_bf16_f32 v246, v124, v125
v_cvt_pk_bf16_f32 v247, v126, v127
v_lshlrev_b32 v112, 16, v240
v_and_b32 v113, 0xffff0000, v240
v_lshlrev_b32 v114, 16, v241
v_and_b32 v115, 0xffff0000, v241
v_lshlrev_b32 v116, 16, v242
v_and_b32 v117, 0xffff0000, v242
v_lshlrev_b32 v118, 16, v243
v_and_b32 v119, 0xffff0000, v243
v_lshlrev_b32 v120, 16, v244
v_and_b32 v121, 0xffff0000, v244
v_lshlrev_b32 v122, 16, v245
v_and_b32 v123, 0xffff0000, v245
v_lshlrev_b32 v124, 16, v246
v_and_b32 v125, 0xffff0000, v246
v_lshlrev_b32 v126, 16, v247
v_and_b32 v127, 0xffff0000, v247
v_max3_f32 v240, v112, v113, v114
v_min3_f32 v241, v112, v113, v114
v_max3_f32 v242, v115, v116, v117
v_min3_f32 v243, v115, v116, v117
v_max3_f32 v240, v240, v118, v119
v_min3_f32 v241, v241, v118, v119
v_max3_f32 v242, v242, v120, v121
v_min3_f32 v243, v243, v120, v121
v_max3_f32 v240, v240, v122, v123
v_min3_f32 v241, v241, v122, v123
v_max3_f32 v242, v242, v124, v125
v_min3_f32 v243, v243, v124, v125
v_max3_f32 v240, v240, v126, v127
v_min3_f32 v241, v241, v126, v127
v_max_f32 v240, v240, v242
v_min_f32 v241, v241, v243
v_mul_f32 v244, s74, v240
v_mul_f32 v246, s74, v241
v_pk_fma_f32 v[24:25], v[112:113], s[74:75], v[244:245] op_sel_hi:[1,1,0] neg_lo:[0,0,1] neg_hi:[0,0,1]
v_pk_fma_f32 v[26:27], v[114:115], s[74:75], v[244:245] op_sel_hi:[1,1,0] neg_lo:[0,0,1] neg_hi:[0,0,1]
v_pk_fma_f32 v[28:29], v[116:117], s[74:75], v[244:245] op_sel_hi:[1,1,0] neg_lo:[0,0,1] neg_hi:[0,0,1]
v_pk_fma_f32 v[30:31], v[118:119], s[74:75], v[244:245] op_sel_hi:[1,1,0] neg_lo:[0,0,1] neg_hi:[0,0,1]
v_pk_fma_f32 v[32:33], v[120:121], s[74:75], v[244:245] op_sel_hi:[1,1,0] neg_lo:[0,0,1] neg_hi:[0,0,1]
v_pk_fma_f32 v[34:35], v[122:123], s[74:75], v[244:245] op_sel_hi:[1,1,0] neg_lo:[0,0,1] neg_hi:[0,0,1]
v_pk_fma_f32 v[36:37], v[124:125], s[74:75], v[244:245] op_sel_hi:[1,1,0] neg_lo:[0,0,1] neg_hi:[0,0,1]
v_pk_fma_f32 v[38:39], v[126:127], s[74:75], v[244:245] op_sel_hi:[1,1,0] neg_lo:[0,0,1] neg_hi:[0,0,1]
v_pk_fma_f32 v[40:41], v[112:113], s[74:75], v[246:247] op_sel_hi:[1,1,0] neg_lo:[0,1,0] neg_hi:[0,1,0]
v_pk_fma_f32 v[42:43], v[114:115], s[74:75], v[246:247] op_sel_hi:[1,1,0] neg_lo:[0,1,0] neg_hi:[0,1,0]
v_pk_fma_f32 v[44:45], v[116:117], s[74:75], v[246:247] op_sel_hi:[1,1,0] neg_lo:[0,1,0] neg_hi:[0,1,0]
v_pk_fma_f32 v[46:47], v[118:119], s[74:75], v[246:247] op_sel_hi:[1,1,0] neg_lo:[0,1,0] neg_hi:[0,1,0]
v_pk_fma_f32 v[48:49], v[120:121], s[74:75], v[246:247] op_sel_hi:[1,1,0] neg_lo:[0,1,0] neg_hi:[0,1,0]
v_pk_fma_f32 v[50:51], v[122:123], s[74:75], v[246:247] op_sel_hi:[1,1,0] neg_lo:[0,1,0] neg_hi:[0,1,0]
v_pk_fma_f32 v[52:53], v[124:125], s[74:75], v[246:247] op_sel_hi:[1,1,0] neg_lo:[0,1,0] neg_hi:[0,1,0]
v_pk_fma_f32 v[54:55], v[126:127], s[74:75], v[246:247] op_sel_hi:[1,1,0] neg_lo:[0,1,0] neg_hi:[0,1,0]
v_exp_f32 v24, v24
v_exp_f32 v25, v25
v_exp_f32 v26, v26
v_exp_f32 v27, v27
v_exp_f32 v28, v28
v_exp_f32 v29, v29
v_exp_f32 v30, v30
v_exp_f32 v31, v31
v_exp_f32 v32, v32
v_exp_f32 v33, v33
v_exp_f32 v34, v34
v_exp_f32 v35, v35
v_exp_f32 v36, v36
v_exp_f32 v37, v37
v_exp_f32 v38, v38
v_exp_f32 v39, v39
v_exp_f32 v40, v40
v_exp_f32 v41, v41
v_exp_f32 v42, v42
v_exp_f32 v43, v43
v_exp_f32 v44, v44
v_exp_f32 v45, v45
v_exp_f32 v46, v46
v_exp_f32 v47, v47
v_exp_f32 v48, v48
v_exp_f32 v49, v49
v_exp_f32 v50, v50
v_exp_f32 v51, v51
v_exp_f32 v52, v52
v_exp_f32 v53, v53
v_exp_f32 v54, v54
v_exp_f32 v55, v55
v_pk_add_f32 v[112:113], v[24:25], v[26:27]
v_pk_add_f32 v[114:115], v[28:29], v[30:31]
v_pk_add_f32 v[116:117], v[32:33], v[34:35]
v_pk_add_f32 v[118:119], v[36:37], v[38:39]
v_pk_add_f32 v[120:121], v[40:41], v[42:43]
v_pk_add_f32 v[122:123], v[44:45], v[46:47]
v_pk_add_f32 v[124:125], v[48:49], v[50:51]
v_pk_add_f32 v[126:127], v[52:53], v[54:55]
v_pk_add_f32 v[112:113], v[112:113], v[114:115]
v_pk_add_f32 v[116:117], v[116:117], v[118:119]
v_pk_add_f32 v[120:121], v[120:121], v[122:123]
v_pk_add_f32 v[124:125], v[124:125], v[126:127]
v_pk_add_f32 v[112:113], v[112:113], v[116:117]
v_pk_add_f32 v[120:121], v[120:121], v[124:125]
v_add_f32 v112, v112, v113
v_add_f32 v120, v120, v121
v_rcp_f32 v112, v112
v_rcp_f32 v120, v120
v_pk_mul_f32 v[24:25], v[24:25], v[112:113] op_sel_hi:[1,0]
v_pk_mul_f32 v[26:27], v[26:27], v[112:113] op_sel_hi:[1,0]
v_pk_mul_f32 v[28:29], v[28:29], v[112:113] op_sel_hi:[1,0]
v_pk_mul_f32 v[30:31], v[30:31], v[112:113] op_sel_hi:[1,0]
v_pk_mul_f32 v[32:33], v[32:33], v[112:113] op_sel_hi:[1,0]
v_pk_mul_f32 v[34:35], v[34:35], v[112:113] op_sel_hi:[1,0]
v_pk_mul_f32 v[36:37], v[36:37], v[112:113] op_sel_hi:[1,0]
v_pk_mul_f32 v[38:39], v[38:39], v[112:113] op_sel_hi:[1,0]
v_pk_mul_f32 v[40:41], v[40:41], v[120:121] op_sel_hi:[1,0]
v_pk_mul_f32 v[42:43], v[42:43], v[120:121] op_sel_hi:[1,0]
v_pk_mul_f32 v[44:45], v[44:45], v[120:121] op_sel_hi:[1,0]
v_pk_mul_f32 v[46:47], v[46:47], v[120:121] op_sel_hi:[1,0]
v_pk_mul_f32 v[48:49], v[48:49], v[120:121] op_sel_hi:[1,0]
v_pk_mul_f32 v[50:51], v[50:51], v[120:121] op_sel_hi:[1,0]
v_pk_mul_f32 v[52:53], v[52:53], v[120:121] op_sel_hi:[1,0]
v_pk_mul_f32 v[54:55], v[54:55], v[120:121] op_sel_hi:[1,0]
v_cvt_pk_bf16_f32 v176, v24, v25
v_cvt_pk_bf16_f32 v177, v26, v27
v_cvt_pk_bf16_f32 v178, v28, v29
v_cvt_pk_bf16_f32 v179, v30, v31
v_cvt_pk_bf16_f32 v180, v32, v33
v_cvt_pk_bf16_f32 v181, v34, v35
v_cvt_pk_bf16_f32 v182, v36, v37
v_cvt_pk_bf16_f32 v183, v38, v39
v_cvt_pk_bf16_f32 v184, v40, v41
v_cvt_pk_bf16_f32 v185, v42, v43
v_cvt_pk_bf16_f32 v186, v44, v45
v_cvt_pk_bf16_f32 v187, v46, v47
v_cvt_pk_bf16_f32 v188, v48, v49
v_cvt_pk_bf16_f32 v189, v50, v51
v_cvt_pk_bf16_f32 v190, v52, v53
v_cvt_pk_bf16_f32 v191, v54, v55
L_s1join_71:
s_cmp_eq_u32 s58, 0
s_cbranch_scc0 L_nkf_83
s_waitcnt vmcnt(0)
v_mov_b32 v250, s6
v_mov_b32 v251, s93
s_mov_b64 exec, 1
buffer_store_dword v250, v251, s[40:43], 0 offen sc1
s_mov_b64 exec, -1
L_nkf_83:
s_lshl_b32 s68, s3, 8
s_lshl_b32 s69, s76, 6
s_add_u32 s68, s68, s69
s_lshl_b32 s69, s59, 5
s_add_u32 s86, s68, s69
s_lshl_b32 s68, s77, 7
s_lshl_b32 s69, s60, 6
s_add_u32 s68, s68, s69
v_add_u32 v57, s86, v2
v_lshlrev_b32 v58, 10, v57
v_lshlrev_b32 v59, 5, v3
v_add_u32 v58, v58, v59
buffer_load_dwordx4 v[212:215], v58, s[8:11], s68 offen
buffer_load_dwordx4 v[216:219], v58, s[8:11], s68 offen offset:16
v_lshlrev_b32 v57, 2, v57
s_mov_b32 s68, 2244608
buffer_load_dword v207, v57, s[40:43], s68 offen sc1
v_add_u32 v220, 98304, v205
s_barrier
ds_read_b128 v[24:27], v203 offset:0
ds_read_b64_tr_b16 v[32:33], v220 offset:0
ds_read_b64_tr_b16 v[34:35], v220 offset:512
ds_read_b128 v[28:31], v204 offset:0
ds_read_b64_tr_b16 v[36:37], v220 offset:2048
ds_read_b64_tr_b16 v[38:39], v220 offset:2560
ds_read_b128 v[40:43], v203 offset:4096
ds_read_b64_tr_b16 v[48:49], v220 offset:4096
ds_read_b64_tr_b16 v[50:51], v220 offset:4608
ds_read_b128 v[44:47], v204 offset:4096
ds_read_b64_tr_b16 v[52:53], v220 offset:6144
ds_read_b64_tr_b16 v[54:55], v220 offset:6656
s_waitcnt lgkmcnt(6)
s_barrier
v_mfma_f32_32x32x16_bf16 v[64:79], v[32:35], v[24:27], 0
ds_read_b128 v[96:99], v203 offset:8192
ds_read_b64_tr_b16 v[104:105], v220 offset:8192
ds_read_b64_tr_b16 v[106:107], v220 offset:8704
v_mfma_f32_32x32x16_bf16 v[64:79], v[36:39], v[28:31], v[64:79]
ds_read_b128 v[100:103], v204 offset:8192
ds_read_b64_tr_b16 v[108:109], v220 offset:10240
ds_read_b64_tr_b16 v[110:111], v220 offset:10752
s_waitcnt lgkmcnt(6)
v_mfma_f32_32x32x16_bf16 v[64:79], v[48:51], v[40:43], v[64:79]
ds_read_b128 v[24:27], v203 offset:12288
ds_read_b64_tr_b16 v[32:33], v220 offset:12288
ds_read_b64_tr_b16 v[34:35], v220 offset:12800
v_mfma_f32_32x32x16_bf16 v[64:79], v[52:55], v[44:47], v[64:79]
ds_read_b128 v[28:31], v204 offset:12288
ds_read_b64_tr_b16 v[36:37], v220 offset:14336
ds_read_b64_tr_b16 v[38:39], v220 offset:14848
s_waitcnt lgkmcnt(6)
s_barrier
v_mfma_f32_32x32x16_bf16 v[64:79], v[104:107], v[96:99], v[64:79]
ds_read_b128 v[40:43], v203 offset:16384
ds_read_b64_tr_b16 v[48:49], v220 offset:16384
ds_read_b64_tr_b16 v[50:51], v220 offset:16896
v_mfma_f32_32x32x16_bf16 v[64:79], v[108:111], v[100:103], v[64:79]
ds_read_b128 v[44:47], v204 offset:16384
ds_read_b64_tr_b16 v[52:53], v220 offset:18432
ds_read_b64_tr_b16 v[54:55], v220 offset:18944
s_waitcnt lgkmcnt(6)
v_mfma_f32_32x32x16_bf16 v[64:79], v[32:35], v[24:27], v[64:79]
ds_read_b128 v[96:99], v203 offset:20480
ds_read_b64_tr_b16 v[104:105], v220 offset:20480
ds_read_b64_tr_b16 v[106:107], v220 offset:20992
v_mfma_f32_32x32x16_bf16 v[64:79], v[36:39], v[28:31], v[64:79]
ds_read_b128 v[100:103], v204 offset:20480
ds_read_b64_tr_b16 v[108:109], v220 offset:22528
ds_read_b64_tr_b16 v[110:111], v220 offset:23040
s_waitcnt lgkmcnt(6)
s_barrier
v_mfma_f32_32x32x16_bf16 v[64:79], v[48:51], v[40:43], v[64:79]
ds_read_b128 v[24:27], v203 offset:24576
ds_read_b64_tr_b16 v[32:33], v220 offset:24576
ds_read_b64_tr_b16 v[34:35], v220 offset:25088
v_mfma_f32_32x32x16_bf16 v[64:79], v[52:55], v[44:47], v[64:79]
ds_read_b128 v[28:31], v204 offset:24576
ds_read_b64_tr_b16 v[36:37], v220 offset:26624
ds_read_b64_tr_b16 v[38:39], v220 offset:27136
s_waitcnt lgkmcnt(6)
v_mfma_f32_32x32x16_bf16 v[64:79], v[104:107], v[96:99], v[64:79]
ds_read_b128 v[40:43], v203 offset:28672
ds_read_b64_tr_b16 v[48:49], v220 offset:28672
ds_read_b64_tr_b16 v[50:51], v220 offset:29184
v_mfma_f32_32x32x16_bf16 v[64:79], v[108:111], v[100:103], v[64:79]
ds_read_b128 v[44:47], v204 offset:28672
ds_read_b64_tr_b16 v[52:53], v220 offset:30720
ds_read_b64_tr_b16 v[54:55], v220 offset:31232
s_waitcnt lgkmcnt(6)
s_barrier
v_mfma_f32_32x32x16_bf16 v[64:79], v[32:35], v[24:27], v[64:79]
ds_read_b128 v[96:99], v203 offset:32768
ds_read_b64_tr_b16 v[104:105], v220 offset:32768
ds_read_b64_tr_b16 v[106:107], v220 offset:33280
v_mfma_f32_32x32x16_bf16 v[64:79], v[36:39], v[28:31], v[64:79]
ds_read_b128 v[100:103], v204 offset:32768
ds_read_b64_tr_b16 v[108:109], v220 offset:34816
ds_read_b64_tr_b16 v[110:111], v220 offset:35328
s_waitcnt lgkmcnt(6)
v_mfma_f32_32x32x16_bf16 v[64:79], v[48:51], v[40:43], v[64:79]
ds_read_b128 v[24:27], v203 offset:36864
ds_read_b64_tr_b16 v[32:33], v220 offset:36864
ds_read_b64_tr_b16 v[34:35], v220 offset:37376
v_mfma_f32_32x32x16_bf16 v[64:79], v[52:55], v[44:47], v[64:79]
ds_read_b128 v[28:31], v204 offset:36864
ds_read_b64_tr_b16 v[36:37], v220 offset:38912
ds_read_b64_tr_b16 v[38:39], v220 offset:39424
s_waitcnt lgkmcnt(6)
s_barrier
v_mfma_f32_32x32x16_bf16 v[64:79], v[104:107], v[96:99], v[64:79]
ds_read_b128 v[40:43], v203 offset:40960
ds_read_b64_tr_b16 v[48:49], v220 offset:40960
ds_read_b64_tr_b16 v[50:51], v220 offset:41472
v_mfma_f32_32x32x16_bf16 v[64:79], v[108:111], v[100:103], v[64:79]
ds_read_b128 v[44:47], v204 offset:40960
ds_read_b64_tr_b16 v[52:53], v220 offset:43008
ds_read_b64_tr_b16 v[54:55], v220 offset:43520
s_waitcnt lgkmcnt(6)
v_mfma_f32_32x32x16_bf16 v[64:79], v[32:35], v[24:27], v[64:79]
ds_read_b128 v[96:99], v203 offset:45056
ds_read_b64_tr_b16 v[104:105], v220 offset:45056
ds_read_b64_tr_b16 v[106:107], v220 offset:45568
v_mfma_f32_32x32x16_bf16 v[64:79], v[36:39], v[28:31], v[64:79]
ds_read_b128 v[100:103], v204 offset:45056
ds_read_b64_tr_b16 v[108:109], v220 offset:47104
ds_read_b64_tr_b16 v[110:111], v220 offset:47616
s_waitcnt lgkmcnt(6)
s_barrier
v_mfma_f32_32x32x16_bf16 v[64:79], v[48:51], v[40:43], v[64:79]
ds_read_b128 v[24:27], v203 offset:49152
ds_read_b64_tr_b16 v[32:33], v220 offset:49152
ds_read_b64_tr_b16 v[34:35], v220 offset:49664
v_mfma_f32_32x32x16_bf16 v[64:79], v[52:55], v[44:47], v[64:79]
ds_read_b128 v[28:31], v204 offset:49152
ds_read_b64_tr_b16 v[36:37], v220 offset:51200
ds_read_b64_tr_b16 v[38:39], v220 offset:51712
s_waitcnt lgkmcnt(6)
v_mfma_f32_32x32x16_bf16 v[64:79], v[104:107], v[96:99], v[64:79]
ds_read_b128 v[40:43], v203 offset:53248
ds_read_b64_tr_b16 v[48:49], v220 offset:53248
ds_read_b64_tr_b16 v[50:51], v220 offset:53760
v_mfma_f32_32x32x16_bf16 v[64:79], v[108:111], v[100:103], v[64:79]
ds_read_b128 v[44:47], v204 offset:53248
ds_read_b64_tr_b16 v[52:53], v220 offset:55296
ds_read_b64_tr_b16 v[54:55], v220 offset:55808
s_waitcnt lgkmcnt(6)
s_barrier
v_mfma_f32_32x32x16_bf16 v[64:79], v[32:35], v[24:27], v[64:79]
ds_read_b128 v[96:99], v203 offset:57344
ds_read_b64_tr_b16 v[104:105], v220 offset:57344
ds_read_b64_tr_b16 v[106:107], v220 offset:57856
v_mfma_f32_32x32x16_bf16 v[64:79], v[36:39], v[28:31], v[64:79]
ds_read_b128 v[100:103], v204 offset:57344
ds_read_b64_tr_b16 v[108:109], v220 offset:59392
ds_read_b64_tr_b16 v[110:111], v220 offset:59904
s_waitcnt lgkmcnt(6)
v_mfma_f32_32x32x16_bf16 v[64:79], v[48:51], v[40:43], v[64:79]
ds_read_b128 v[24:27], v203 offset:61440
ds_read_b64_tr_b16 v[32:33], v220 offset:61440
ds_read_b64_tr_b16 v[34:35], v220 offset:61952
v_mfma_f32_32x32x16_bf16 v[64:79], v[52:55], v[44:47], v[64:79]
ds_read_b128 v[28:31], v204 offset:61440
ds_read_b64_tr_b16 v[36:37], v220 offset:63488
ds_read_b64_tr_b16 v[38:39], v220 offset:64000
s_waitcnt lgkmcnt(6)
v_mfma_f32_32x32x16_bf16 v[64:79], v[104:107], v[96:99], v[64:79]
v_mfma_f32_32x32x16_bf16 v[64:79], v[108:111], v[100:103], v[64:79]
s_waitcnt lgkmcnt(0)
v_mfma_f32_32x32x16_bf16 v[64:79], v[32:35], v[24:27], v[64:79]
v_mfma_f32_32x32x16_bf16 v[64:79], v[36:39], v[28:31], v[64:79]
s_waitcnt lgkmcnt(0)
s_barrier
s_waitcnt vmcnt(0)
s_nop 8
v_cvt_pk_bf16_f32 v24, v64, v65
v_cvt_pk_bf16_f32 v25, v66, v67
v_cvt_pk_bf16_f32 v26, v68, v69
v_cvt_pk_bf16_f32 v27, v70, v71
v_cvt_pk_bf16_f32 v28, v72, v73
v_cvt_pk_bf16_f32 v29, v74, v75
v_cvt_pk_bf16_f32 v30, v76, v77
v_cvt_pk_bf16_f32 v31, v78, v79
v_lshlrev_b32 v64, 16, v24
v_and_b32 v65, 0xffff0000, v24
v_lshlrev_b32 v66, 16, v25
v_and_b32 v67, 0xffff0000, v25
v_lshlrev_b32 v68, 16, v26
v_and_b32 v69, 0xffff0000, v26
v_lshlrev_b32 v70, 16, v27
v_and_b32 v71, 0xffff0000, v27
v_lshlrev_b32 v72, 16, v28
v_and_b32 v73, 0xffff0000, v28
v_lshlrev_b32 v74, 16, v29
v_and_b32 v75, 0xffff0000, v29
v_lshlrev_b32 v76, 16, v30
v_and_b32 v77, 0xffff0000, v30
v_lshlrev_b32 v78, 16, v31
v_and_b32 v79, 0xffff0000, v31
v_lshlrev_b32 v24, 16, v212
v_and_b32 v25, 0xffff0000, v212
v_lshlrev_b32 v26, 16, v213
v_and_b32 v27, 0xffff0000, v213
v_lshlrev_b32 v28, 16, v214
v_and_b32 v29, 0xffff0000, v214
v_lshlrev_b32 v30, 16, v215
v_and_b32 v31, 0xffff0000, v215
v_lshlrev_b32 v32, 16, v216
v_and_b32 v33, 0xffff0000, v216
v_lshlrev_b32 v34, 16, v217
v_and_b32 v35, 0xffff0000, v217
v_lshlrev_b32 v36, 16, v218
v_and_b32 v37, 0xffff0000, v218
v_lshlrev_b32 v38, 16, v219
v_and_b32 v39, 0xffff0000, v219
v_pk_add_f32 v[64:65], v[64:65], v[24:25]
v_pk_add_f32 v[66:67], v[66:67], v[26:27]
v_pk_add_f32 v[68:69], v[68:69], v[28:29]
v_pk_add_f32 v[70:71], v[70:71], v[30:31]
v_pk_add_f32 v[72:73], v[72:73], v[32:33]
v_pk_add_f32 v[74:75], v[74:75], v[34:35]
v_pk_add_f32 v[76:77], v[76:77], v[36:37]
v_pk_add_f32 v[78:79], v[78:79], v[38:39]
v_cvt_pk_bf16_f32 v192, v64, v65
v_cvt_pk_bf16_f32 v193, v66, v67
v_cvt_pk_bf16_f32 v194, v68, v69
v_cvt_pk_bf16_f32 v195, v70, v71
v_cvt_pk_bf16_f32 v196, v72, v73
v_cvt_pk_bf16_f32 v197, v74, v75
v_cvt_pk_bf16_f32 v198, v76, v77
v_cvt_pk_bf16_f32 v199, v78, v79
v_mov_b32 v40, v192
v_mov_b32 v41, v193
v_mov_b32 v42, v194
v_mov_b32 v43, v195
v_mov_b32 v44, v196
v_mov_b32 v45, v197
v_mov_b32 v46, v198
v_mov_b32 v47, v199
v_permlane16_swap_b32 v40, v44
v_permlane16_swap_b32 v41, v45
v_permlane16_swap_b32 v42, v46
v_permlane16_swap_b32 v43, v47
s_lshl_b32 s68, s77, 1
s_add_u32 s68, s68, s60
s_lshl_b32 s69, s76, 1
s_add_u32 s69, s69, s59
s_lshl_b32 s70, s68, 14
s_lshl_b32 s71, s69, 11
s_add_u32 s70, s70, s71
s_add_u32 s70, s70, s63
s_add_u32 s70, s70, 262144
s_cmp_lg_u32 s7, 0
s_cbranch_scc1 L_sc_84
buffer_store_dwordx4 v[40:43], v206, s[36:39], s70 offen offset:0
buffer_store_dwordx4 v[44:47], v206, s[36:39], s70 offen offset:1024
s_branch L_sj_85
L_sc_84:
buffer_store_dwordx4 v[40:43], v206, s[36:39], s70 offen offset:0 sc1
buffer_store_dwordx4 v[44:47], v206, s[36:39], s70 offen offset:1024 sc1
L_sj_85:
v_lshlrev_b32 v64, 16, v192
v_and_b32 v65, 0xffff0000, v192
v_lshlrev_b32 v66, 16, v193
v_and_b32 v67, 0xffff0000, v193
v_lshlrev_b32 v68, 16, v194
v_and_b32 v69, 0xffff0000, v194
v_lshlrev_b32 v70, 16, v195
v_and_b32 v71, 0xffff0000, v195
v_lshlrev_b32 v72, 16, v196
v_and_b32 v73, 0xffff0000, v196
v_lshlrev_b32 v74, 16, v197
v_and_b32 v75, 0xffff0000, v197
v_lshlrev_b32 v76, 16, v198
v_and_b32 v77, 0xffff0000, v198
v_lshlrev_b32 v78, 16, v199
v_and_b32 v79, 0xffff0000, v199
v_pk_add_f32 v[24:25], v[64:65], v[66:67]
v_pk_mul_f32 v[26:27], v[64:65], v[64:65]
v_pk_fma_f32 v[26:27], v[66:67], v[66:67], v[26:27]
v_pk_add_f32 v[24:25], v[24:25], v[68:69]
v_pk_fma_f32 v[26:27], v[68:69], v[68:69], v[26:27]
v_pk_add_f32 v[24:25], v[24:25], v[70:71]
v_pk_fma_f32 v[26:27], v[70:71], v[70:71], v[26:27]
v_pk_add_f32 v[24:25], v[24:25], v[72:73]
v_pk_fma_f32 v[26:27], v[72:73], v[72:73], v[26:27]
v_pk_add_f32 v[24:25], v[24:25], v[74:75]
v_pk_fma_f32 v[26:27], v[74:75], v[74:75], v[26:27]
v_pk_add_f32 v[24:25], v[24:25], v[76:77]
v_pk_fma_f32 v[26:27], v[76:77], v[76:77], v[26:27]
v_pk_add_f32 v[24:25], v[24:25], v[78:79]
v_pk_fma_f32 v[26:27], v[78:79], v[78:79], v[26:27]
v_add_f32 v24, v24, v25
v_add_f32 v25, v26, v27
v_mov_b32 v26, v24
v_mov_b32 v27, v25
s_nop 0
v_permlane32_swap_b32 v24, v26
v_permlane32_swap_b32 v25, v27
v_pk_add_f32 v[24:25], v[24:25], v[26:27]
s_lshl_b32 s70, s68, 11
s_lshl_b32 s71, s69, 8
s_add_u32 s70, s70, s71
s_add_u32 s70, s70, s63
s_add_u32 s70, s70, 1540096
v_lshlrev_b32 v28, 3, v2
s_mov_b32 exec_hi, 0
s_cmp_lg_u32 s7, 0
s_cbranch_scc1 L_sc_86
buffer_store_dwordx2 v[24:25], v28, s[36:39], s70 offen
s_branch L_sj_87
L_sc_86:
buffer_store_dwordx2 v[24:25], v28, s[36:39], s70 offen sc1
L_sj_87:
s_mov_b64 exec, -1
s_lshl_b32 s70, s3, 9
s_lshl_b32 s71, s69, 6
s_add_u32 s70, s70, s71
s_lshl_b32 s71, s68, 2
s_add_u32 s70, s70, s71
s_add_u32 s70, s70, 28672
v_and_b32 v56, 15, v1
v_lshrrev_b32 v57, 4, v1
v_and_b32 v57, 1, v57
v_cmp_eq_u32 vcc, v56, v57
v_mov_b32 v58, 0x3f803f80
s_nop 0
v_cndmask_b32 v12, 0, v58, vcc
v_cndmask_b32 v13, 0, v58, vcc
v_cndmask_b32 v14, 0, v58, vcc
v_cndmask_b32 v15, 0, v58, vcc
s_waitcnt vmcnt(0)
v_mov_b32 v28, s6
v_mov_b32 v29, s70
s_mov_b64 exec, 1
s_cmp_lg_u32 s7, 0
s_cbranch_scc1 L_sc_88
buffer_store_dword v28, v29, s[40:43], 0 offen
s_branch L_sj_89
L_sc_88:
buffer_store_dword v28, v29, s[40:43], 0 offen sc1
L_sj_89:
s_mov_b64 exec, -1
s_lshl_b32 s68, s5, 1
s_add_u32 s69, s68, 0
s_sub_u32 s70, s69, 2
s_mul_i32 s70, s70, 12288
s_cmp_eq_u32 s69, 0
s_cselect_b32 s70, 65536, s70
s_cmp_eq_u32 s69, 1
s_cselect_b32 s70, 77824, s70
s_cmp_eq_u32 s69, 7
s_cselect_b32 s70, 98304, s70
v_add_u32 v26, s70, v6
s_add_u32 s69, s68, 1
s_sub_u32 s70, s69, 2
s_mul_i32 s70, s70, 12288
s_cmp_eq_u32 s69, 0
s_cselect_b32 s70, 65536, s70
s_cmp_eq_u32 s69, 1
s_cselect_b32 s70, 77824, s70
s_cmp_eq_u32 s69, 7
s_cselect_b32 s70, 98304, s70
v_add_u32 v27, s70, v6
v_lshrrev_b32 v28, 4, v1
v_and_b32 v29, 1, v28
v_lshlrev_b32 v29, 6, v29
v_lshrrev_b32 v28, 1, v28
v_lshlrev_b32 v28, 4, v28
v_add_u32 v29, v29, v28
v_and_b32 v28, 15, v1
v_lshlrev_b32 v28, 5, v28
v_add_u32 v29, v29, v28
s_mul_i32 s68, s5, 384
s_add_u32 s68, s68, 90112
v_add_u32 v29, s68, v29
s_barrier
ds_read_b64_tr_b16 v[64:65], v26 offset:0
ds_read_b64_tr_b16 v[66:67], v26 offset:768
ds_read_b64_tr_b16 v[68:69], v26 offset:64
ds_read_b64_tr_b16 v[70:71], v26 offset:832
ds_read_b64_tr_b16 v[72:73], v26 offset:128
ds_read_b64_tr_b16 v[74:75], v26 offset:896
ds_read_b64_tr_b16 v[76:77], v26 offset:3072
ds_read_b64_tr_b16 v[78:79], v26 offset:3840
ds_read_b64_tr_b16 v[80:81], v26 offset:3136
ds_read_b64_tr_b16 v[82:83], v26 offset:3904
ds_read_b64_tr_b16 v[84:85], v26 offset:3200
ds_read_b64_tr_b16 v[86:87], v26 offset:3968
ds_read_b64_tr_b16 v[88:89], v26 offset:6144
ds_read_b64_tr_b16 v[90:91], v26 offset:6912
ds_read_b64_tr_b16 v[92:93], v26 offset:6208
ds_read_b64_tr_b16 v[94:95], v26 offset:6976
s_waitcnt lgkmcnt(14)
v_mfma_f32_16x16x32_bf16 v[112:115], v[64:67], v[12:15], 0
ds_read_b64_tr_b16 v[64:65], v26 offset:6272
ds_read_b64_tr_b16 v[66:67], v26 offset:7040
s_waitcnt lgkmcnt(14)
v_mfma_f32_16x16x32_bf16 v[116:119], v[68:71], v[12:15], 0
ds_read_b64_tr_b16 v[68:69], v26 offset:9216
ds_read_b64_tr_b16 v[70:71], v26 offset:9984
s_waitcnt lgkmcnt(14)
v_mfma_f32_16x16x32_bf16 v[120:123], v[72:75], v[12:15], 0
ds_read_b64_tr_b16 v[72:73], v26 offset:9280
ds_read_b64_tr_b16 v[74:75], v26 offset:10048
s_waitcnt lgkmcnt(14)
v_mfma_f32_16x16x32_bf16 v[112:115], v[76:79], v[12:15], v[112:115]
ds_read_b64_tr_b16 v[76:77], v26 offset:9344
ds_read_b64_tr_b16 v[78:79], v26 offset:10112
s_waitcnt lgkmcnt(14)
v_mfma_f32_16x16x32_bf16 v[116:119], v[80:83], v[12:15], v[116:119]
ds_read_b64_tr_b16 v[80:81], v27 offset:0
ds_read_b64_tr_b16 v[82:83], v27 offset:768
s_waitcnt lgkmcnt(14)
v_mfma_f32_16x16x32_bf16 v[120:123], v[84:87], v[12:15], v[120:123]
ds_read_b64_tr_b16 v[84:85], v27 offset:64
ds_read_b64_tr_b16 v[86:87], v27 offset:832
s_waitcnt lgkmcnt(14)
v_mfma_f32_16x16x32_bf16 v[112:115], v[88:91], v[12:15], v[112:115]
ds_read_b64_tr_b16 v[88:89], v27 offset:128
ds_read_b64_tr_b16 v[90:91], v27 offset:896
s_waitcnt lgkmcnt(14)
v_mfma_f32_16x16x32_bf16 v[116:119], v[92:95], v[12:15], v[116:119]
ds_read_b64_tr_b16 v[92:93], v27 offset:3072
ds_read_b64_tr_b16 v[94:95], v27 offset:3840
s_waitcnt lgkmcnt(14)
v_mfma_f32_16x16x32_bf16 v[120:123], v[64:67], v[12:15], v[120:123]
ds_read_b64_tr_b16 v[64:65], v27 offset:3136
ds_read_b64_tr_b16 v[66:67], v27 offset:3904
s_waitcnt lgkmcnt(14)
v_mfma_f32_16x16x32_bf16 v[112:115], v[68:71], v[12:15], v[112:115]
ds_read_b64_tr_b16 v[68:69], v27 offset:3200
ds_read_b64_tr_b16 v[70:71], v27 offset:3968
s_waitcnt lgkmcnt(14)
v_mfma_f32_16x16x32_bf16 v[116:119], v[72:75], v[12:15], v[116:119]
ds_read_b64_tr_b16 v[72:73], v27 offset:6144
ds_read_b64_tr_b16 v[74:75], v27 offset:6912
s_waitcnt lgkmcnt(14)
v_mfma_f32_16x16x32_bf16 v[120:123], v[76:79], v[12:15], v[120:123]
ds_read_b64_tr_b16 v[76:77], v27 offset:6208
ds_read_b64_tr_b16 v[78:79], v27 offset:6976
s_waitcnt lgkmcnt(14)
v_mfma_f32_16x16x32_bf16 v[112:115], v[80:83], v[12:15], v[112:115]
ds_read_b64_tr_b16 v[80:81], v27 offset:6272
ds_read_b64_tr_b16 v[82:83], v27 offset:7040
s_waitcnt lgkmcnt(14)
v_mfma_f32_16x16x32_bf16 v[116:119], v[84:87], v[12:15], v[116:119]
ds_read_b64_tr_b16 v[84:85], v27 offset:9216
ds_read_b64_tr_b16 v[86:87], v27 offset:9984
s_waitcnt lgkmcnt(14)
v_mfma_f32_16x16x32_bf16 v[120:123], v[88:91], v[12:15], v[120:123]
ds_read_b64_tr_b16 v[88:89], v27 offset:9280
ds_read_b64_tr_b16 v[90:91], v27 offset:10048
s_waitcnt lgkmcnt(14)
v_mfma_f32_16x16x32_bf16 v[112:115], v[92:95], v[12:15], v[112:115]
ds_read_b64_tr_b16 v[92:93], v27 offset:9344
ds_read_b64_tr_b16 v[94:95], v27 offset:10112
s_waitcnt lgkmcnt(14)
v_mfma_f32_16x16x32_bf16 v[116:119], v[64:67], v[12:15], v[116:119]
s_waitcnt lgkmcnt(12)
v_mfma_f32_16x16x32_bf16 v[120:123], v[68:71], v[12:15], v[120:123]
s_waitcnt lgkmcnt(10)
v_mfma_f32_16x16x32_bf16 v[112:115], v[72:75], v[12:15], v[112:115]
s_waitcnt lgkmcnt(8)
v_mfma_f32_16x16x32_bf16 v[116:119], v[76:79], v[12:15], v[116:119]
s_waitcnt lgkmcnt(6)
v_mfma_f32_16x16x32_bf16 v[120:123], v[80:83], v[12:15], v[120:123]
s_waitcnt lgkmcnt(4)
v_mfma_f32_16x16x32_bf16 v[112:115], v[84:87], v[12:15], v[112:115]
s_waitcnt lgkmcnt(2)
v_mfma_f32_16x16x32_bf16 v[116:119], v[88:91], v[12:15], v[116:119]
s_waitcnt lgkmcnt(0)
v_mfma_f32_16x16x32_bf16 v[120:123], v[92:95], v[12:15], v[120:123]
s_mov_b32 exec_lo, 0x00030003
s_mov_b32 exec_hi, 0x00030003
s_nop 1
ds_write_b128 v29, v[112:115] offset:0
s_nop 0
ds_write_b128 v29, v[116:119] offset:128
s_nop 0
ds_write_b128 v29, v[120:123] offset:256
s_mov_b64 exec, -1
s_waitcnt lgkmcnt(0)
s_barrier
ds_read_b128 v[24:27], v4 offset:0
ds_read_b128 v[28:31], v5 offset:0
ds_read_b128 v[32:35], v4 offset:8192
ds_read_b128 v[36:39], v5 offset:8192
ds_read_b64_tr_b16 v[40:41], v7 offset:0
ds_read_b64_tr_b16 v[42:43], v7 offset:768
ds_read_b64_tr_b16 v[44:45], v7 offset:64
ds_read_b64_tr_b16 v[46:47], v7 offset:832
ds_read_b64_tr_b16 v[48:49], v7 offset:128
ds_read_b64_tr_b16 v[50:51], v7 offset:896
ds_read_b64_tr_b16 v[52:53], v7 offset:3072
ds_read_b64_tr_b16 v[54:55], v7 offset:3840
ds_read_b64_tr_b16 v[56:57], v7 offset:3136
ds_read_b64_tr_b16 v[58:59], v7 offset:3904
ds_read_b64_tr_b16 v[60:61], v7 offset:3200
ds_read_b64_tr_b16 v[62:63], v7 offset:3968
s_lshl_b32 s68, s56, 7
s_lshl_b32 s69, s5, 5
s_add_u32 s68, s68, s69
v_add_u32 v208, s68, v2
v_lshlrev_b32 v208, 3, v208
v_lshlrev_b32 v209, 11, v3
v_add_u32 v208, v208, v209
s_add_u32 s68, s63, 1540096
buffer_load_dwordx2 v[216:217], v208, s[36:39], s68 offen
s_add_u32 s68, s68, 4096
buffer_load_dwordx2 v[218:219], v208, s[36:39], s68 offen
s_add_u32 s68, s68, 4096
buffer_load_dwordx2 v[220:221], v208, s[36:39], s68 offen
s_add_u32 s68, s68, 4096
buffer_load_dwordx2 v[222:223], v208, s[36:39], s68 offen
s_add_u32 s68, s68, 4096
buffer_load_dwordx2 v[224:225], v208, s[36:39], s68 offen
s_add_u32 s68, s68, 4096
buffer_load_dwordx2 v[226:227], v208, s[36:39], s68 offen
s_add_u32 s68, s68, 4096
buffer_load_dwordx2 v[228:229], v208, s[36:39], s68 offen
s_add_u32 s68, s68, 4096
buffer_load_dwordx2 v[230:231], v208, s[36:39], s68 offen
s_cmp_ge_u32 s78, 11
s_cselect_b64 vcc, -1, 0
s_waitcnt lgkmcnt(12)
s_waitcnt lgkmcnt(6)
v_mfma_f32_32x32x16_bf16 v[64:79], v[40:43], v[24:27], 0
ds_read_b64_tr_b16 v[112:113], v7 offset:6144
ds_read_b64_tr_b16 v[114:115], v7 offset:6912
v_mfma_f32_32x32x16_bf16 v[80:95], v[44:47], v[24:27], 0
ds_read_b64_tr_b16 v[116:117], v7 offset:6208
ds_read_b64_tr_b16 v[118:119], v7 offset:6976
s_cbranch_vccnz L_lt_90
v_mfma_f32_32x32x16_bf16 v[96:111], v[48:51], v[24:27], 0
L_lt_90:
ds_read_b64_tr_b16 v[120:121], v7 offset:6272
ds_read_b64_tr_b16 v[122:123], v7 offset:7040
s_waitcnt lgkmcnt(6)
v_mfma_f32_32x32x16_bf16 v[64:79], v[52:55], v[28:31], v[64:79]
ds_read_b64_tr_b16 v[40:41], v7 offset:9216
ds_read_b64_tr_b16 v[42:43], v7 offset:9984
v_mfma_f32_32x32x16_bf16 v[80:95], v[56:59], v[28:31], v[80:95]
ds_read_b64_tr_b16 v[44:45], v7 offset:9280
ds_read_b64_tr_b16 v[46:47], v7 offset:10048
s_cbranch_vccnz L_lt_91
v_mfma_f32_32x32x16_bf16 v[96:111], v[60:63], v[28:31], v[96:111]
L_lt_91:
ds_read_b64_tr_b16 v[48:49], v7 offset:9344
ds_read_b64_tr_b16 v[50:51], v7 offset:10112
s_waitcnt lgkmcnt(6)
s_barrier
v_mfma_f32_32x32x16_bf16 v[64:79], v[112:115], v[32:35], v[64:79]
ds_read_b128 v[128:131], v4 offset:16384
ds_read_b128 v[132:135], v5 offset:16384
ds_read_b64_tr_b16 v[52:53], v7 offset:12288
v_mfma_f32_32x32x16_bf16 v[80:95], v[116:119], v[32:35], v[80:95]
ds_read_b64_tr_b16 v[54:55], v7 offset:13056
ds_read_b64_tr_b16 v[56:57], v7 offset:12352
ds_read_b64_tr_b16 v[58:59], v7 offset:13120
s_cbranch_vccnz L_lt_92
v_mfma_f32_32x32x16_bf16 v[96:111], v[120:123], v[32:35], v[96:111]
L_lt_92:
ds_read_b64_tr_b16 v[60:61], v7 offset:12416
ds_read_b64_tr_b16 v[62:63], v7 offset:13184
s_waitcnt lgkmcnt(8)
v_mfma_f32_32x32x16_bf16 v[64:79], v[40:43], v[36:39], v[64:79]
ds_read_b128 v[136:139], v4 offset:24576
ds_read_b128 v[140:143], v5 offset:24576
ds_read_b64_tr_b16 v[112:113], v7 offset:15360
v_mfma_f32_32x32x16_bf16 v[80:95], v[44:47], v[36:39], v[80:95]
ds_read_b64_tr_b16 v[114:115], v7 offset:16128
ds_read_b64_tr_b16 v[116:117], v7 offset:15424
ds_read_b64_tr_b16 v[118:119], v7 offset:16192
s_cbranch_vccnz L_lt_93
v_mfma_f32_32x32x16_bf16 v[96:111], v[48:51], v[36:39], v[96:111]
L_lt_93:
ds_read_b64_tr_b16 v[120:121], v7 offset:15488
ds_read_b64_tr_b16 v[122:123], v7 offset:16256
s_waitcnt lgkmcnt(6)
v_mfma_f32_32x32x16_bf16 v[64:79], v[52:55], v[128:131], v[64:79]
ds_read_b64_tr_b16 v[40:41], v7 offset:18432
ds_read_b64_tr_b16 v[42:43], v7 offset:19200
v_mfma_f32_32x32x16_bf16 v[80:95], v[56:59], v[128:131], v[80:95]
ds_read_b64_tr_b16 v[44:45], v7 offset:18496
ds_read_b64_tr_b16 v[46:47], v7 offset:19264
s_cbranch_vccnz L_lt_94
v_mfma_f32_32x32x16_bf16 v[96:111], v[60:63], v[128:131], v[96:111]
L_lt_94:
ds_read_b64_tr_b16 v[48:49], v7 offset:18560
ds_read_b64_tr_b16 v[50:51], v7 offset:19328
s_waitcnt lgkmcnt(6)
v_mfma_f32_32x32x16_bf16 v[64:79], v[112:115], v[132:135], v[64:79]
ds_read_b64_tr_b16 v[52:53], v7 offset:21504
ds_read_b64_tr_b16 v[54:55], v7 offset:22272
v_mfma_f32_32x32x16_bf16 v[80:95], v[116:119], v[132:135], v[80:95]
ds_read_b64_tr_b16 v[56:57], v7 offset:21568
ds_read_b64_tr_b16 v[58:59], v7 offset:22336
s_cbranch_vccnz L_lt_95
v_mfma_f32_32x32x16_bf16 v[96:111], v[120:123], v[132:135], v[96:111]
L_lt_95:
ds_read_b64_tr_b16 v[60:61], v7 offset:21632
ds_read_b64_tr_b16 v[62:63], v7 offset:22400
s_waitcnt lgkmcnt(6)
s_barrier
v_mfma_f32_32x32x16_bf16 v[64:79], v[40:43], v[136:139], v[64:79]
ds_read_b128 v[24:27], v4 offset:32768
ds_read_b128 v[28:31], v5 offset:32768
ds_read_b64_tr_b16 v[112:113], v6 offset:0
v_mfma_f32_32x32x16_bf16 v[80:95], v[44:47], v[136:139], v[80:95]
ds_read_b64_tr_b16 v[114:115], v6 offset:768
ds_read_b64_tr_b16 v[116:117], v6 offset:64
ds_read_b64_tr_b16 v[118:119], v6 offset:832
s_cbranch_vccnz L_lt_96
v_mfma_f32_32x32x16_bf16 v[96:111], v[48:51], v[136:139], v[96:111]
L_lt_96:
ds_read_b64_tr_b16 v[120:121], v6 offset:128
ds_read_b64_tr_b16 v[122:123], v6 offset:896
s_waitcnt lgkmcnt(8)
v_mfma_f32_32x32x16_bf16 v[64:79], v[52:55], v[140:143], v[64:79]
ds_read_b128 v[32:35], v4 offset:40960
ds_read_b128 v[36:39], v5 offset:40960
ds_read_b64_tr_b16 v[40:41], v6 offset:3072
v_mfma_f32_32x32x16_bf16 v[80:95], v[56:59], v[140:143], v[80:95]
ds_read_b64_tr_b16 v[42:43], v6 offset:3840
ds_read_b64_tr_b16 v[44:45], v6 offset:3136
ds_read_b64_tr_b16 v[46:47], v6 offset:3904
s_cbranch_vccnz L_lt_97
v_mfma_f32_32x32x16_bf16 v[96:111], v[60:63], v[140:143], v[96:111]
L_lt_97:
ds_read_b64_tr_b16 v[48:49], v6 offset:3200
ds_read_b64_tr_b16 v[50:51], v6 offset:3968
s_waitcnt lgkmcnt(6)
v_mfma_f32_32x32x16_bf16 v[64:79], v[112:115], v[24:27], v[64:79]
ds_read_b64_tr_b16 v[52:53], v6 offset:6144
ds_read_b64_tr_b16 v[54:55], v6 offset:6912
v_mfma_f32_32x32x16_bf16 v[80:95], v[116:119], v[24:27], v[80:95]
ds_read_b64_tr_b16 v[56:57], v6 offset:6208
ds_read_b64_tr_b16 v[58:59], v6 offset:6976
s_cbranch_vccnz L_lt_98
v_mfma_f32_32x32x16_bf16 v[96:111], v[120:123], v[24:27], v[96:111]
L_lt_98:
ds_read_b64_tr_b16 v[60:61], v6 offset:6272
ds_read_b64_tr_b16 v[62:63], v6 offset:7040
s_waitcnt lgkmcnt(6)
v_mfma_f32_32x32x16_bf16 v[64:79], v[40:43], v[28:31], v[64:79]
ds_read_b64_tr_b16 v[112:113], v6 offset:9216
ds_read_b64_tr_b16 v[114:115], v6 offset:9984
v_mfma_f32_32x32x16_bf16 v[80:95], v[44:47], v[28:31], v[80:95]
ds_read_b64_tr_b16 v[116:117], v6 offset:9280
ds_read_b64_tr_b16 v[118:119], v6 offset:10048
s_cbranch_vccnz L_lt_99
v_mfma_f32_32x32x16_bf16 v[96:111], v[48:51], v[28:31], v[96:111]
L_lt_99:
ds_read_b64_tr_b16 v[120:121], v6 offset:9344
ds_read_b64_tr_b16 v[122:123], v6 offset:10112
s_waitcnt lgkmcnt(6)
s_barrier
v_mfma_f32_32x32x16_bf16 v[64:79], v[52:55], v[32:35], v[64:79]
ds_read_b128 v[128:131], v4 offset:0
ds_read_b128 v[132:135], v5 offset:0
ds_read_b64_tr_b16 v[40:41], v6 offset:12288
v_mfma_f32_32x32x16_bf16 v[80:95], v[56:59], v[32:35], v[80:95]
ds_read_b64_tr_b16 v[42:43], v6 offset:13056
ds_read_b64_tr_b16 v[44:45], v6 offset:12352
ds_read_b64_tr_b16 v[46:47], v6 offset:13120
s_cbranch_vccnz L_lt_100
v_mfma_f32_32x32x16_bf16 v[96:111], v[60:63], v[32:35], v[96:111]
L_lt_100:
ds_read_b64_tr_b16 v[48:49], v6 offset:12416
ds_read_b64_tr_b16 v[50:51], v6 offset:13184
s_waitcnt lgkmcnt(8)
v_mfma_f32_32x32x16_bf16 v[64:79], v[112:115], v[36:39], v[64:79]
ds_read_b128 v[136:139], v4 offset:8192
ds_read_b128 v[140:143], v5 offset:8192
ds_read_b64_tr_b16 v[52:53], v6 offset:15360
v_mfma_f32_32x32x16_bf16 v[80:95], v[116:119], v[36:39], v[80:95]
ds_read_b64_tr_b16 v[54:55], v6 offset:16128
ds_read_b64_tr_b16 v[56:57], v6 offset:15424
ds_read_b64_tr_b16 v[58:59], v6 offset:16192
s_cbranch_vccnz L_lt_101
v_mfma_f32_32x32x16_bf16 v[96:111], v[120:123], v[36:39], v[96:111]
L_lt_101:
ds_read_b64_tr_b16 v[60:61], v6 offset:15488
ds_read_b64_tr_b16 v[62:63], v6 offset:16256
s_waitcnt lgkmcnt(6)
s_cmp_eq_u32 s58, 0
s_cbranch_scc1 L_npp_102
s_lshl_b32 s68, s57, 2
s_lshl_b32 s69, s60, 1
s_add_u32 s68, s68, s69
s_lshl_b32 s69, s68, 5
s_add_u32 s69, s69, 20480
v_and_b32 v211, 15, v1
v_lshlrev_b32 v211, 2, v211
v_add_u32 v211, s69, v211
buffer_load_dword v210, v211, s[40:43], 0 offen sc1
L_npp_102:
v_mfma_f32_32x32x16_bf16 v[64:79], v[40:43], v[128:131], v[64:79]
ds_read_b64_tr_b16 v[112:113], v6 offset:18432
ds_read_b64_tr_b16 v[114:115], v6 offset:19200
v_mfma_f32_32x32x16_bf16 v[80:95], v[44:47], v[128:131], v[80:95]
ds_read_b64_tr_b16 v[116:117], v6 offset:18496
ds_read_b64_tr_b16 v[118:119], v6 offset:19264
s_cbranch_vccnz L_lt_103
v_mfma_f32_32x32x16_bf16 v[96:111], v[48:51], v[128:131], v[96:111]
L_lt_103:
ds_read_b64_tr_b16 v[120:121], v6 offset:18560
ds_read_b64_tr_b16 v[122:123], v6 offset:19328
s_waitcnt lgkmcnt(6)
v_mfma_f32_32x32x16_bf16 v[64:79], v[52:55], v[132:135], v[64:79]
ds_read_b64_tr_b16 v[40:41], v6 offset:21504
ds_read_b64_tr_b16 v[42:43], v6 offset:22272
v_mfma_f32_32x32x16_bf16 v[80:95], v[56:59], v[132:135], v[80:95]
ds_read_b64_tr_b16 v[44:45], v6 offset:21568
ds_read_b64_tr_b16 v[46:47], v6 offset:22336
s_cbranch_vccnz L_lt_104
v_mfma_f32_32x32x16_bf16 v[96:111], v[60:63], v[132:135], v[96:111]
L_lt_104:
ds_read_b64_tr_b16 v[48:49], v6 offset:21632
ds_read_b64_tr_b16 v[50:51], v6 offset:22400
s_waitcnt lgkmcnt(6)
s_barrier
v_mfma_f32_32x32x16_bf16 v[64:79], v[112:115], v[136:139], v[64:79]
ds_read_b128 v[24:27], v4 offset:16384
ds_read_b128 v[28:31], v5 offset:16384
ds_read_b64_tr_b16 v[52:53], v6 offset:24576
v_mfma_f32_32x32x16_bf16 v[80:95], v[116:119], v[136:139], v[80:95]
ds_read_b64_tr_b16 v[54:55], v6 offset:25344
ds_read_b64_tr_b16 v[56:57], v6 offset:24640
ds_read_b64_tr_b16 v[58:59], v6 offset:25408
s_cbranch_vccnz L_lt_105
v_mfma_f32_32x32x16_bf16 v[96:111], v[120:123], v[136:139], v[96:111]
L_lt_105:
ds_read_b64_tr_b16 v[60:61], v6 offset:24704
ds_read_b64_tr_b16 v[62:63], v6 offset:25472
s_waitcnt lgkmcnt(8)
v_mfma_f32_32x32x16_bf16 v[64:79], v[40:43], v[140:143], v[64:79]
ds_read_b128 v[32:35], v4 offset:24576
ds_read_b128 v[36:39], v5 offset:24576
ds_read_b64_tr_b16 v[112:113], v6 offset:27648
v_mfma_f32_32x32x16_bf16 v[80:95], v[44:47], v[140:143], v[80:95]
ds_read_b64_tr_b16 v[114:115], v6 offset:28416
ds_read_b64_tr_b16 v[116:117], v6 offset:27712
ds_read_b64_tr_b16 v[118:119], v6 offset:28480
s_cbranch_vccnz L_lt_106
v_mfma_f32_32x32x16_bf16 v[96:111], v[48:51], v[140:143], v[96:111]
L_lt_106:
ds_read_b64_tr_b16 v[120:121], v6 offset:27776
ds_read_b64_tr_b16 v[122:123], v6 offset:28544
s_waitcnt lgkmcnt(6)
v_mfma_f32_32x32x16_bf16 v[64:79], v[52:55], v[24:27], v[64:79]
ds_read_b64_tr_b16 v[40:41], v6 offset:30720
ds_read_b64_tr_b16 v[42:43], v6 offset:31488
v_mfma_f32_32x32x16_bf16 v[80:95], v[56:59], v[24:27], v[80:95]
ds_read_b64_tr_b16 v[44:45], v6 offset:30784
ds_read_b64_tr_b16 v[46:47], v6 offset:31552
s_cbranch_vccnz L_lt_107
v_mfma_f32_32x32x16_bf16 v[96:111], v[60:63], v[24:27], v[96:111]
L_lt_107:
ds_read_b64_tr_b16 v[48:49], v6 offset:30848
ds_read_b64_tr_b16 v[50:51], v6 offset:31616
s_waitcnt lgkmcnt(6)
v_mfma_f32_32x32x16_bf16 v[64:79], v[112:115], v[28:31], v[64:79]
ds_read_b64_tr_b16 v[52:53], v6 offset:33792
ds_read_b64_tr_b16 v[54:55], v6 offset:34560
v_mfma_f32_32x32x16_bf16 v[80:95], v[116:119], v[28:31], v[80:95]
ds_read_b64_tr_b16 v[56:57], v6 offset:33856
ds_read_b64_tr_b16 v[58:59], v6 offset:34624
s_cbranch_vccnz L_lt_108
v_mfma_f32_32x32x16_bf16 v[96:111], v[120:123], v[28:31], v[96:111]
L_lt_108:
ds_read_b64_tr_b16 v[60:61], v6 offset:33920
ds_read_b64_tr_b16 v[62:63], v6 offset:34688
s_waitcnt lgkmcnt(6)
s_barrier
v_mfma_f32_32x32x16_bf16 v[64:79], v[40:43], v[32:35], v[64:79]
ds_read_b128 v[128:131], v4 offset:32768
ds_read_b128 v[132:135], v5 offset:32768
ds_read_b64_tr_b16 v[112:113], v6 offset:36864
v_mfma_f32_32x32x16_bf16 v[80:95], v[44:47], v[32:35], v[80:95]
ds_read_b64_tr_b16 v[114:115], v6 offset:37632
ds_read_b64_tr_b16 v[116:117], v6 offset:36928
ds_read_b64_tr_b16 v[118:119], v6 offset:37696
s_cbranch_vccnz L_lt_109
v_mfma_f32_32x32x16_bf16 v[96:111], v[48:51], v[32:35], v[96:111]
L_lt_109:
ds_read_b64_tr_b16 v[120:121], v6 offset:36992
ds_read_b64_tr_b16 v[122:123], v6 offset:37760
s_waitcnt lgkmcnt(8)
v_mfma_f32_32x32x16_bf16 v[64:79], v[52:55], v[36:39], v[64:79]
ds_read_b128 v[136:139], v4 offset:40960
ds_read_b128 v[140:143], v5 offset:40960
ds_read_b64_tr_b16 v[40:41], v6 offset:39936
v_mfma_f32_32x32x16_bf16 v[80:95], v[56:59], v[36:39], v[80:95]
ds_read_b64_tr_b16 v[42:43], v6 offset:40704
ds_read_b64_tr_b16 v[44:45], v6 offset:40000
ds_read_b64_tr_b16 v[46:47], v6 offset:40768
s_cbranch_vccnz L_lt_110
v_mfma_f32_32x32x16_bf16 v[96:111], v[60:63], v[36:39], v[96:111]
L_lt_110:
ds_read_b64_tr_b16 v[48:49], v6 offset:40064
ds_read_b64_tr_b16 v[50:51], v6 offset:40832
s_waitcnt lgkmcnt(6)
s_waitcnt vmcnt(0)
v_pk_add_f32 v[216:217], v[216:217], v[218:219]
v_pk_add_f32 v[220:221], v[220:221], v[222:223]
v_pk_add_f32 v[224:225], v[224:225], v[226:227]
v_pk_add_f32 v[228:229], v[228:229], v[230:231]
v_pk_add_f32 v[216:217], v[216:217], v[220:221]
v_pk_add_f32 v[224:225], v[224:225], v[228:229]
v_pk_add_f32 v[216:217], v[216:217], v[224:225]
v_mov_b32 v218, v216
v_mov_b32 v219, v217
s_nop 0
v_permlane32_swap_b32 v216, v218
v_permlane32_swap_b32 v217, v219
v_pk_add_f32 v[216:217], v[216:217], v[218:219]
v_mul_f32 v216, 989855744, v216
v_mul_f32 v217, 989855744, v217
v_fma_f32 v217, -v216, v216, v217
v_max_f32 v217, 0, v217
v_cvt_pk_bf16_f32 v220, v217, v217
v_lshlrev_b32 v217, 16, v220
v_cvt_pk_bf16_f32 v221, v216, v216
v_lshlrev_b32 v216, 16, v221
v_add_f32 v217, 925353388, v217
v_cvt_pk_bf16_f32 v220, v217, v217
v_lshlrev_b32 v217, 16, v220
v_sqrt_f32 v217, v217
s_nop 0
v_cvt_pk_bf16_f32 v220, v217, v217
v_lshlrev_b32 v217, 16, v220
v_rcp_f32 v208, v217
s_nop 0
v_mul_f32 v209, v216, v208
v_sub_f32 v209, 0, v209
s_cmp_eq_u32 s58, 0
s_cbranch_scc1 L_npl_111
s_waitcnt vmcnt(0)
v_cmp_ne_u32 vcc, s6, v210
s_nop 0
s_cbranch_vccz L_kd_113
s_mov_b32 s79, 0
L_kp_112:
s_sleep 1
buffer_load_dword v210, v211, s[40:43], 0 offen sc1
s_add_u32 s79, s79, 1
s_cmp_gt_u32 s79, 200000
s_waitcnt vmcnt(0)
s_cbranch_scc1 L_kd_113
v_cmp_ne_u32 vcc, s6, v210
s_nop 0
s_cbranch_vccnz L_kp_112
L_kd_113:
s_lshl_b32 s68, s57, 2
s_lshl_b32 s69, s60, 1
s_add_u32 s68, s68, s69
v_lshrrev_b32 v210, 2, v2
v_and_b32 v210, 1, v210
v_lshrrev_b32 v211, 3, v2
v_lshlrev_b32 v211, 2, v211
v_and_b32 v212, 3, v2
v_add_u32 v211, v211, v212
v_lshlrev_b32 v211, 6, v211
v_lshlrev_b32 v212, 10, v3
v_add_u32 v211, v211, v212
v_cmp_eq_u32 vcc, v210, v3
v_mov_b32 v212, 0x7fff0000
s_nop 0
v_cndmask_b32 v211, v212, v211, vcc
s_lshl_b32 s69, s68, 10
s_add_u32 s69, s69, 2162688
buffer_load_dwordx4 v[232:235], v211, s[40:43], s69 offen offset:0 sc1
buffer_load_dwordx4 v[236:239], v211, s[40:43], s69 offen offset:16 sc1
buffer_load_dwordx4 v[240:243], v211, s[40:43], s69 offen offset:32 sc1
buffer_load_dwordx4 v[244:247], v211, s[40:43], s69 offen offset:48 sc1
v_lshlrev_b32 v212, 7, v3
s_lshl_b32 s69, s68, 7
s_add_u32 s69, s69, 2195456
buffer_load_dwordx4 v[144:147], v212, s[40:43], s69 offen offset:0 sc1
buffer_load_dwordx4 v[148:151], v212, s[40:43], s69 offen offset:16 sc1
buffer_load_dwordx4 v[152:155], v212, s[40:43], s69 offen offset:32 sc1
buffer_load_dwordx4 v[156:159], v212, s[40:43], s69 offen offset:48 sc1
L_npl_111:
s_cmp_ge_u32 s78, 11
s_cselect_b64 vcc, -1, 0
v_mfma_f32_32x32x16_bf16 v[64:79], v[112:115], v[128:131], v[64:79]
ds_read_b64_tr_b16 v[52:53], v6 offset:43008
ds_read_b64_tr_b16 v[54:55], v6 offset:43776
v_mfma_f32_32x32x16_bf16 v[80:95], v[116:119], v[128:131], v[80:95]
ds_read_b64_tr_b16 v[56:57], v6 offset:43072
ds_read_b64_tr_b16 v[58:59], v6 offset:43840
s_cbranch_vccnz L_lt_114
v_mfma_f32_32x32x16_bf16 v[96:111], v[120:123], v[128:131], v[96:111]
L_lt_114:
ds_read_b64_tr_b16 v[60:61], v6 offset:43136
ds_read_b64_tr_b16 v[62:63], v6 offset:43904
s_waitcnt lgkmcnt(6)
s_lshl_b32 s68, s56, 2
s_add_u32 s68, s68, s5
s_lshl_b32 s70, s87, 14
s_lshl_b32 s71, s68, 11
s_add_u32 s70, s70, s71
s_add_u32 s70, s70, s63
s_add_u32 s70, s70, 786432
v_lshrrev_b32 v252, 4, v1
v_mul_u32_u24 v252, 16384, v252
v_and_b32 v251, 15, v1
v_lshlrev_b32 v251, 7, v251
v_add_u32 v252, v252, v251
s_mov_b32 exec_lo, 0xffffffff
s_mov_b32 exec_hi, 0xffff
buffer_load_dword v253, v252, s[36:39], s70 offen sc1
s_mov_b64 exec, -1
s_cmp_eq_u32 s58, 0
s_cbranch_scc1 L_npt_115
s_lshl_b32 s68, s56, 1
s_add_u32 s68, s68, s59
s_lshl_b32 s69, s57, 1
s_add_u32 s69, s69, s60
s_lshl_b32 s70, s69, 14
s_lshl_b32 s71, s68, 12
s_add_u32 s70, s70, s71
s_add_u32 s70, s70, s63
s_add_u32 s70, s70, 524288
v_lshlrev_b32 v252, 7, v1
s_mov_b32 exec_lo, 0xffffffff
s_mov_b32 exec_hi, 0x0
buffer_load_dword v253, v252, s[36:39], s70 offen sc1
s_mov_b64 exec, -1
L_npt_115:
v_mfma_f32_32x32x16_bf16 v[64:79], v[40:43], v[132:135], v[64:79]
ds_read_b64_tr_b16 v[112:113], v6 offset:46080
ds_read_b64_tr_b16 v[114:115], v6 offset:46848
v_mfma_f32_32x32x16_bf16 v[80:95], v[44:47], v[132:135], v[80:95]
ds_read_b64_tr_b16 v[116:117], v6 offset:46144
ds_read_b64_tr_b16 v[118:119], v6 offset:46912
s_cbranch_vccnz L_lt_116
v_mfma_f32_32x32x16_bf16 v[96:111], v[48:51], v[132:135], v[96:111]
L_lt_116:
ds_read_b64_tr_b16 v[120:121], v6 offset:46208
ds_read_b64_tr_b16 v[122:123], v6 offset:46976
s_waitcnt lgkmcnt(6)
s_barrier
v_mfma_f32_32x32x16_bf16 v[64:79], v[52:55], v[136:139], v[64:79]
ds_read_b128 v[24:27], v4 offset:0
ds_read_b128 v[28:31], v5 offset:0
ds_read_b64_tr_b16 v[40:41], v6 offset:49152
v_mfma_f32_32x32x16_bf16 v[80:95], v[56:59], v[136:139], v[80:95]
ds_read_b64_tr_b16 v[42:43], v6 offset:49920
ds_read_b64_tr_b16 v[44:45], v6 offset:49216
ds_read_b64_tr_b16 v[46:47], v6 offset:49984
s_cbranch_vccnz L_lt_117
v_mfma_f32_32x32x16_bf16 v[96:111], v[60:63], v[136:139], v[96:111]
L_lt_117:
ds_read_b64_tr_b16 v[48:49], v6 offset:49280
ds_read_b64_tr_b16 v[50:51], v6 offset:50048
s_waitcnt lgkmcnt(8)
v_mfma_f32_32x32x16_bf16 v[64:79], v[112:115], v[140:143], v[64:79]
ds_read_b128 v[32:35], v4 offset:8192
ds_read_b128 v[36:39], v5 offset:8192
ds_read_b64_tr_b16 v[52:53], v6 offset:52224
v_mfma_f32_32x32x16_bf16 v[80:95], v[116:119], v[140:143], v[80:95]
ds_read_b64_tr_b16 v[54:55], v6 offset:52992
ds_read_b64_tr_b16 v[56:57], v6 offset:52288
ds_read_b64_tr_b16 v[58:59], v6 offset:53056
s_cbranch_vccnz L_lt_118
v_mfma_f32_32x32x16_bf16 v[96:111], v[120:123], v[140:143], v[96:111]
L_lt_118:
ds_read_b64_tr_b16 v[60:61], v6 offset:52352
ds_read_b64_tr_b16 v[62:63], v6 offset:53120
s_waitcnt lgkmcnt(6)
v_mfma_f32_32x32x16_bf16 v[64:79], v[40:43], v[24:27], v[64:79]
ds_read_b64_tr_b16 v[112:113], v6 offset:55296
ds_read_b64_tr_b16 v[114:115], v6 offset:56064
v_mfma_f32_32x32x16_bf16 v[80:95], v[44:47], v[24:27], v[80:95]
ds_read_b64_tr_b16 v[116:117], v6 offset:55360
ds_read_b64_tr_b16 v[118:119], v6 offset:56128
s_cbranch_vccnz L_lt_119
v_mfma_f32_32x32x16_bf16 v[96:111], v[48:51], v[24:27], v[96:111]
L_lt_119:
ds_read_b64_tr_b16 v[120:121], v6 offset:55424
ds_read_b64_tr_b16 v[122:123], v6 offset:56192
s_waitcnt lgkmcnt(6)
v_mfma_f32_32x32x16_bf16 v[64:79], v[52:55], v[28:31], v[64:79]
ds_read_b64_tr_b16 v[40:41], v6 offset:58368
ds_read_b64_tr_b16 v[42:43], v6 offset:59136
v_mfma_f32_32x32x16_bf16 v[80:95], v[56:59], v[28:31], v[80:95]
ds_read_b64_tr_b16 v[44:45], v6 offset:58432
ds_read_b64_tr_b16 v[46:47], v6 offset:59200
s_cbranch_vccnz L_lt_120
v_mfma_f32_32x32x16_bf16 v[96:111], v[60:63], v[28:31], v[96:111]
L_lt_120:
ds_read_b64_tr_b16 v[48:49], v6 offset:58496
ds_read_b64_tr_b16 v[50:51], v6 offset:59264
s_waitcnt lgkmcnt(6)
s_barrier
v_mfma_f32_32x32x16_bf16 v[64:79], v[112:115], v[32:35], v[64:79]
ds_read_b128 v[128:131], v4 offset:16384
ds_read_b128 v[132:135], v5 offset:16384
ds_read_b64_tr_b16 v[52:53], v7 offset:32768
v_mfma_f32_32x32x16_bf16 v[80:95], v[116:119], v[32:35], v[80:95]
ds_read_b64_tr_b16 v[54:55], v7 offset:33536
ds_read_b64_tr_b16 v[56:57], v7 offset:32832
ds_read_b64_tr_b16 v[58:59], v7 offset:33600
s_cbranch_vccnz L_lt_121
v_mfma_f32_32x32x16_bf16 v[96:111], v[120:123], v[32:35], v[96:111]
L_lt_121:
ds_read_b64_tr_b16 v[60:61], v7 offset:32896
ds_read_b64_tr_b16 v[62:63], v7 offset:33664
s_waitcnt lgkmcnt(8)
v_mfma_f32_32x32x16_bf16 v[64:79], v[40:43], v[36:39], v[64:79]
ds_read_b128 v[136:139], v4 offset:24576
ds_read_b128 v[140:143], v5 offset:24576
ds_read_b64_tr_b16 v[112:113], v7 offset:35840
v_mfma_f32_32x32x16_bf16 v[80:95], v[44:47], v[36:39], v[80:95]
ds_read_b64_tr_b16 v[114:115], v7 offset:36608
ds_read_b64_tr_b16 v[116:117], v7 offset:35904
ds_read_b64_tr_b16 v[118:119], v7 offset:36672
s_cbranch_vccnz L_lt_122
v_mfma_f32_32x32x16_bf16 v[96:111], v[48:51], v[36:39], v[96:111]
L_lt_122:
ds_read_b64_tr_b16 v[120:121], v7 offset:35968
ds_read_b64_tr_b16 v[122:123], v7 offset:36736
s_waitcnt lgkmcnt(6)
v_mfma_f32_32x32x16_bf16 v[64:79], v[52:55], v[128:131], v[64:79]
ds_read_b64_tr_b16 v[40:41], v7 offset:38912
ds_read_b64_tr_b16 v[42:43], v7 offset:39680
v_mfma_f32_32x32x16_bf16 v[80:95], v[56:59], v[128:131], v[80:95]
ds_read_b64_tr_b16 v[44:45], v7 offset:38976
ds_read_b64_tr_b16 v[46:47], v7 offset:39744
s_cbranch_vccnz L_lt_123
v_mfma_f32_32x32x16_bf16 v[96:111], v[60:63], v[128:131], v[96:111]
L_lt_123:
ds_read_b64_tr_b16 v[48:49], v7 offset:39040
ds_read_b64_tr_b16 v[50:51], v7 offset:39808
s_waitcnt lgkmcnt(6)
v_mfma_f32_32x32x16_bf16 v[64:79], v[112:115], v[132:135], v[64:79]
ds_read_b64_tr_b16 v[52:53], v7 offset:41984
ds_read_b64_tr_b16 v[54:55], v7 offset:42752
v_mfma_f32_32x32x16_bf16 v[80:95], v[116:119], v[132:135], v[80:95]
ds_read_b64_tr_b16 v[56:57], v7 offset:42048
ds_read_b64_tr_b16 v[58:59], v7 offset:42816
s_cbranch_vccnz L_lt_124
v_mfma_f32_32x32x16_bf16 v[96:111], v[120:123], v[132:135], v[96:111]
L_lt_124:
ds_read_b64_tr_b16 v[60:61], v7 offset:42112
ds_read_b64_tr_b16 v[62:63], v7 offset:42880
s_waitcnt lgkmcnt(6)
v_mfma_f32_32x32x16_bf16 v[64:79], v[40:43], v[136:139], v[64:79]
v_mfma_f32_32x32x16_bf16 v[80:95], v[44:47], v[136:139], v[80:95]
s_cbranch_vccnz L_lt_125
v_mfma_f32_32x32x16_bf16 v[96:111], v[48:51], v[136:139], v[96:111]
L_lt_125:
s_waitcnt lgkmcnt(0)
v_mfma_f32_32x32x16_bf16 v[64:79], v[52:55], v[140:143], v[64:79]
v_mfma_f32_32x32x16_bf16 v[80:95], v[56:59], v[140:143], v[80:95]
s_cbranch_vccnz L_lt_126
v_mfma_f32_32x32x16_bf16 v[96:111], v[60:63], v[140:143], v[96:111]
L_lt_126:
s_waitcnt lgkmcnt(0)
s_barrier
v_lshlrev_b32 v56, 6, v3
v_add_u32 v56, 92160, v56
ds_read_b128 v[112:115], v56 offset:0
ds_read_b128 v[116:119], v56 offset:16
ds_read_b128 v[120:123], v56 offset:32
ds_read_b128 v[124:127], v56 offset:48
ds_read_b128 v[128:131], v56 offset:128
ds_read_b128 v[132:135], v56 offset:144
ds_read_b128 v[136:139], v56 offset:160
ds_read_b128 v[140:143], v56 offset:176
s_lshl_b32 s68, s56, 2
s_add_u32 s68, s68, s5
s_lshl_b32 s70, s87, 14
s_lshl_b32 s71, s68, 11
s_add_u32 s70, s70, s71
s_add_u32 s70, s70, s63
s_add_u32 s70, s70, 786432
s_lshl_b32 s72, s3, 9
s_lshl_b32 s71, s68, 6
s_add_u32 s72, s72, s71
s_lshl_b32 s71, s78, 2
s_add_u32 s93, s72, s71
s_add_u32 s93, s93, 32768
s_waitcnt lgkmcnt(4)
v_pk_mul_f32 v[24:25], v[112:113], v[208:209] op_sel:[0,1] op_sel_hi:[1,1]
v_pk_mul_f32 v[26:27], v[114:115], v[208:209] op_sel:[0,1] op_sel_hi:[1,1]
v_pk_mul_f32 v[28:29], v[116:117], v[208:209] op_sel:[0,1] op_sel_hi:[1,1]
v_pk_mul_f32 v[30:31], v[118:119], v[208:209] op_sel:[0,1] op_sel_hi:[1,1]
v_pk_mul_f32 v[32:33], v[120:121], v[208:209] op_sel:[0,1] op_sel_hi:[1,1]
v_pk_mul_f32 v[34:35], v[122:123], v[208:209] op_sel:[0,1] op_sel_hi:[1,1]
v_pk_mul_f32 v[36:37], v[124:125], v[208:209] op_sel:[0,1] op_sel_hi:[1,1]
v_pk_mul_f32 v[38:39], v[126:127], v[208:209] op_sel:[0,1] op_sel_hi:[1,1]
ds_read_b128 v[112:115], v56 offset:256
ds_read_b128 v[116:119], v56 offset:272
ds_read_b128 v[120:123], v56 offset:288
ds_read_b128 v[124:127], v56 offset:304
v_pk_fma_f32 v[64:65], v[64:65], v[208:209], v[24:25] op_sel_hi:[1,0,1]
v_pk_fma_f32 v[66:67], v[66:67], v[208:209], v[26:27] op_sel_hi:[1,0,1]
v_pk_fma_f32 v[68:69], v[68:69], v[208:209], v[28:29] op_sel_hi:[1,0,1]
v_pk_fma_f32 v[70:71], v[70:71], v[208:209], v[30:31] op_sel_hi:[1,0,1]
v_pk_fma_f32 v[72:73], v[72:73], v[208:209], v[32:33] op_sel_hi:[1,0,1]
v_pk_fma_f32 v[74:75], v[74:75], v[208:209], v[34:35] op_sel_hi:[1,0,1]
v_pk_fma_f32 v[76:77], v[76:77], v[208:209], v[36:37] op_sel_hi:[1,0,1]
v_pk_fma_f32 v[78:79], v[78:79], v[208:209], v[38:39] op_sel_hi:[1,0,1]
v_pk_mul_f32 v[40:41], v[64:65], v[64:65]
v_pk_mul_f32 v[42:43], v[66:67], v[66:67]
v_pk_mul_f32 v[44:45], v[68:69], v[68:69]
v_pk_mul_f32 v[46:47], v[70:71], v[70:71]
v_pk_mul_f32 v[48:49], v[72:73], v[72:73]
v_pk_mul_f32 v[50:51], v[74:75], v[74:75]
v_pk_mul_f32 v[52:53], v[76:77], v[76:77]
v_pk_mul_f32 v[54:55], v[78:79], v[78:79]
v_pk_fma_f32 v[40:41], v[40:41], s[80:81], v[200:201]
v_pk_fma_f32 v[42:43], v[42:43], s[80:81], v[200:201]
v_pk_fma_f32 v[44:45], v[44:45], s[80:81], v[200:201]
v_pk_fma_f32 v[46:47], v[46:47], s[80:81], v[200:201]
v_pk_fma_f32 v[48:49], v[48:49], s[80:81], v[200:201]
v_pk_fma_f32 v[50:51], v[50:51], s[80:81], v[200:201]
v_pk_fma_f32 v[52:53], v[52:53], s[80:81], v[200:201]
v_pk_fma_f32 v[54:55], v[54:55], s[80:81], v[200:201]
v_pk_mul_f32 v[40:41], v[40:41], v[64:65]
v_pk_mul_f32 v[42:43], v[42:43], v[66:67]
v_pk_mul_f32 v[44:45], v[44:45], v[68:69]
v_pk_mul_f32 v[46:47], v[46:47], v[70:71]
v_pk_mul_f32 v[48:49], v[48:49], v[72:73]
v_pk_mul_f32 v[50:51], v[50:51], v[74:75]
v_pk_mul_f32 v[52:53], v[52:53], v[76:77]
v_pk_mul_f32 v[54:55], v[54:55], v[78:79]
v_exp_f32 v40, v40
v_exp_f32 v41, v41
v_exp_f32 v42, v42
v_exp_f32 v43, v43
v_exp_f32 v44, v44
v_exp_f32 v45, v45
v_exp_f32 v46, v46
v_exp_f32 v47, v47
v_exp_f32 v48, v48
v_exp_f32 v49, v49
v_exp_f32 v50, v50
v_exp_f32 v51, v51
v_exp_f32 v52, v52
v_exp_f32 v53, v53
v_exp_f32 v54, v54
v_exp_f32 v55, v55
v_pk_add_f32 v[40:41], v[40:41], s[82:83]
v_pk_add_f32 v[42:43], v[42:43], s[82:83]
v_pk_add_f32 v[44:45], v[44:45], s[82:83]
v_pk_add_f32 v[46:47], v[46:47], s[82:83]
v_pk_add_f32 v[48:49], v[48:49], s[82:83]
v_pk_add_f32 v[50:51], v[50:51], s[82:83]
v_pk_add_f32 v[52:53], v[52:53], s[82:83]
v_pk_add_f32 v[54:55], v[54:55], s[82:83]
v_rcp_f32 v40, v40
v_rcp_f32 v41, v41
v_rcp_f32 v42, v42
v_rcp_f32 v43, v43
v_rcp_f32 v44, v44
v_rcp_f32 v45, v45
v_rcp_f32 v46, v46
v_rcp_f32 v47, v47
v_rcp_f32 v48, v48
v_rcp_f32 v49, v49
v_rcp_f32 v50, v50
v_rcp_f32 v51, v51
v_rcp_f32 v52, v52
v_rcp_f32 v53, v53
v_rcp_f32 v54, v54
v_rcp_f32 v55, v55
v_pk_mul_f32 v[64:65], v[64:65], v[40:41]
v_pk_mul_f32 v[66:67], v[66:67], v[42:43]
v_pk_mul_f32 v[68:69], v[68:69], v[44:45]
v_pk_mul_f32 v[70:71], v[70:71], v[46:47]
v_pk_mul_f32 v[72:73], v[72:73], v[48:49]
v_pk_mul_f32 v[74:75], v[74:75], v[50:51]
v_pk_mul_f32 v[76:77], v[76:77], v[52:53]
v_pk_mul_f32 v[78:79], v[78:79], v[54:55]
v_cvt_pk_bf16_f32 v64, v64, v65
v_cvt_pk_bf16_f32 v65, v66, v67
v_cvt_pk_bf16_f32 v66, v68, v69
v_cvt_pk_bf16_f32 v67, v70, v71
v_cvt_pk_bf16_f32 v68, v72, v73
v_cvt_pk_bf16_f32 v69, v74, v75
v_cvt_pk_bf16_f32 v70, v76, v77
v_cvt_pk_bf16_f32 v71, v78, v79
v_permlane16_swap_b32 v64, v68
v_permlane16_swap_b32 v65, v69
v_permlane16_swap_b32 v66, v70
v_permlane16_swap_b32 v67, v71
s_cmp_lg_u32 s7, 0
s_cbranch_scc1 L_sc_127
buffer_store_dwordx4 v[64:67], v206, s[36:39], s70 offen offset:0
buffer_store_dwordx4 v[68:71], v206, s[36:39], s70 offen offset:1024
s_branch L_sj_128
L_sc_127:
buffer_store_dwordx4 v[64:67], v206, s[36:39], s70 offen offset:0 sc1
buffer_store_dwordx4 v[68:71], v206, s[36:39], s70 offen offset:1024 sc1
L_sj_128:
s_add_u32 s70, s70, 16384
s_waitcnt lgkmcnt(4)
v_pk_mul_f32 v[24:25], v[128:129], v[208:209] op_sel:[0,1] op_sel_hi:[1,1]
v_pk_mul_f32 v[26:27], v[130:131], v[208:209] op_sel:[0,1] op_sel_hi:[1,1]
v_pk_mul_f32 v[28:29], v[132:133], v[208:209] op_sel:[0,1] op_sel_hi:[1,1]
v_pk_mul_f32 v[30:31], v[134:135], v[208:209] op_sel:[0,1] op_sel_hi:[1,1]
v_pk_mul_f32 v[32:33], v[136:137], v[208:209] op_sel:[0,1] op_sel_hi:[1,1]
v_pk_mul_f32 v[34:35], v[138:139], v[208:209] op_sel:[0,1] op_sel_hi:[1,1]
v_pk_mul_f32 v[36:37], v[140:141], v[208:209] op_sel:[0,1] op_sel_hi:[1,1]
v_pk_mul_f32 v[38:39], v[142:143], v[208:209] op_sel:[0,1] op_sel_hi:[1,1]
v_pk_fma_f32 v[80:81], v[80:81], v[208:209], v[24:25] op_sel_hi:[1,0,1]
v_pk_fma_f32 v[82:83], v[82:83], v[208:209], v[26:27] op_sel_hi:[1,0,1]
v_pk_fma_f32 v[84:85], v[84:85], v[208:209], v[28:29] op_sel_hi:[1,0,1]
v_pk_fma_f32 v[86:87], v[86:87], v[208:209], v[30:31] op_sel_hi:[1,0,1]
v_pk_fma_f32 v[88:89], v[88:89], v[208:209], v[32:33] op_sel_hi:[1,0,1]
v_pk_fma_f32 v[90:91], v[90:91], v[208:209], v[34:35] op_sel_hi:[1,0,1]
v_pk_fma_f32 v[92:93], v[92:93], v[208:209], v[36:37] op_sel_hi:[1,0,1]
v_pk_fma_f32 v[94:95], v[94:95], v[208:209], v[38:39] op_sel_hi:[1,0,1]
v_pk_mul_f32 v[40:41], v[80:81], v[80:81]
v_pk_mul_f32 v[42:43], v[82:83], v[82:83]
v_pk_mul_f32 v[44:45], v[84:85], v[84:85]
v_pk_mul_f32 v[46:47], v[86:87], v[86:87]
v_pk_mul_f32 v[48:49], v[88:89], v[88:89]
v_pk_mul_f32 v[50:51], v[90:91], v[90:91]
v_pk_mul_f32 v[52:53], v[92:93], v[92:93]
v_pk_mul_f32 v[54:55], v[94:95], v[94:95]
v_pk_fma_f32 v[40:41], v[40:41], s[80:81], v[200:201]
v_pk_fma_f32 v[42:43], v[42:43], s[80:81], v[200:201]
v_pk_fma_f32 v[44:45], v[44:45], s[80:81], v[200:201]
v_pk_fma_f32 v[46:47], v[46:47], s[80:81], v[200:201]
v_pk_fma_f32 v[48:49], v[48:49], s[80:81], v[200:201]
v_pk_fma_f32 v[50:51], v[50:51], s[80:81], v[200:201]
v_pk_fma_f32 v[52:53], v[52:53], s[80:81], v[200:201]
v_pk_fma_f32 v[54:55], v[54:55], s[80:81], v[200:201]
v_pk_mul_f32 v[40:41], v[40:41], v[80:81]
v_pk_mul_f32 v[42:43], v[42:43], v[82:83]
v_pk_mul_f32 v[44:45], v[44:45], v[84:85]
v_pk_mul_f32 v[46:47], v[46:47], v[86:87]
v_pk_mul_f32 v[48:49], v[48:49], v[88:89]
v_pk_mul_f32 v[50:51], v[50:51], v[90:91]
v_pk_mul_f32 v[52:53], v[52:53], v[92:93]
v_pk_mul_f32 v[54:55], v[54:55], v[94:95]
v_exp_f32 v40, v40
v_exp_f32 v41, v41
v_exp_f32 v42, v42
v_exp_f32 v43, v43
v_exp_f32 v44, v44
v_exp_f32 v45, v45
v_exp_f32 v46, v46
v_exp_f32 v47, v47
v_exp_f32 v48, v48
v_exp_f32 v49, v49
v_exp_f32 v50, v50
v_exp_f32 v51, v51
v_exp_f32 v52, v52
v_exp_f32 v53, v53
v_exp_f32 v54, v54
v_exp_f32 v55, v55
v_pk_add_f32 v[40:41], v[40:41], s[82:83]
v_pk_add_f32 v[42:43], v[42:43], s[82:83]
v_pk_add_f32 v[44:45], v[44:45], s[82:83]
v_pk_add_f32 v[46:47], v[46:47], s[82:83]
v_pk_add_f32 v[48:49], v[48:49], s[82:83]
v_pk_add_f32 v[50:51], v[50:51], s[82:83]
v_pk_add_f32 v[52:53], v[52:53], s[82:83]
v_pk_add_f32 v[54:55], v[54:55], s[82:83]
v_rcp_f32 v40, v40
v_rcp_f32 v41, v41
v_rcp_f32 v42, v42
v_rcp_f32 v43, v43
v_rcp_f32 v44, v44
v_rcp_f32 v45, v45
v_rcp_f32 v46, v46
v_rcp_f32 v47, v47
v_rcp_f32 v48, v48
v_rcp_f32 v49, v49
v_rcp_f32 v50, v50
v_rcp_f32 v51, v51
v_rcp_f32 v52, v52
v_rcp_f32 v53, v53
v_rcp_f32 v54, v54
v_rcp_f32 v55, v55
v_pk_mul_f32 v[80:81], v[80:81], v[40:41]
v_pk_mul_f32 v[82:83], v[82:83], v[42:43]
v_pk_mul_f32 v[84:85], v[84:85], v[44:45]
v_pk_mul_f32 v[86:87], v[86:87], v[46:47]
v_pk_mul_f32 v[88:89], v[88:89], v[48:49]
v_pk_mul_f32 v[90:91], v[90:91], v[50:51]
v_pk_mul_f32 v[92:93], v[92:93], v[52:53]
v_pk_mul_f32 v[94:95], v[94:95], v[54:55]
v_cvt_pk_bf16_f32 v80, v80, v81
v_cvt_pk_bf16_f32 v81, v82, v83
v_cvt_pk_bf16_f32 v82, v84, v85
v_cvt_pk_bf16_f32 v83, v86, v87
v_cvt_pk_bf16_f32 v84, v88, v89
v_cvt_pk_bf16_f32 v85, v90, v91
v_cvt_pk_bf16_f32 v86, v92, v93
v_cvt_pk_bf16_f32 v87, v94, v95
v_permlane16_swap_b32 v80, v84
v_permlane16_swap_b32 v81, v85
v_permlane16_swap_b32 v82, v86
v_permlane16_swap_b32 v83, v87
s_waitcnt vmcnt(0)
v_mov_b32 v58, s6
v_mov_b32 v59, s93
s_mov_b64 exec, 1
s_cmp_lg_u32 s7, 0
s_cbranch_scc1 L_sc_129
buffer_store_dword v58, v59, s[40:43], 0 offen
s_branch L_sj_130
L_sc_129:
buffer_store_dword v58, v59, s[40:43], 0 offen sc1
L_sj_130:
s_mov_b64 exec, -1
s_add_u32 s93, s93, 8192
s_cmp_lg_u32 s7, 0
s_cbranch_scc1 L_sc_131
buffer_store_dwordx4 v[80:83], v206, s[36:39], s70 offen offset:0
buffer_store_dwordx4 v[84:87], v206, s[36:39], s70 offen offset:1024
s_branch L_sj_132
L_sc_131:
buffer_store_dwordx4 v[80:83], v206, s[36:39], s70 offen offset:0 sc1
buffer_store_dwordx4 v[84:87], v206, s[36:39], s70 offen offset:1024 sc1
L_sj_132:
s_add_u32 s70, s70, 16384
s_cmp_ge_u32 s78, 11
s_cbranch_scc1 L_lt_133
s_waitcnt lgkmcnt(0)
v_pk_mul_f32 v[24:25], v[112:113], v[208:209] op_sel:[0,1] op_sel_hi:[1,1]
v_pk_mul_f32 v[26:27], v[114:115], v[208:209] op_sel:[0,1] op_sel_hi:[1,1]
v_pk_mul_f32 v[28:29], v[116:117], v[208:209] op_sel:[0,1] op_sel_hi:[1,1]
v_pk_mul_f32 v[30:31], v[118:119], v[208:209] op_sel:[0,1] op_sel_hi:[1,1]
v_pk_mul_f32 v[32:33], v[120:121], v[208:209] op_sel:[0,1] op_sel_hi:[1,1]
v_pk_mul_f32 v[34:35], v[122:123], v[208:209] op_sel:[0,1] op_sel_hi:[1,1]
v_pk_mul_f32 v[36:37], v[124:125], v[208:209] op_sel:[0,1] op_sel_hi:[1,1]
v_pk_mul_f32 v[38:39], v[126:127], v[208:209] op_sel:[0,1] op_sel_hi:[1,1]
v_pk_fma_f32 v[96:97], v[96:97], v[208:209], v[24:25] op_sel_hi:[1,0,1]
v_pk_fma_f32 v[98:99], v[98:99], v[208:209], v[26:27] op_sel_hi:[1,0,1]
v_pk_fma_f32 v[100:101], v[100:101], v[208:209], v[28:29] op_sel_hi:[1,0,1]
v_pk_fma_f32 v[102:103], v[102:103], v[208:209], v[30:31] op_sel_hi:[1,0,1]
v_pk_fma_f32 v[104:105], v[104:105], v[208:209], v[32:33] op_sel_hi:[1,0,1]
v_pk_fma_f32 v[106:107], v[106:107], v[208:209], v[34:35] op_sel_hi:[1,0,1]
v_pk_fma_f32 v[108:109], v[108:109], v[208:209], v[36:37] op_sel_hi:[1,0,1]
v_pk_fma_f32 v[110:111], v[110:111], v[208:209], v[38:39] op_sel_hi:[1,0,1]
v_pk_mul_f32 v[40:41], v[96:97], v[96:97]
v_pk_mul_f32 v[42:43], v[98:99], v[98:99]
v_pk_mul_f32 v[44:45], v[100:101], v[100:101]
v_pk_mul_f32 v[46:47], v[102:103], v[102:103]
v_pk_mul_f32 v[48:49], v[104:105], v[104:105]
v_pk_mul_f32 v[50:51], v[106:107], v[106:107]
v_pk_mul_f32 v[52:53], v[108:109], v[108:109]
v_pk_mul_f32 v[54:55], v[110:111], v[110:111]
v_pk_fma_f32 v[40:41], v[40:41], s[80:81], v[200:201]
v_pk_fma_f32 v[42:43], v[42:43], s[80:81], v[200:201]
v_pk_fma_f32 v[44:45], v[44:45], s[80:81], v[200:201]
v_pk_fma_f32 v[46:47], v[46:47], s[80:81], v[200:201]
v_pk_fma_f32 v[48:49], v[48:49], s[80:81], v[200:201]
v_pk_fma_f32 v[50:51], v[50:51], s[80:81], v[200:201]
v_pk_fma_f32 v[52:53], v[52:53], s[80:81], v[200:201]
v_pk_fma_f32 v[54:55], v[54:55], s[80:81], v[200:201]
v_pk_mul_f32 v[40:41], v[40:41], v[96:97]
v_pk_mul_f32 v[42:43], v[42:43], v[98:99]
v_pk_mul_f32 v[44:45], v[44:45], v[100:101]
v_pk_mul_f32 v[46:47], v[46:47], v[102:103]
v_pk_mul_f32 v[48:49], v[48:49], v[104:105]
v_pk_mul_f32 v[50:51], v[50:51], v[106:107]
v_pk_mul_f32 v[52:53], v[52:53], v[108:109]
v_pk_mul_f32 v[54:55], v[54:55], v[110:111]
v_exp_f32 v40, v40
v_exp_f32 v41, v41
v_exp_f32 v42, v42
v_exp_f32 v43, v43
v_exp_f32 v44, v44
v_exp_f32 v45, v45
v_exp_f32 v46, v46
v_exp_f32 v47, v47
v_exp_f32 v48, v48
v_exp_f32 v49, v49
v_exp_f32 v50, v50
v_exp_f32 v51, v51
v_exp_f32 v52, v52
v_exp_f32 v53, v53
v_exp_f32 v54, v54
v_exp_f32 v55, v55
v_pk_add_f32 v[40:41], v[40:41], s[82:83]
v_pk_add_f32 v[42:43], v[42:43], s[82:83]
v_pk_add_f32 v[44:45], v[44:45], s[82:83]
v_pk_add_f32 v[46:47], v[46:47], s[82:83]
v_pk_add_f32 v[48:49], v[48:49], s[82:83]
v_pk_add_f32 v[50:51], v[50:51], s[82:83]
v_pk_add_f32 v[52:53], v[52:53], s[82:83]
v_pk_add_f32 v[54:55], v[54:55], s[82:83]
v_rcp_f32 v40, v40
v_rcp_f32 v41, v41
v_rcp_f32 v42, v42
v_rcp_f32 v43, v43
v_rcp_f32 v44, v44
v_rcp_f32 v45, v45
v_rcp_f32 v46, v46
v_rcp_f32 v47, v47
v_rcp_f32 v48, v48
v_rcp_f32 v49, v49
v_rcp_f32 v50, v50
v_rcp_f32 v51, v51
v_rcp_f32 v52, v52
v_rcp_f32 v53, v53
v_rcp_f32 v54, v54
v_rcp_f32 v55, v55
v_pk_mul_f32 v[96:97], v[96:97], v[40:41]
v_pk_mul_f32 v[98:99], v[98:99], v[42:43]
v_pk_mul_f32 v[100:101], v[100:101], v[44:45]
v_pk_mul_f32 v[102:103], v[102:103], v[46:47]
v_pk_mul_f32 v[104:105], v[104:105], v[48:49]
v_pk_mul_f32 v[106:107], v[106:107], v[50:51]
v_pk_mul_f32 v[108:109], v[108:109], v[52:53]
v_pk_mul_f32 v[110:111], v[110:111], v[54:55]
v_cvt_pk_bf16_f32 v96, v96, v97
v_cvt_pk_bf16_f32 v97, v98, v99
v_cvt_pk_bf16_f32 v98, v100, v101
v_cvt_pk_bf16_f32 v99, v102, v103
v_cvt_pk_bf16_f32 v100, v104, v105
v_cvt_pk_bf16_f32 v101, v106, v107
v_cvt_pk_bf16_f32 v102, v108, v109
v_cvt_pk_bf16_f32 v103, v110, v111
v_permlane16_swap_b32 v96, v100
v_permlane16_swap_b32 v97, v101
v_permlane16_swap_b32 v98, v102
v_permlane16_swap_b32 v99, v103
s_waitcnt vmcnt(0)
v_mov_b32 v58, s6
v_mov_b32 v59, s93
s_mov_b64 exec, 1
s_cmp_lg_u32 s7, 0
s_cbranch_scc1 L_sc_134
buffer_store_dword v58, v59, s[40:43], 0 offen
s_branch L_sj_135
L_sc_134:
buffer_store_dword v58, v59, s[40:43], 0 offen sc1
L_sj_135:
s_mov_b64 exec, -1
s_add_u32 s93, s93, 8192
s_cmp_lg_u32 s7, 0
s_cbranch_scc1 L_sc_136
buffer_store_dwordx4 v[96:99], v206, s[36:39], s70 offen offset:0
buffer_store_dwordx4 v[100:103], v206, s[36:39], s70 offen offset:1024
s_branch L_sj_137
L_sc_136:
buffer_store_dwordx4 v[96:99], v206, s[36:39], s70 offen offset:0 sc1
buffer_store_dwordx4 v[100:103], v206, s[36:39], s70 offen offset:1024 sc1
L_sj_137:
L_lt_133:
s_waitcnt lgkmcnt(0)
s_cmp_eq_u32 s58, 0
s_cbranch_scc1 L_noo_138
s_lshl_b32 s68, s56, 1
s_add_u32 s68, s68, s59
s_lshl_b32 s69, s57, 1
s_add_u32 s69, s69, s60
s_lshl_b32 s70, s69, 14
s_lshl_b32 s71, s68, 12
s_add_u32 s70, s70, s71
s_add_u32 s70, s70, s63
s_add_u32 s70, s70, 524288
s_waitcnt vmcnt(2)
v_mfma_f32_32x32x16_bf16 v[96:111], v[232:235], v[160:163], 0
v_mfma_f32_32x32x16_bf16 v[96:111], v[236:239], v[164:167], v[96:111]
v_mfma_f32_32x32x16_bf16 v[96:111], v[240:243], v[168:171], v[96:111]
v_mfma_f32_32x32x16_bf16 v[96:111], v[244:247], v[172:175], v[96:111]
v_mfma_f32_32x32x16_bf16 v[112:127], v[232:235], v[176:179], 0
v_mfma_f32_32x32x16_bf16 v[112:127], v[236:239], v[180:183], v[112:127]
v_mfma_f32_32x32x16_bf16 v[112:127], v[240:243], v[184:187], v[112:127]
v_mfma_f32_32x32x16_bf16 v[112:127], v[244:247], v[188:191], v[112:127]
v_mov_b32 v24, 0
v_mov_b32 v25, 0
v_mov_b32 v26, 0
v_mov_b32 v27, 0
v_dot2_f32_bf16 v24, v160, v144, v24
v_dot2_f32_bf16 v25, v161, v145, v25
v_dot2_f32_bf16 v26, v162, v146, v26
v_dot2_f32_bf16 v27, v163, v147, v27
v_dot2_f32_bf16 v24, v164, v148, v24
v_dot2_f32_bf16 v25, v165, v149, v25
v_dot2_f32_bf16 v26, v166, v150, v26
v_dot2_f32_bf16 v27, v167, v151, v27
v_dot2_f32_bf16 v24, v168, v152, v24
v_dot2_f32_bf16 v25, v169, v153, v25
v_dot2_f32_bf16 v26, v170, v154, v26
v_dot2_f32_bf16 v27, v171, v155, v27
v_dot2_f32_bf16 v24, v172, v156, v24
v_dot2_f32_bf16 v25, v173, v157, v25
v_dot2_f32_bf16 v26, v174, v158, v26
v_dot2_f32_bf16 v27, v175, v159, v27
v_mov_b32 v28, 0
v_mov_b32 v29, 0
v_mov_b32 v30, 0
v_mov_b32 v31, 0
v_dot2_f32_bf16 v28, v176, v144, v28
v_dot2_f32_bf16 v29, v177, v145, v29
v_dot2_f32_bf16 v30, v178, v146, v30
v_dot2_f32_bf16 v31, v179, v147, v31
v_dot2_f32_bf16 v28, v180, v148, v28
v_dot2_f32_bf16 v29, v181, v149, v29
v_dot2_f32_bf16 v30, v182, v150, v30
v_dot2_f32_bf16 v31, v183, v151, v31
v_dot2_f32_bf16 v28, v184, v152, v28
v_dot2_f32_bf16 v29, v185, v153, v29
v_dot2_f32_bf16 v30, v186, v154, v30
v_dot2_f32_bf16 v31, v187, v155, v31
v_dot2_f32_bf16 v28, v188, v156, v28
v_dot2_f32_bf16 v29, v189, v157, v29
v_dot2_f32_bf16 v30, v190, v158, v30
v_dot2_f32_bf16 v31, v191, v159, v31
s_waitcnt vmcnt(0)
v_mov_b32 v56, s6
v_mov_b32 v57, s93
s_mov_b64 exec, 1
s_cmp_lg_u32 s7, 0
s_cbranch_scc1 L_sc_140
buffer_store_dword v56, v57, s[40:43], 0 offen
s_branch L_sj_141
L_sc_140:
buffer_store_dword v56, v57, s[40:43], 0 offen sc1
L_sj_141:
s_mov_b64 exec, -1
v_add_f32 v24, v24, v25
v_add_f32 v26, v26, v27
v_add_f32 v24, v24, v26
v_cvt_pk_bf16_f32 v25, v24, v24
v_lshlrev_b32 v24, 16, v25
v_add_f32 v24, 897988541, v24
v_cvt_pk_bf16_f32 v25, v24, v24
v_lshlrev_b32 v24, 16, v25
v_rcp_f32 v24, v24
v_add_f32 v28, v28, v29
v_add_f32 v30, v30, v31
v_add_f32 v28, v28, v30
v_cvt_pk_bf16_f32 v29, v28, v28
v_lshlrev_b32 v28, 16, v29
v_add_f32 v28, 897988541, v28
v_cvt_pk_bf16_f32 v29, v28, v28
v_lshlrev_b32 v28, 16, v29
v_rcp_f32 v28, v28
v_cvt_pk_bf16_f32 v40, v96, v97
v_cvt_pk_bf16_f32 v41, v98, v99
v_cvt_pk_bf16_f32 v42, v100, v101
v_cvt_pk_bf16_f32 v43, v102, v103
v_cvt_pk_bf16_f32 v44, v104, v105
v_cvt_pk_bf16_f32 v45, v106, v107
v_cvt_pk_bf16_f32 v46, v108, v109
v_cvt_pk_bf16_f32 v47, v110, v111
v_lshlrev_b32 v96, 16, v40
v_and_b32 v97, 0xffff0000, v40
v_lshlrev_b32 v98, 16, v41
v_and_b32 v99, 0xffff0000, v41
v_lshlrev_b32 v100, 16, v42
v_and_b32 v101, 0xffff0000, v42
v_lshlrev_b32 v102, 16, v43
v_and_b32 v103, 0xffff0000, v43
v_lshlrev_b32 v104, 16, v44
v_and_b32 v105, 0xffff0000, v44
v_lshlrev_b32 v106, 16, v45
v_and_b32 v107, 0xffff0000, v45
v_lshlrev_b32 v108, 16, v46
v_and_b32 v109, 0xffff0000, v46
v_lshlrev_b32 v110, 16, v47
v_and_b32 v111, 0xffff0000, v47
v_pk_mul_f32 v[96:97], v[96:97], v[24:25] op_sel_hi:[1,0]
v_pk_mul_f32 v[98:99], v[98:99], v[24:25] op_sel_hi:[1,0]
v_pk_mul_f32 v[100:101], v[100:101], v[24:25] op_sel_hi:[1,0]
v_pk_mul_f32 v[102:103], v[102:103], v[24:25] op_sel_hi:[1,0]
v_pk_mul_f32 v[104:105], v[104:105], v[24:25] op_sel_hi:[1,0]
v_pk_mul_f32 v[106:107], v[106:107], v[24:25] op_sel_hi:[1,0]
v_pk_mul_f32 v[108:109], v[108:109], v[24:25] op_sel_hi:[1,0]
v_pk_mul_f32 v[110:111], v[110:111], v[24:25] op_sel_hi:[1,0]
v_cvt_pk_bf16_f32 v208, v96, v97
v_cvt_pk_bf16_f32 v209, v98, v99
v_cvt_pk_bf16_f32 v210, v100, v101
v_cvt_pk_bf16_f32 v211, v102, v103
v_cvt_pk_bf16_f32 v212, v104, v105
v_cvt_pk_bf16_f32 v213, v106, v107
v_cvt_pk_bf16_f32 v214, v108, v109
v_cvt_pk_bf16_f32 v215, v110, v111
v_permlane16_swap_b32 v208, v212
v_permlane16_swap_b32 v209, v213
v_permlane16_swap_b32 v210, v214
v_permlane16_swap_b32 v211, v215
s_cmp_lg_u32 s7, 0
s_cbranch_scc1 L_sc_142
buffer_store_dwordx4 v[208:211], v206, s[36:39], s70 offen offset:0
buffer_store_dwordx4 v[212:215], v206, s[36:39], s70 offen offset:1024
s_branch L_sj_143
L_sc_142:
buffer_store_dwordx4 v[208:211], v206, s[36:39], s70 offen offset:0 sc1
buffer_store_dwordx4 v[212:215], v206, s[36:39], s70 offen offset:1024 sc1
L_sj_143:
v_cvt_pk_bf16_f32 v40, v112, v113
v_cvt_pk_bf16_f32 v41, v114, v115
v_cvt_pk_bf16_f32 v42, v116, v117
v_cvt_pk_bf16_f32 v43, v118, v119
v_cvt_pk_bf16_f32 v44, v120, v121
v_cvt_pk_bf16_f32 v45, v122, v123
v_cvt_pk_bf16_f32 v46, v124, v125
v_cvt_pk_bf16_f32 v47, v126, v127
v_lshlrev_b32 v112, 16, v40
v_and_b32 v113, 0xffff0000, v40
v_lshlrev_b32 v114, 16, v41
v_and_b32 v115, 0xffff0000, v41
v_lshlrev_b32 v116, 16, v42
v_and_b32 v117, 0xffff0000, v42
v_lshlrev_b32 v118, 16, v43
v_and_b32 v119, 0xffff0000, v43
v_lshlrev_b32 v120, 16, v44
v_and_b32 v121, 0xffff0000, v44
v_lshlrev_b32 v122, 16, v45
v_and_b32 v123, 0xffff0000, v45
v_lshlrev_b32 v124, 16, v46
v_and_b32 v125, 0xffff0000, v46
v_lshlrev_b32 v126, 16, v47
v_and_b32 v127, 0xffff0000, v47
v_pk_mul_f32 v[112:113], v[112:113], v[28:29] op_sel_hi:[1,0]
v_pk_mul_f32 v[114:115], v[114:115], v[28:29] op_sel_hi:[1,0]
v_pk_mul_f32 v[116:117], v[116:117], v[28:29] op_sel_hi:[1,0]
v_pk_mul_f32 v[118:119], v[118:119], v[28:29] op_sel_hi:[1,0]
v_pk_mul_f32 v[120:121], v[120:121], v[28:29] op_sel_hi:[1,0]
v_pk_mul_f32 v[122:123], v[122:123], v[28:29] op_sel_hi:[1,0]
v_pk_mul_f32 v[124:125], v[124:125], v[28:29] op_sel_hi:[1,0]
v_pk_mul_f32 v[126:127], v[126:127], v[28:29] op_sel_hi:[1,0]
v_cvt_pk_bf16_f32 v216, v112, v113
v_cvt_pk_bf16_f32 v217, v114, v115
v_cvt_pk_bf16_f32 v218, v116, v117
v_cvt_pk_bf16_f32 v219, v118, v119
v_cvt_pk_bf16_f32 v220, v120, v121
v_cvt_pk_bf16_f32 v221, v122, v123
v_cvt_pk_bf16_f32 v222, v124, v125
v_cvt_pk_bf16_f32 v223, v126, v127
v_permlane16_swap_b32 v216, v220
v_permlane16_swap_b32 v217, v221
v_permlane16_swap_b32 v218, v222
v_permlane16_swap_b32 v219, v223
s_add_u32 s70, s70, 2048
s_cmp_lg_u32 s7, 0
s_cbranch_scc1 L_sc_144
buffer_store_dwordx4 v[216:219], v206, s[36:39], s70 offen offset:0
buffer_store_dwordx4 v[220:223], v206, s[36:39], s70 offen offset:1024
s_branch L_sj_145
L_sc_144:
buffer_store_dwordx4 v[216:219], v206, s[36:39], s70 offen offset:0 sc1
buffer_store_dwordx4 v[220:223], v206, s[36:39], s70 offen offset:1024 sc1
L_sj_145:
s_lshl_b32 s70, s3, 8
s_lshl_b32 s71, s68, 6
s_add_u32 s70, s70, s71
s_lshl_b32 s71, s69, 2
s_add_u32 s94, s70, s71
s_add_u32 s94, s94, 36864
s_branch L_oj_139
L_noo_138:
s_waitcnt vmcnt(0)
v_mov_b32 v24, s6
v_mov_b32 v25, s93
s_mov_b64 exec, 1
s_cmp_lg_u32 s7, 0
s_cbranch_scc1 L_sc_146
buffer_store_dword v24, v25, s[40:43], 0 offen
s_branch L_sj_147
L_sc_146:
buffer_store_dword v24, v25, s[40:43], 0 offen sc1
L_sj_147:
s_mov_b64 exec, -1
L_oj_139:
v_add_u32 v210, 98304, v203
v_add_u32 v211, 98304, v204
v_add_u32 v212, 0x10000, v205
v_lshlrev_b32 v128, 16, v192
v_and_b32 v129, 0xffff0000, v192
v_lshlrev_b32 v130, 16, v193
v_and_b32 v131, 0xffff0000, v193
v_lshlrev_b32 v132, 16, v194
v_and_b32 v133, 0xffff0000, v194
v_lshlrev_b32 v134, 16, v195
v_and_b32 v135, 0xffff0000, v195
v_lshlrev_b32 v136, 16, v196
v_and_b32 v137, 0xffff0000, v196
v_lshlrev_b32 v138, 16, v197
v_and_b32 v139, 0xffff0000, v197
v_lshlrev_b32 v140, 16, v198
v_and_b32 v141, 0xffff0000, v198
v_lshlrev_b32 v142, 16, v199
v_and_b32 v143, 0xffff0000, v199
v_sub_f32 v214, 1.0, v207
v_cvt_pk_bf16_f32 v215, v214, v214
v_lshlrev_b32 v214, 16, v215
v_mov_b32 v216, v207
s_barrier
ds_read_b128 v[24:27], v210 offset:0
ds_read_b64_tr_b16 v[32:33], v205 offset:0
ds_read_b64_tr_b16 v[34:35], v205 offset:512
ds_read_b128 v[28:31], v211 offset:0
ds_read_b64_tr_b16 v[36:37], v205 offset:2048
ds_read_b64_tr_b16 v[38:39], v205 offset:2560
ds_read_b128 v[40:43], v210 offset:4096
ds_read_b64_tr_b16 v[48:49], v205 offset:4096
ds_read_b64_tr_b16 v[50:51], v205 offset:4608
ds_read_b128 v[44:47], v211 offset:4096
ds_read_b64_tr_b16 v[52:53], v205 offset:6144
ds_read_b64_tr_b16 v[54:55], v205 offset:6656
s_waitcnt lgkmcnt(6)
s_barrier
v_mfma_f32_32x32x16_bf16 v[64:79], v[32:35], v[24:27], 0
ds_read_b128 v[96:99], v210 offset:8192
ds_read_b64_tr_b16 v[104:105], v205 offset:8192
ds_read_b64_tr_b16 v[106:107], v205 offset:8704
v_mfma_f32_32x32x16_bf16 v[64:79], v[36:39], v[28:31], v[64:79]
ds_read_b128 v[100:103], v211 offset:8192
ds_read_b64_tr_b16 v[108:109], v205 offset:10240
ds_read_b64_tr_b16 v[110:111], v205 offset:10752
s_waitcnt lgkmcnt(6)
v_mfma_f32_32x32x16_bf16 v[64:79], v[48:51], v[40:43], v[64:79]
ds_read_b128 v[24:27], v210 offset:12288
ds_read_b64_tr_b16 v[32:33], v205 offset:12288
ds_read_b64_tr_b16 v[34:35], v205 offset:12800
v_mfma_f32_32x32x16_bf16 v[64:79], v[52:55], v[44:47], v[64:79]
ds_read_b128 v[28:31], v211 offset:12288
ds_read_b64_tr_b16 v[36:37], v205 offset:14336
ds_read_b64_tr_b16 v[38:39], v205 offset:14848
s_waitcnt lgkmcnt(6)
s_barrier
s_cmp_eq_u32 s58, 0
s_cbranch_scc1 L_nof_148
s_waitcnt vmcnt(0)
v_mov_b32 v250, s6
v_mov_b32 v251, s94
s_mov_b64 exec, 1
s_cmp_lg_u32 s7, 0
s_cbranch_scc1 L_sc_149
buffer_store_dword v250, v251, s[40:43], 0 offen
s_branch L_sj_150
L_sc_149:
buffer_store_dword v250, v251, s[40:43], 0 offen sc1
L_sj_150:
s_mov_b64 exec, -1
L_nof_148:
v_mfma_f32_32x32x16_bf16 v[64:79], v[104:107], v[96:99], v[64:79]
ds_read_b128 v[40:43], v210 offset:16384
ds_read_b64_tr_b16 v[48:49], v205 offset:16384
ds_read_b64_tr_b16 v[50:51], v205 offset:16896
v_mfma_f32_32x32x16_bf16 v[64:79], v[108:111], v[100:103], v[64:79]
ds_read_b128 v[44:47], v211 offset:16384
ds_read_b64_tr_b16 v[52:53], v205 offset:18432
ds_read_b64_tr_b16 v[54:55], v205 offset:18944
s_waitcnt lgkmcnt(6)
v_mfma_f32_32x32x16_bf16 v[64:79], v[32:35], v[24:27], v[64:79]
ds_read_b128 v[96:99], v210 offset:20480
ds_read_b64_tr_b16 v[104:105], v205 offset:20480
ds_read_b64_tr_b16 v[106:107], v205 offset:20992
v_mfma_f32_32x32x16_bf16 v[64:79], v[36:39], v[28:31], v[64:79]
ds_read_b128 v[100:103], v211 offset:20480
ds_read_b64_tr_b16 v[108:109], v205 offset:22528
ds_read_b64_tr_b16 v[110:111], v205 offset:23040
s_waitcnt lgkmcnt(6)
s_barrier
v_mfma_f32_32x32x16_bf16 v[64:79], v[48:51], v[40:43], v[64:79]
ds_read_b128 v[24:27], v210 offset:24576
ds_read_b64_tr_b16 v[32:33], v205 offset:24576
ds_read_b64_tr_b16 v[34:35], v205 offset:25088
v_mfma_f32_32x32x16_bf16 v[64:79], v[52:55], v[44:47], v[64:79]
ds_read_b128 v[28:31], v211 offset:24576
ds_read_b64_tr_b16 v[36:37], v205 offset:26624
ds_read_b64_tr_b16 v[38:39], v205 offset:27136
s_waitcnt lgkmcnt(6)
v_mfma_f32_32x32x16_bf16 v[64:79], v[104:107], v[96:99], v[64:79]
ds_read_b128 v[40:43], v210 offset:28672
ds_read_b64_tr_b16 v[48:49], v205 offset:28672
ds_read_b64_tr_b16 v[50:51], v205 offset:29184
v_mfma_f32_32x32x16_bf16 v[64:79], v[108:111], v[100:103], v[64:79]
ds_read_b128 v[44:47], v211 offset:28672
ds_read_b64_tr_b16 v[52:53], v205 offset:30720
ds_read_b64_tr_b16 v[54:55], v205 offset:31232
s_waitcnt lgkmcnt(6)
s_barrier
v_mfma_f32_32x32x16_bf16 v[64:79], v[32:35], v[24:27], v[64:79]
ds_read_b128 v[96:99], v210 offset:32768
ds_read_b64_tr_b16 v[104:105], v205 offset:32768
ds_read_b64_tr_b16 v[106:107], v205 offset:33280
v_mfma_f32_32x32x16_bf16 v[64:79], v[36:39], v[28:31], v[64:79]
ds_read_b128 v[100:103], v211 offset:32768
ds_read_b64_tr_b16 v[108:109], v205 offset:34816
ds_read_b64_tr_b16 v[110:111], v205 offset:35328
s_waitcnt lgkmcnt(6)
v_mfma_f32_32x32x16_bf16 v[64:79], v[48:51], v[40:43], v[64:79]
ds_read_b128 v[24:27], v210 offset:36864
ds_read_b64_tr_b16 v[32:33], v205 offset:36864
ds_read_b64_tr_b16 v[34:35], v205 offset:37376
v_mfma_f32_32x32x16_bf16 v[64:79], v[52:55], v[44:47], v[64:79]
ds_read_b128 v[28:31], v211 offset:36864
ds_read_b64_tr_b16 v[36:37], v205 offset:38912
ds_read_b64_tr_b16 v[38:39], v205 offset:39424
s_waitcnt lgkmcnt(6)
s_barrier
v_mfma_f32_32x32x16_bf16 v[64:79], v[104:107], v[96:99], v[64:79]
ds_read_b128 v[40:43], v210 offset:40960
ds_read_b64_tr_b16 v[48:49], v205 offset:40960
ds_read_b64_tr_b16 v[50:51], v205 offset:41472
v_mfma_f32_32x32x16_bf16 v[64:79], v[108:111], v[100:103], v[64:79]
ds_read_b128 v[44:47], v211 offset:40960
ds_read_b64_tr_b16 v[52:53], v205 offset:43008
ds_read_b64_tr_b16 v[54:55], v205 offset:43520
s_waitcnt lgkmcnt(6)
v_mfma_f32_32x32x16_bf16 v[64:79], v[32:35], v[24:27], v[64:79]
ds_read_b128 v[96:99], v210 offset:45056
ds_read_b64_tr_b16 v[104:105], v205 offset:45056
ds_read_b64_tr_b16 v[106:107], v205 offset:45568
v_mfma_f32_32x32x16_bf16 v[64:79], v[36:39], v[28:31], v[64:79]
ds_read_b128 v[100:103], v211 offset:45056
ds_read_b64_tr_b16 v[108:109], v205 offset:47104
ds_read_b64_tr_b16 v[110:111], v205 offset:47616
s_waitcnt lgkmcnt(6)
s_barrier
v_mfma_f32_32x32x16_bf16 v[64:79], v[48:51], v[40:43], v[64:79]
ds_read_b128 v[24:27], v210 offset:49152
ds_read_b64_tr_b16 v[32:33], v205 offset:49152
ds_read_b64_tr_b16 v[34:35], v205 offset:49664
v_mfma_f32_32x32x16_bf16 v[64:79], v[52:55], v[44:47], v[64:79]
ds_read_b128 v[28:31], v211 offset:49152
ds_read_b64_tr_b16 v[36:37], v205 offset:51200
ds_read_b64_tr_b16 v[38:39], v205 offset:51712
s_waitcnt lgkmcnt(6)
v_mfma_f32_32x32x16_bf16 v[64:79], v[104:107], v[96:99], v[64:79]
ds_read_b128 v[40:43], v210 offset:53248
ds_read_b64_tr_b16 v[48:49], v205 offset:53248
ds_read_b64_tr_b16 v[50:51], v205 offset:53760
v_mfma_f32_32x32x16_bf16 v[64:79], v[108:111], v[100:103], v[64:79]
ds_read_b128 v[44:47], v211 offset:53248
ds_read_b64_tr_b16 v[52:53], v205 offset:55296
ds_read_b64_tr_b16 v[54:55], v205 offset:55808
s_waitcnt lgkmcnt(6)
s_barrier
v_mfma_f32_32x32x16_bf16 v[64:79], v[32:35], v[24:27], v[64:79]
ds_read_b128 v[96:99], v210 offset:57344
ds_read_b64_tr_b16 v[104:105], v205 offset:57344
ds_read_b64_tr_b16 v[106:107], v205 offset:57856
v_mfma_f32_32x32x16_bf16 v[64:79], v[36:39], v[28:31], v[64:79]
ds_read_b128 v[100:103], v211 offset:57344
ds_read_b64_tr_b16 v[108:109], v205 offset:59392
ds_read_b64_tr_b16 v[110:111], v205 offset:59904
s_waitcnt lgkmcnt(6)
v_mfma_f32_32x32x16_bf16 v[64:79], v[48:51], v[40:43], v[64:79]
ds_read_b128 v[24:27], v210 offset:61440
ds_read_b64_tr_b16 v[32:33], v205 offset:61440
ds_read_b64_tr_b16 v[34:35], v205 offset:61952
v_mfma_f32_32x32x16_bf16 v[64:79], v[52:55], v[44:47], v[64:79]
ds_read_b128 v[28:31], v211 offset:61440
ds_read_b64_tr_b16 v[36:37], v205 offset:63488
ds_read_b64_tr_b16 v[38:39], v205 offset:64000
s_waitcnt lgkmcnt(6)
s_barrier
v_mfma_f32_32x32x16_bf16 v[64:79], v[104:107], v[96:99], v[64:79]
ds_read_b128 v[40:43], v210 offset:0
ds_read_b64_tr_b16 v[48:49], v212 offset:0
ds_read_b64_tr_b16 v[50:51], v212 offset:512
v_mfma_f32_32x32x16_bf16 v[64:79], v[108:111], v[100:103], v[64:79]
ds_read_b128 v[44:47], v211 offset:0
ds_read_b64_tr_b16 v[52:53], v212 offset:2048
ds_read_b64_tr_b16 v[54:55], v212 offset:2560
s_waitcnt lgkmcnt(6)
v_mfma_f32_32x32x16_bf16 v[64:79], v[32:35], v[24:27], v[64:79]
ds_read_b128 v[96:99], v210 offset:4096
ds_read_b64_tr_b16 v[104:105], v212 offset:4096
ds_read_b64_tr_b16 v[106:107], v212 offset:4608
v_mfma_f32_32x32x16_bf16 v[64:79], v[36:39], v[28:31], v[64:79]
ds_read_b128 v[100:103], v211 offset:4096
ds_read_b64_tr_b16 v[108:109], v212 offset:6144
ds_read_b64_tr_b16 v[110:111], v212 offset:6656
s_waitcnt lgkmcnt(6)
s_barrier
v_mfma_f32_32x32x16_bf16 v[64:79], v[48:51], v[40:43], v[64:79]
ds_read_b128 v[24:27], v210 offset:8192
ds_read_b64_tr_b16 v[32:33], v212 offset:8192
ds_read_b64_tr_b16 v[34:35], v212 offset:8704
v_mfma_f32_32x32x16_bf16 v[64:79], v[52:55], v[44:47], v[64:79]
ds_read_b128 v[28:31], v211 offset:8192
ds_read_b64_tr_b16 v[36:37], v212 offset:10240
ds_read_b64_tr_b16 v[38:39], v212 offset:10752
s_waitcnt lgkmcnt(6)
v_mfma_f32_32x32x16_bf16 v[64:79], v[104:107], v[96:99], v[64:79]
ds_read_b128 v[40:43], v210 offset:12288
ds_read_b64_tr_b16 v[48:49], v212 offset:12288
ds_read_b64_tr_b16 v[50:51], v212 offset:12800
v_mfma_f32_32x32x16_bf16 v[64:79], v[108:111], v[100:103], v[64:79]
ds_read_b128 v[44:47], v211 offset:12288
ds_read_b64_tr_b16 v[52:53], v212 offset:14336
ds_read_b64_tr_b16 v[54:55], v212 offset:14848
s_waitcnt lgkmcnt(6)
s_barrier
v_mfma_f32_32x32x16_bf16 v[64:79], v[32:35], v[24:27], v[64:79]
ds_read_b128 v[96:99], v210 offset:16384
ds_read_b64_tr_b16 v[104:105], v212 offset:16384
ds_read_b64_tr_b16 v[106:107], v212 offset:16896
v_mfma_f32_32x32x16_bf16 v[64:79], v[36:39], v[28:31], v[64:79]
ds_read_b128 v[100:103], v211 offset:16384
ds_read_b64_tr_b16 v[108:109], v212 offset:18432
ds_read_b64_tr_b16 v[110:111], v212 offset:18944
s_waitcnt lgkmcnt(6)
v_mfma_f32_32x32x16_bf16 v[64:79], v[48:51], v[40:43], v[64:79]
ds_read_b128 v[24:27], v210 offset:20480
ds_read_b64_tr_b16 v[32:33], v212 offset:20480
ds_read_b64_tr_b16 v[34:35], v212 offset:20992
v_mfma_f32_32x32x16_bf16 v[64:79], v[52:55], v[44:47], v[64:79]
ds_read_b128 v[28:31], v211 offset:20480
ds_read_b64_tr_b16 v[36:37], v212 offset:22528
ds_read_b64_tr_b16 v[38:39], v212 offset:23040
s_waitcnt lgkmcnt(6)
s_barrier
v_mfma_f32_32x32x16_bf16 v[64:79], v[104:107], v[96:99], v[64:79]
ds_read_b128 v[40:43], v210 offset:24576
ds_read_b64_tr_b16 v[48:49], v212 offset:24576
ds_read_b64_tr_b16 v[50:51], v212 offset:25088
v_mfma_f32_32x32x16_bf16 v[64:79], v[108:111], v[100:103], v[64:79]
ds_read_b128 v[44:47], v211 offset:24576
ds_read_b64_tr_b16 v[52:53], v212 offset:26624
ds_read_b64_tr_b16 v[54:55], v212 offset:27136
s_waitcnt lgkmcnt(6)
v_mfma_f32_32x32x16_bf16 v[64:79], v[32:35], v[24:27], v[64:79]
ds_read_b128 v[96:99], v210 offset:28672
ds_read_b64_tr_b16 v[104:105], v212 offset:28672
ds_read_b64_tr_b16 v[106:107], v212 offset:29184
v_mfma_f32_32x32x16_bf16 v[64:79], v[36:39], v[28:31], v[64:79]
ds_read_b128 v[100:103], v211 offset:28672
ds_read_b64_tr_b16 v[108:109], v212 offset:30720
ds_read_b64_tr_b16 v[110:111], v212 offset:31232
s_waitcnt lgkmcnt(6)
s_barrier
v_mfma_f32_32x32x16_bf16 v[64:79], v[48:51], v[40:43], v[64:79]
ds_read_b128 v[24:27], v210 offset:32768
ds_read_b64_tr_b16 v[32:33], v205 offset:0
ds_read_b64_tr_b16 v[34:35], v205 offset:512
v_mfma_f32_32x32x16_bf16 v[64:79], v[52:55], v[44:47], v[64:79]
ds_read_b128 v[28:31], v211 offset:32768
ds_read_b64_tr_b16 v[36:37], v205 offset:2048
ds_read_b64_tr_b16 v[38:39], v205 offset:2560
s_waitcnt lgkmcnt(6)
v_mfma_f32_32x32x16_bf16 v[64:79], v[104:107], v[96:99], v[64:79]
ds_read_b128 v[40:43], v210 offset:36864
ds_read_b64_tr_b16 v[48:49], v205 offset:4096
ds_read_b64_tr_b16 v[50:51], v205 offset:4608
v_mfma_f32_32x32x16_bf16 v[64:79], v[108:111], v[100:103], v[64:79]
ds_read_b128 v[44:47], v211 offset:36864
ds_read_b64_tr_b16 v[52:53], v205 offset:6144
ds_read_b64_tr_b16 v[54:55], v205 offset:6656
s_waitcnt lgkmcnt(6)
s_barrier
v_mfma_f32_32x32x16_bf16 v[64:79], v[32:35], v[24:27], v[64:79]
ds_read_b128 v[96:99], v210 offset:40960
ds_read_b64_tr_b16 v[104:105], v205 offset:8192
ds_read_b64_tr_b16 v[106:107], v205 offset:8704
v_mfma_f32_32x32x16_bf16 v[64:79], v[36:39], v[28:31], v[64:79]
ds_read_b128 v[100:103], v211 offset:40960
ds_read_b64_tr_b16 v[108:109], v205 offset:10240
ds_read_b64_tr_b16 v[110:111], v205 offset:10752
s_waitcnt lgkmcnt(6)
v_mfma_f32_32x32x16_bf16 v[64:79], v[48:51], v[40:43], v[64:79]
ds_read_b128 v[24:27], v210 offset:45056
ds_read_b64_tr_b16 v[32:33], v205 offset:12288
ds_read_b64_tr_b16 v[34:35], v205 offset:12800
v_mfma_f32_32x32x16_bf16 v[64:79], v[52:55], v[44:47], v[64:79]
ds_read_b128 v[28:31], v211 offset:45056
ds_read_b64_tr_b16 v[36:37], v205 offset:14336
ds_read_b64_tr_b16 v[38:39], v205 offset:14848
s_waitcnt lgkmcnt(6)
s_barrier
v_mfma_f32_32x32x16_bf16 v[64:79], v[104:107], v[96:99], v[64:79]
ds_read_b128 v[40:43], v210 offset:49152
ds_read_b64_tr_b16 v[48:49], v205 offset:16384
ds_read_b64_tr_b16 v[50:51], v205 offset:16896
v_mfma_f32_32x32x16_bf16 v[64:79], v[108:111], v[100:103], v[64:79]
ds_read_b128 v[44:47], v211 offset:49152
ds_read_b64_tr_b16 v[52:53], v205 offset:18432
ds_read_b64_tr_b16 v[54:55], v205 offset:18944
s_waitcnt lgkmcnt(6)
v_mfma_f32_32x32x16_bf16 v[64:79], v[32:35], v[24:27], v[64:79]
ds_read_b128 v[96:99], v210 offset:53248
ds_read_b64_tr_b16 v[104:105], v205 offset:20480
ds_read_b64_tr_b16 v[106:107], v205 offset:20992
v_mfma_f32_32x32x16_bf16 v[64:79], v[36:39], v[28:31], v[64:79]
ds_read_b128 v[100:103], v211 offset:53248
ds_read_b64_tr_b16 v[108:109], v205 offset:22528
ds_read_b64_tr_b16 v[110:111], v205 offset:23040
s_waitcnt lgkmcnt(6)
s_barrier
v_mfma_f32_32x32x16_bf16 v[64:79], v[48:51], v[40:43], v[64:79]
ds_read_b128 v[24:27], v210 offset:57344
ds_read_b64_tr_b16 v[32:33], v205 offset:24576
ds_read_b64_tr_b16 v[34:35], v205 offset:25088
v_mfma_f32_32x32x16_bf16 v[64:79], v[52:55], v[44:47], v[64:79]
ds_read_b128 v[28:31], v211 offset:57344
ds_read_b64_tr_b16 v[36:37], v205 offset:26624
ds_read_b64_tr_b16 v[38:39], v205 offset:27136
s_waitcnt lgkmcnt(6)
v_mfma_f32_32x32x16_bf16 v[64:79], v[104:107], v[96:99], v[64:79]
ds_read_b128 v[40:43], v210 offset:61440
ds_read_b64_tr_b16 v[48:49], v205 offset:28672
ds_read_b64_tr_b16 v[50:51], v205 offset:29184
v_mfma_f32_32x32x16_bf16 v[64:79], v[108:111], v[100:103], v[64:79]
ds_read_b128 v[44:47], v211 offset:61440
ds_read_b64_tr_b16 v[52:53], v205 offset:30720
ds_read_b64_tr_b16 v[54:55], v205 offset:31232
s_waitcnt lgkmcnt(6)
s_barrier
v_mfma_f32_32x32x16_bf16 v[64:79], v[32:35], v[24:27], v[64:79]
ds_read_b128 v[96:99], v210 offset:0
ds_read_b64_tr_b16 v[104:105], v205 offset:32768
ds_read_b64_tr_b16 v[106:107], v205 offset:33280
v_mfma_f32_32x32x16_bf16 v[64:79], v[36:39], v[28:31], v[64:79]
ds_read_b128 v[100:103], v211 offset:0
ds_read_b64_tr_b16 v[108:109], v205 offset:34816
ds_read_b64_tr_b16 v[110:111], v205 offset:35328
s_waitcnt lgkmcnt(6)
v_mfma_f32_32x32x16_bf16 v[64:79], v[48:51], v[40:43], v[64:79]
ds_read_b128 v[24:27], v210 offset:4096
ds_read_b64_tr_b16 v[32:33], v205 offset:36864
ds_read_b64_tr_b16 v[34:35], v205 offset:37376
v_mfma_f32_32x32x16_bf16 v[64:79], v[52:55], v[44:47], v[64:79]
ds_read_b128 v[28:31], v211 offset:4096
ds_read_b64_tr_b16 v[36:37], v205 offset:38912
ds_read_b64_tr_b16 v[38:39], v205 offset:39424
s_waitcnt lgkmcnt(6)
s_barrier
v_mfma_f32_32x32x16_bf16 v[64:79], v[104:107], v[96:99], v[64:79]
ds_read_b128 v[40:43], v210 offset:8192
ds_read_b64_tr_b16 v[48:49], v205 offset:40960
ds_read_b64_tr_b16 v[50:51], v205 offset:41472
v_mfma_f32_32x32x16_bf16 v[64:79], v[108:111], v[100:103], v[64:79]
ds_read_b128 v[44:47], v211 offset:8192
ds_read_b64_tr_b16 v[52:53], v205 offset:43008
ds_read_b64_tr_b16 v[54:55], v205 offset:43520
s_waitcnt lgkmcnt(6)
v_mfma_f32_32x32x16_bf16 v[64:79], v[32:35], v[24:27], v[64:79]
ds_read_b128 v[96:99], v210 offset:12288
ds_read_b64_tr_b16 v[104:105], v205 offset:45056
ds_read_b64_tr_b16 v[106:107], v205 offset:45568
v_mfma_f32_32x32x16_bf16 v[64:79], v[36:39], v[28:31], v[64:79]
ds_read_b128 v[100:103], v211 offset:12288
ds_read_b64_tr_b16 v[108:109], v205 offset:47104
ds_read_b64_tr_b16 v[110:111], v205 offset:47616
s_waitcnt lgkmcnt(6)
s_barrier
v_mfma_f32_32x32x16_bf16 v[64:79], v[48:51], v[40:43], v[64:79]
ds_read_b128 v[24:27], v210 offset:16384
ds_read_b64_tr_b16 v[32:33], v205 offset:49152
ds_read_b64_tr_b16 v[34:35], v205 offset:49664
v_mfma_f32_32x32x16_bf16 v[64:79], v[52:55], v[44:47], v[64:79]
ds_read_b128 v[28:31], v211 offset:16384
ds_read_b64_tr_b16 v[36:37], v205 offset:51200
ds_read_b64_tr_b16 v[38:39], v205 offset:51712
s_waitcnt lgkmcnt(6)
v_mfma_f32_32x32x16_bf16 v[64:79], v[104:107], v[96:99], v[64:79]
ds_read_b128 v[40:43], v210 offset:20480
ds_read_b64_tr_b16 v[48:49], v205 offset:53248
ds_read_b64_tr_b16 v[50:51], v205 offset:53760
v_mfma_f32_32x32x16_bf16 v[64:79], v[108:111], v[100:103], v[64:79]
ds_read_b128 v[44:47], v211 offset:20480
ds_read_b64_tr_b16 v[52:53], v205 offset:55296
ds_read_b64_tr_b16 v[54:55], v205 offset:55808
s_waitcnt lgkmcnt(6)
s_barrier
v_mfma_f32_32x32x16_bf16 v[64:79], v[32:35], v[24:27], v[64:79]
ds_read_b128 v[96:99], v210 offset:24576
ds_read_b64_tr_b16 v[104:105], v205 offset:57344
ds_read_b64_tr_b16 v[106:107], v205 offset:57856
v_mfma_f32_32x32x16_bf16 v[64:79], v[36:39], v[28:31], v[64:79]
ds_read_b128 v[100:103], v211 offset:24576
ds_read_b64_tr_b16 v[108:109], v205 offset:59392
ds_read_b64_tr_b16 v[110:111], v205 offset:59904
s_waitcnt lgkmcnt(6)
v_mfma_f32_32x32x16_bf16 v[64:79], v[48:51], v[40:43], v[64:79]
ds_read_b128 v[24:27], v210 offset:28672
ds_read_b64_tr_b16 v[32:33], v205 offset:61440
ds_read_b64_tr_b16 v[34:35], v205 offset:61952
v_mfma_f32_32x32x16_bf16 v[64:79], v[52:55], v[44:47], v[64:79]
ds_read_b128 v[28:31], v211 offset:28672
ds_read_b64_tr_b16 v[36:37], v205 offset:63488
ds_read_b64_tr_b16 v[38:39], v205 offset:64000
s_waitcnt lgkmcnt(6)
s_barrier
v_mfma_f32_32x32x16_bf16 v[64:79], v[104:107], v[96:99], v[64:79]
ds_read_b128 v[40:43], v210 offset:32768
ds_read_b64_tr_b16 v[48:49], v212 offset:0
ds_read_b64_tr_b16 v[50:51], v212 offset:512
v_mfma_f32_32x32x16_bf16 v[64:79], v[108:111], v[100:103], v[64:79]
ds_read_b128 v[44:47], v211 offset:32768
ds_read_b64_tr_b16 v[52:53], v212 offset:2048
ds_read_b64_tr_b16 v[54:55], v212 offset:2560
s_waitcnt lgkmcnt(6)
v_mfma_f32_32x32x16_bf16 v[64:79], v[32:35], v[24:27], v[64:79]
ds_read_b128 v[96:99], v210 offset:36864
ds_read_b64_tr_b16 v[104:105], v212 offset:4096
ds_read_b64_tr_b16 v[106:107], v212 offset:4608
v_mfma_f32_32x32x16_bf16 v[64:79], v[36:39], v[28:31], v[64:79]
ds_read_b128 v[100:103], v211 offset:36864
ds_read_b64_tr_b16 v[108:109], v212 offset:6144
ds_read_b64_tr_b16 v[110:111], v212 offset:6656
s_waitcnt lgkmcnt(6)
s_barrier
v_mfma_f32_32x32x16_bf16 v[64:79], v[48:51], v[40:43], v[64:79]
ds_read_b128 v[24:27], v210 offset:40960
ds_read_b64_tr_b16 v[32:33], v212 offset:8192
ds_read_b64_tr_b16 v[34:35], v212 offset:8704
v_mfma_f32_32x32x16_bf16 v[64:79], v[52:55], v[44:47], v[64:79]
ds_read_b128 v[28:31], v211 offset:40960
ds_read_b64_tr_b16 v[36:37], v212 offset:10240
ds_read_b64_tr_b16 v[38:39], v212 offset:10752
s_waitcnt lgkmcnt(6)
s_barrier
v_mfma_f32_32x32x16_bf16 v[64:79], v[104:107], v[96:99], v[64:79]
ds_read_b128 v[40:43], v210 offset:49152
ds_read_b64_tr_b16 v[48:49], v212 offset:16384
ds_read_b64_tr_b16 v[50:51], v212 offset:16896
v_mfma_f32_32x32x16_bf16 v[64:79], v[108:111], v[100:103], v[64:79]
ds_read_b128 v[44:47], v211 offset:49152
ds_read_b64_tr_b16 v[52:53], v212 offset:18432
ds_read_b64_tr_b16 v[54:55], v212 offset:18944
s_waitcnt lgkmcnt(6)
v_mfma_f32_32x32x16_bf16 v[64:79], v[32:35], v[24:27], v[64:79]
ds_read_b128 v[96:99], v210 offset:53248
ds_read_b64_tr_b16 v[104:105], v212 offset:20480
ds_read_b64_tr_b16 v[106:107], v212 offset:20992
v_mfma_f32_32x32x16_bf16 v[64:79], v[36:39], v[28:31], v[64:79]
ds_read_b128 v[100:103], v211 offset:53248
ds_read_b64_tr_b16 v[108:109], v212 offset:22528
ds_read_b64_tr_b16 v[110:111], v212 offset:23040
s_waitcnt lgkmcnt(6)
s_barrier
v_mfma_f32_32x32x16_bf16 v[80:95], v[48:51], v[40:43], 0
ds_read_b128 v[24:27], v210 offset:57344
ds_read_b64_tr_b16 v[32:33], v212 offset:24576
ds_read_b64_tr_b16 v[34:35], v212 offset:25088
v_mfma_f32_32x32x16_bf16 v[80:95], v[52:55], v[44:47], v[80:95]
ds_read_b128 v[28:31], v211 offset:57344
ds_read_b64_tr_b16 v[36:37], v212 offset:26624
ds_read_b64_tr_b16 v[38:39], v212 offset:27136
s_waitcnt lgkmcnt(6)
v_mfma_f32_32x32x16_bf16 v[80:95], v[104:107], v[96:99], v[80:95]
ds_read_b128 v[40:43], v210 offset:61440
ds_read_b64_tr_b16 v[48:49], v212 offset:28672
ds_read_b64_tr_b16 v[50:51], v212 offset:29184
v_mfma_f32_32x32x16_bf16 v[80:95], v[108:111], v[100:103], v[80:95]
ds_read_b128 v[44:47], v211 offset:61440
ds_read_b64_tr_b16 v[52:53], v212 offset:30720
ds_read_b64_tr_b16 v[54:55], v212 offset:31232
s_waitcnt lgkmcnt(6)
s_barrier
v_mfma_f32_32x32x16_bf16 v[80:95], v[32:35], v[24:27], v[80:95]
ds_read_b128 v[96:99], v210 offset:0
ds_read_b64_tr_b16 v[104:105], v205 offset:0
ds_read_b64_tr_b16 v[106:107], v205 offset:512
v_mfma_f32_32x32x16_bf16 v[80:95], v[36:39], v[28:31], v[80:95]
ds_read_b128 v[100:103], v211 offset:0
ds_read_b64_tr_b16 v[108:109], v205 offset:2048
ds_read_b64_tr_b16 v[110:111], v205 offset:2560
s_waitcnt lgkmcnt(6)
v_mfma_f32_32x32x16_bf16 v[80:95], v[48:51], v[40:43], v[80:95]
ds_read_b128 v[24:27], v210 offset:4096
ds_read_b64_tr_b16 v[32:33], v205 offset:4096
ds_read_b64_tr_b16 v[34:35], v205 offset:4608
v_mfma_f32_32x32x16_bf16 v[80:95], v[52:55], v[44:47], v[80:95]
ds_read_b128 v[28:31], v211 offset:4096
ds_read_b64_tr_b16 v[36:37], v205 offset:6144
ds_read_b64_tr_b16 v[38:39], v205 offset:6656
s_waitcnt lgkmcnt(6)
s_barrier
v_mfma_f32_32x32x16_bf16 v[80:95], v[104:107], v[96:99], v[80:95]
ds_read_b128 v[40:43], v210 offset:8192
ds_read_b64_tr_b16 v[48:49], v205 offset:8192
ds_read_b64_tr_b16 v[50:51], v205 offset:8704
v_mfma_f32_32x32x16_bf16 v[80:95], v[108:111], v[100:103], v[80:95]
ds_read_b128 v[44:47], v211 offset:8192
ds_read_b64_tr_b16 v[52:53], v205 offset:10240
ds_read_b64_tr_b16 v[54:55], v205 offset:10752
s_waitcnt lgkmcnt(6)
v_mfma_f32_32x32x16_bf16 v[80:95], v[32:35], v[24:27], v[80:95]
ds_read_b128 v[96:99], v210 offset:12288
ds_read_b64_tr_b16 v[104:105], v205 offset:12288
ds_read_b64_tr_b16 v[106:107], v205 offset:12800
v_mfma_f32_32x32x16_bf16 v[80:95], v[36:39], v[28:31], v[80:95]
ds_read_b128 v[100:103], v211 offset:12288
ds_read_b64_tr_b16 v[108:109], v205 offset:14336
ds_read_b64_tr_b16 v[110:111], v205 offset:14848
s_waitcnt lgkmcnt(6)
s_barrier
v_mfma_f32_32x32x16_bf16 v[80:95], v[48:51], v[40:43], v[80:95]
ds_read_b128 v[24:27], v210 offset:16384
ds_read_b64_tr_b16 v[32:33], v205 offset:16384
ds_read_b64_tr_b16 v[34:35], v205 offset:16896
v_mfma_f32_32x32x16_bf16 v[80:95], v[52:55], v[44:47], v[80:95]
ds_read_b128 v[28:31], v211 offset:16384
ds_read_b64_tr_b16 v[36:37], v205 offset:18432
ds_read_b64_tr_b16 v[38:39], v205 offset:18944
s_waitcnt lgkmcnt(6)
v_mfma_f32_32x32x16_bf16 v[80:95], v[104:107], v[96:99], v[80:95]
ds_read_b128 v[40:43], v210 offset:20480
ds_read_b64_tr_b16 v[48:49], v205 offset:20480
ds_read_b64_tr_b16 v[50:51], v205 offset:20992
v_mfma_f32_32x32x16_bf16 v[80:95], v[108:111], v[100:103], v[80:95]
ds_read_b128 v[44:47], v211 offset:20480
ds_read_b64_tr_b16 v[52:53], v205 offset:22528
ds_read_b64_tr_b16 v[54:55], v205 offset:23040
s_waitcnt lgkmcnt(6)
s_barrier
v_mfma_f32_32x32x16_bf16 v[80:95], v[32:35], v[24:27], v[80:95]
ds_read_b128 v[96:99], v210 offset:24576
ds_read_b64_tr_b16 v[104:105], v205 offset:24576
ds_read_b64_tr_b16 v[106:107], v205 offset:25088
v_mfma_f32_32x32x16_bf16 v[80:95], v[36:39], v[28:31], v[80:95]
ds_read_b128 v[100:103], v211 offset:24576
ds_read_b64_tr_b16 v[108:109], v205 offset:26624
ds_read_b64_tr_b16 v[110:111], v205 offset:27136
s_waitcnt lgkmcnt(6)
v_mfma_f32_32x32x16_bf16 v[80:95], v[48:51], v[40:43], v[80:95]
ds_read_b128 v[24:27], v210 offset:28672
ds_read_b64_tr_b16 v[32:33], v205 offset:28672
ds_read_b64_tr_b16 v[34:35], v205 offset:29184
v_mfma_f32_32x32x16_bf16 v[80:95], v[52:55], v[44:47], v[80:95]
ds_read_b128 v[28:31], v211 offset:28672
ds_read_b64_tr_b16 v[36:37], v205 offset:30720
ds_read_b64_tr_b16 v[38:39], v205 offset:31232
s_waitcnt lgkmcnt(6)
s_barrier
v_mfma_f32_32x32x16_bf16 v[80:95], v[104:107], v[96:99], v[80:95]
ds_read_b128 v[40:43], v210 offset:32768
ds_read_b64_tr_b16 v[48:49], v205 offset:32768
ds_read_b64_tr_b16 v[50:51], v205 offset:33280
v_mfma_f32_32x32x16_bf16 v[80:95], v[108:111], v[100:103], v[80:95]
ds_read_b128 v[44:47], v211 offset:32768
ds_read_b64_tr_b16 v[52:53], v205 offset:34816
ds_read_b64_tr_b16 v[54:55], v205 offset:35328
s_waitcnt lgkmcnt(6)
v_mfma_f32_32x32x16_bf16 v[80:95], v[32:35], v[24:27], v[80:95]
ds_read_b128 v[96:99], v210 offset:36864
ds_read_b64_tr_b16 v[104:105], v205 offset:36864
ds_read_b64_tr_b16 v[106:107], v205 offset:37376
v_mfma_f32_32x32x16_bf16 v[80:95], v[36:39], v[28:31], v[80:95]
ds_read_b128 v[100:103], v211 offset:36864
ds_read_b64_tr_b16 v[108:109], v205 offset:38912
ds_read_b64_tr_b16 v[110:111], v205 offset:39424
s_waitcnt lgkmcnt(6)
s_barrier
v_mfma_f32_32x32x16_bf16 v[80:95], v[48:51], v[40:43], v[80:95]
ds_read_b128 v[24:27], v210 offset:40960
ds_read_b64_tr_b16 v[32:33], v205 offset:40960
ds_read_b64_tr_b16 v[34:35], v205 offset:41472
v_mfma_f32_32x32x16_bf16 v[80:95], v[52:55], v[44:47], v[80:95]
ds_read_b128 v[28:31], v211 offset:40960
ds_read_b64_tr_b16 v[36:37], v205 offset:43008
ds_read_b64_tr_b16 v[38:39], v205 offset:43520
s_waitcnt lgkmcnt(6)
v_mfma_f32_32x32x16_bf16 v[80:95], v[104:107], v[96:99], v[80:95]
ds_read_b128 v[40:43], v210 offset:45056
ds_read_b64_tr_b16 v[48:49], v205 offset:45056
ds_read_b64_tr_b16 v[50:51], v205 offset:45568
v_mfma_f32_32x32x16_bf16 v[80:95], v[108:111], v[100:103], v[80:95]
ds_read_b128 v[44:47], v211 offset:45056
ds_read_b64_tr_b16 v[52:53], v205 offset:47104
ds_read_b64_tr_b16 v[54:55], v205 offset:47616
s_waitcnt lgkmcnt(6)
v_mfma_f32_32x32x16_bf16 v[80:95], v[32:35], v[24:27], v[80:95]
v_mfma_f32_32x32x16_bf16 v[80:95], v[36:39], v[28:31], v[80:95]
s_waitcnt lgkmcnt(0)
v_mfma_f32_32x32x16_bf16 v[80:95], v[48:51], v[40:43], v[80:95]
v_mfma_f32_32x32x16_bf16 v[80:95], v[52:55], v[44:47], v[80:95]
v_pk_add_f32 v[64:65], v[64:65], v[128:129]
v_pk_add_f32 v[66:67], v[66:67], v[130:131]
v_pk_add_f32 v[68:69], v[68:69], v[132:133]
v_pk_add_f32 v[70:71], v[70:71], v[134:135]
v_pk_add_f32 v[72:73], v[72:73], v[136:137]
v_pk_add_f32 v[74:75], v[74:75], v[138:139]
v_pk_add_f32 v[76:77], v[76:77], v[140:141]
v_pk_add_f32 v[78:79], v[78:79], v[142:143]
v_pk_mul_f32 v[64:65], v[64:65], v[214:215] op_sel_hi:[1,0]
v_pk_mul_f32 v[66:67], v[66:67], v[214:215] op_sel_hi:[1,0]
v_pk_mul_f32 v[68:69], v[68:69], v[214:215] op_sel_hi:[1,0]
v_pk_mul_f32 v[70:71], v[70:71], v[214:215] op_sel_hi:[1,0]
v_pk_mul_f32 v[72:73], v[72:73], v[214:215] op_sel_hi:[1,0]
v_pk_mul_f32 v[74:75], v[74:75], v[214:215] op_sel_hi:[1,0]
v_pk_mul_f32 v[76:77], v[76:77], v[214:215] op_sel_hi:[1,0]
v_pk_mul_f32 v[78:79], v[78:79], v[214:215] op_sel_hi:[1,0]
v_pk_fma_f32 v[64:65], v[80:81], v[216:217], v[64:65] op_sel_hi:[1,0,1]
v_pk_fma_f32 v[66:67], v[82:83], v[216:217], v[66:67] op_sel_hi:[1,0,1]
v_pk_fma_f32 v[68:69], v[84:85], v[216:217], v[68:69] op_sel_hi:[1,0,1]
v_pk_fma_f32 v[70:71], v[86:87], v[216:217], v[70:71] op_sel_hi:[1,0,1]
v_pk_fma_f32 v[72:73], v[88:89], v[216:217], v[72:73] op_sel_hi:[1,0,1]
v_pk_fma_f32 v[74:75], v[90:91], v[216:217], v[74:75] op_sel_hi:[1,0,1]
v_pk_fma_f32 v[76:77], v[92:93], v[216:217], v[76:77] op_sel_hi:[1,0,1]
v_pk_fma_f32 v[78:79], v[94:95], v[216:217], v[78:79] op_sel_hi:[1,0,1]
v_cvt_pk_bf16_f32 v40, v64, v65
v_cvt_pk_bf16_f32 v41, v66, v67
v_cvt_pk_bf16_f32 v42, v68, v69
v_cvt_pk_bf16_f32 v43, v70, v71
v_cvt_pk_bf16_f32 v44, v72, v73
v_cvt_pk_bf16_f32 v45, v74, v75
v_cvt_pk_bf16_f32 v46, v76, v77
v_cvt_pk_bf16_f32 v47, v78, v79
v_permlane16_swap_b32 v40, v44
v_permlane16_swap_b32 v41, v45
v_permlane16_swap_b32 v42, v46
v_permlane16_swap_b32 v43, v47
s_lshl_b32 s68, s3, 8
s_lshl_b32 s69, s76, 6
s_add_u32 s68, s68, s69
s_lshl_b32 s69, s59, 5
s_add_u32 s68, s68, s69
s_lshl_b32 s68, s68, 10
s_lshl_b32 s69, s77, 7
s_add_u32 s68, s68, s69
s_lshl_b32 s69, s60, 6
s_add_u32 s68, s68, s69
s_add_u32 s69, s68, 16384
v_and_b32 v56, 15, v1
v_lshlrev_b32 v56, 10, v56
v_lshrrev_b32 v57, 4, v1
v_lshlrev_b32 v57, 4, v57
v_add_u32 v56, v56, v57
buffer_store_dwordx4 v[40:43], v56, s[44:47], s68 offen
buffer_store_dwordx4 v[44:47], v56, s[44:47], s69 offen
L_end:
s_endpgm
L_kend:
.section .rodata,"a"
.p2align 6
.amdhsa_kernel gated_mix__linear_kernel_hedgehog__mixer_s_mlp__prompt_kernel
  .amdhsa_next_free_vgpr 256
  .amdhsa_next_free_sgpr 96
  .amdhsa_accum_offset 256
  .amdhsa_group_segment_fixed_size 0
  .amdhsa_kernarg_size 104
  .amdhsa_user_sgpr_count 2
  .amdhsa_user_sgpr_kernarg_segment_ptr 1
  .amdhsa_system_sgpr_workgroup_id_x 1
.end_amdhsa_kernel
```
